```python
import torch

def _softmax(x, axis=-1):
    return torch.softmax(x, dim=axis)
def _gelu(x):
    return torch.nn.functional.gelu(x, approximate="tanh")
def _silu(x):
    return torch.nn.functional.silu(x)
def _sigmoid(x):
    return torch.sigmoid(x)
def _layernorm(x, axis=-1, eps=1e-5):
    m = x.mean(dim=axis, keepdim=True)
    v = x.var(dim=axis, keepdim=True, unbiased=False)
    return (x - m) / torch.sqrt(v + eps)
def _scatter_add(tgt, idx, src, axis=0):
    return tgt.clone().index_add_(axis, idx, src)
def _segment_sum(src, seg, n):
    out = torch.zeros((n,) + src.shape[1:], dtype=src.dtype)
    return out.index_add_(0, seg, src)
def _pad(x, pw):
    flat = tuple(v for pair in reversed(pw) for v in pair)
    return torch.nn.functional.pad(x, flat)

kernel_name = 'recurrent_scan__linear_kernel_hedgehog__mixer_s_mlp__prompt'

def setup_inputs():

    _w = (lambda a: (lambda t: t.to(torch.bfloat16) if t.is_floating_point() else t)(torch.as_tensor(a)))
    def _A_setup():
        B, S, D, H = 1, 2048, 448, 16
        Dh = D // H
        return {
            "x": _w((lambda *s: torch.randn(*s, dtype=torch.bfloat16) * 0.05)(B, S, D)),
            "wqkv": _w((lambda *s: torch.randn(*s, dtype=torch.bfloat16) * 0.2)(D, 3 * D)),
            "w_phi": _w((lambda *s: torch.randn(*s, dtype=torch.bfloat16) * 0.2)(H, Dh, Dh) * (Dh ** -0.5)),
            "wo": _w((lambda *s: torch.randn(*s, dtype=torch.bfloat16) * 0.05)(D, D)),
        }
    _A_in = _A_setup()

    def _B_setup():
        B, S, D, F = 1, 2048, 448, 1792
        return {
            "x":  _w((lambda *s: torch.randn(*s, dtype=torch.bfloat16) * 0.05)(B, S, D)),
            "w1": _w((lambda *s: torch.randn(*s, dtype=torch.bfloat16) * 0.8)(D, D) * (D ** -0.5)),
            "w2": _w((lambda *s: torch.randn(*s, dtype=torch.bfloat16) * 0.8)(D, D) * (D ** -0.5)),
            "w3": _w((lambda *s: torch.randn(*s, dtype=torch.bfloat16) * 0.8)(D, F) * (D ** -0.5)),
            "w4": _w((lambda *s: torch.randn(*s, dtype=torch.bfloat16) * 0.8)(F, D) * (F ** -0.5)),
        }
    _B_in = _B_setup()

    return {
        "A_x": _A_in["x"],
        "A_wqkv": _A_in["wqkv"],
        "A_w_phi": _A_in["w_phi"],
        "A_wo": _A_in["wo"],
        "B_x": _B_in["x"],
        "B_w1": _B_in["w1"],
        "B_w2": _B_in["w2"],
        "B_w3": _B_in["w3"],
        "B_w4": _B_in["w4"],
    }

def reference(A_x, A_wqkv, A_w_phi, A_wo, B_x, B_w1, B_w2, B_w3, B_w4):
    def _A_ref(x, wqkv, w_phi, wo):
        B, S, D = x.shape
        H = 16; Dh = D // H
        qkv = (lambda x, *d: x.permute(*d))((x @ wqkv).reshape(B, S, 3, H, Dh), 2, 0, 3, 1, 4)
        q, k, v = qkv[0], qkv[1], qkv[2]
        pq = torch.einsum("bhsd,hdf->bhsf", q, w_phi)
        pk = torch.einsum("bhsd,hdf->bhsf", k, w_phi)
        phi_q = torch.concatenate([_softmax(pq, axis=-1), _softmax(-pq, axis=-1)], axis=-1)
        phi_k = torch.concatenate([_softmax(pk, axis=-1), _softmax(-pk, axis=-1)], axis=-1)
        kv = torch.einsum("bhsf,bhsd->bhfd", phi_k, v)
        z  = torch.einsum("bhsf->bhf", phi_k)
        num = torch.einsum("bhqf,bhfd->bhqd", phi_q, kv)
        den = torch.einsum("bhqf,bhf->bhq", phi_q, z)[..., None] + 1e-6
        o = num / den
        return (lambda x, *d: x.permute(*d))(o, 0, 2, 1, 3).reshape(B, S, D) @ wo

    def _B_ref(x, w1, w2, w3, w4):
        B, S, D = x.shape
        h = _gelu(_layernorm(x, axis=-1) @ w1)
        c = D // 4
        g0 = _pad(h[:, :, 0*c:1*c], ((0, 0), (1, 0), (0, 0)))[:, :S, :]
        g1 = _pad(h[:, :, 1*c:2*c], ((0, 0), (0, 1), (0, 0)))[:, 1:, :]
        g2 = _pad(h[:, :, 2*c:3*c], ((0, 0), (2, 0), (0, 0)))[:, :S, :]
        g3 = _pad(h[:, :, 3*c:   ], ((0, 0), (0, 2), (0, 0)))[:, 2:, :]
        hs = torch.concatenate([g0, g1, g2, g3], axis=-1) @ w2
        x1 = x + hs
        h2 = _gelu(_layernorm(x1, axis=-1) @ w3) @ w4
        return x1 + h2

    x = A_x
    xn = _layernorm(x, axis=-1)
    s = _A_ref(xn, A_wqkv, A_w_phi, A_wo)
    g = _silu(_B_ref(xn, B_w1, B_w2, B_w3, B_w4))
    return x + s * g
```

```asm
; @launch grid=(256,1,1) block=(256,1,1) lds=163840
.amdgcn_target "amdgcn-amd-amdhsa--gfx950"
.text
.globl recurrent_scan__linear_kernel_hedgehog__mixer_s_mlp__prompt_kernel
.p2align 8
.type recurrent_scan__linear_kernel_hedgehog__mixer_s_mlp__prompt_kernel,@function
recurrent_scan__linear_kernel_hedgehog__mixer_s_mlp__prompt_kernel:
    s_cmp_ge_u32 s2, 256
    s_cbranch_scc1 L_end
    s_load_dwordx8 s[8:15], s[0:1], 0
    s_load_dwordx8 s[16:23], s[0:1], 40
    s_load_dwordx4 s[24:27], s[0:1], 72
    s_load_dwordx2 s[28:29], s[0:1], 88
    v_lshrrev_b32 v2, 6, v0
    v_and_b32 v1, 63, v0
    v_readfirstlane_b32 s5, v2
    s_lshr_b32 s6, s2, 3
    s_sub_u32 s4, s6, 4
    s_mul_i32 s7, s4, 37
    s_lshr_b32 s7, s7, 8
    s_mul_i32 s3, s7, 7
    s_sub_u32 s4, s4, s3
    s_cmp_lt_u32 s6, 4
    s_cselect_b32 s4, 7, s4
    s_cselect_b32 s7, s6, s7
    s_and_b32 s3, s2, 7
    s_lshl_b32 s3, s3, 2
    s_add_u32 s3, s3, s7
    s_xor_b32 s91, s3, s4
    s_and_b32 s91, s91, 1
    s_and_b32 s6, s5, 1
    s_lshr_b32 s7, s5, 1
    s_lshl_b32 s76, s5, 10
    s_lshl_b32 s31, s2, 2
    s_add_u32 s31, s31, s5
    s_getpc_b64 s[36:37]
L_pc:
    s_lshr_b32 s38, s2, 3
    s_lshl_b32 s38, s38, 2
    s_add_u32 s38, s38, s5
    s_and_b32 s38, s38, 31
    s_mul_i32 s38, s38, 2048
    v_and_b32_e64 v2, 15, v1
    v_lshl_add_u32 v2, v2, 7, s38
    v_min_u32 v2, L_code_end-L_pc-4, v2
    global_load_dword v7, v2, s[36:37]
    s_cmp_eq_u32 s4, 7
    s_cbranch_scc1 L_spare
    v_lshrrev_b32_e64 v2, 2, v1
    v_mul_u32_u24 v255, 896, v2
    v_and_b32_e64 v3, 3, v1
    v_lshl_add_u32 v255, v3, 4, v255
    s_lshl_b32 s30, s3, 2
    s_add_u32 s30, s30, s5
    s_mul_i32 s30, s30, 14336
    s_lshl_b32 s78, s4, 7
    s_add_u32 s78, s78, s30
    s_mul_i32 s89, s91, 448
    s_add_u32 s77, s30, s89
    s_add_u32 s30, s30, 448
    s_sub_u32 s30, s30, s89
    v_mov_b32 v254, 0
    v_lshlrev_b32 v253, 7, v1
    v_lshlrev_b32_e64 v252, 4, v1
    s_mov_b32 s34, 1835008
    s_mov_b32 s35, 0x20000
    s_waitcnt lgkmcnt(0)
    s_mov_b64 s[32:33], s[8:9]
    s_mov_b64 s[36:37], s[10:11]
    s_mov_b32 s38, 1204224
    s_mov_b32 s39, 0x20000
    s_mov_b64 s[72:73], s[28:29]
    s_mov_b32 s74, 18087936
    s_mov_b32 s75, 0x20000
    s_cmp_eq_u32 s2, 32
    s_nop 0
    s_cselect_b32 s87, 0, 0x7f000000
    buffer_load_dword v248, v254, s[72:75], s87 offen sc1
    buffer_load_dwordx4 v[12:15], v255, s[32:35], s77 offen offset:0
    buffer_load_dwordx4 v[16:19], v255, s[32:35], s77 offen offset:64
    buffer_load_dwordx4 v[20:23], v255, s[32:35], s77 offen offset:128
    buffer_load_dwordx4 v[24:27], v255, s[32:35], s77 offen offset:192
    buffer_load_dwordx4 v[28:31], v255, s[32:35], s77 offen offset:256
    buffer_load_dwordx4 v[32:35], v255, s[32:35], s77 offen offset:320
    buffer_load_dwordx4 v[36:39], v255, s[32:35], s77 offen offset:384
    s_mov_b64 s[48:49], s[16:17]
    s_mov_b32 s50, 401408
    s_mov_b32 s51, 0x20000
    s_mov_b64 s[40:41], s[12:13]
    s_mov_b32 s42, 25088
    s_mov_b32 s43, 0x20000
    s_mov_b64 s[56:57], s[20:21]
    s_mov_b32 s58, 1605632
    s_mov_b32 s59, 0x20000
    s_mov_b64 s[68:69], s[26:27]
    s_mov_b32 s70, 256
    s_mov_b32 s71, 0x20000
    s_mov_b64 s[44:45], s[14:15]
    s_mov_b32 s46, 401408
    s_mov_b32 s47, 0x20000
    s_mov_b64 s[52:53], s[18:19]
    s_mov_b32 s54, 401408
    s_mov_b32 s55, 0x20000
    s_mov_b64 s[60:61], s[22:23]
    s_mov_b32 s62, 1605632
    s_mov_b32 s63, 0x20000
    s_mov_b64 s[64:65], s[24:25]
    s_mov_b32 s66, 1835008
    s_mov_b32 s67, 0x20000
    v_lshrrev_b32 v2, 3, v1
    v_lshrrev_b32 v3, 2, v1
    v_and_b32 v3, 4, v3
    v_and_b32 v4, 7, v1
    v_xor_b32 v4, v4, v3
    v_lshlrev_b32 v5, 4, v4
    v_mul_u32_u24 v246, 896, v2
    v_add_u32_e64 v246, v246, v5
    v_add_u32 v244, 6144, v246
    v_add_u32 v243, 12288, v246
    v_add_u32 v242, 18432, v246
    s_mov_b32 s88, s78
    s_lshl_b32 s8, s4, 7
    s_mul_i32 s18, s5, 7168
    s_mul_i32 s79, s5, 50176
    s_add_u32 s79, s79, s8
    s_mul_i32 s11, s91, 200704
    s_add_u32 s80, s79, 200704
    s_sub_u32 s80, s80, s11
    s_add_u32 s79, s79, s11
    s_mul_i32 s9, s4, 57344
    v_lshl_add_u32 v245, v2, 7, v5
    v_cmp_eq_u32 vcc, 7, v4
    v_mul_u32_u24 v241, 2688, v2
    v_add_u32_e64 v241, v241, v5
    v_mov_b32 v3, 0x7fffff00
    v_cndmask_b32_e64 v241, v241, v3, vcc
    v_add_u32 v240, 20480, v241
    v_add_u32 v239, 40960, v241
    v_add_u32 v238, 61440, v241
    s_mul_i32 s83, s5, 150528
    s_mul_i32 s10, s4, 112
    s_add_u32 s83, s83, s10
    s_mul_i32 s11, s91, 602112
    s_add_u32 s85, s83, 602112
    s_sub_u32 s85, s85, s11
    s_add_u32 s83, s83, s11
    s_mul_i32 s81, s5, 7168
    s_add_u32 s81, s81, s9
    s_mul_i32 s11, s91, 28672
    s_add_u32 s82, s81, 28672
    s_sub_u32 s82, s82, s11
    s_add_u32 s81, s81, s11
    s_mul_i32 s92, s4, 3136
    s_add_u32 s92, s92, s76
    s_lshl_b32 s12, s3, 1
    s_add_u32 s12, s12, s6
    s_lshl_b32 s13, s4, 1
    s_add_u32 s13, s13, s7
    s_and_b32 s93, s3, 3
    s_lshl_b32 s93, s93, 1
    s_add_u32 s93, s93, s4
    s_cmp_ge_u32 s93, 7
    s_cselect_b32 s9, 7, 0
    s_sub_u32 s93, s93, s9
    s_mov_b32 s93, s6
    s_mul_i32 s84, s5, 401408
    s_add_u32 s84, s84, s8
    s_add_u32 s86, s84, 401408
    s_mul_i32 s9, s93, 57344
    s_add_u32 s84, s84, s9
    s_mov_b32 s94, 0
    s_mov_b32 s95, -1
    s_mov_b32 s96, 0x10000000
    s_mov_b32 s97, 0x10000000
    s_mov_b32 s98, 0x3fb8aa3b
    s_mov_b32 s99, s98
    v_cndmask_b32 v232, 1.0, 0, s[94:95]
    v_cndmask_b32 v231, -1, 0, s[94:95]
    v_mov_b32 v233, 0
    v_mov_b32 v2, 0x7fffff00
    v_cmp_eq_u32 vcc, 0, v0
    s_nop 1
    v_cndmask_b32_e64 v250, v2, v254, vcc
    buffer_load_dwordx4 v[40:43], v255, s[32:35], s30 offen offset:0
    buffer_load_dwordx4 v[44:47], v255, s[32:35], s30 offen offset:64
    buffer_load_dwordx4 v[48:51], v255, s[32:35], s30 offen offset:128
    buffer_load_dwordx4 v[52:55], v255, s[32:35], s30 offen offset:192
    buffer_load_dwordx4 v[56:59], v255, s[32:35], s30 offen offset:256
    buffer_load_dwordx4 v[60:63], v255, s[32:35], s30 offen offset:320
    buffer_load_dwordx4 v[64:67], v255, s[32:35], s30 offen offset:384
    v_and_b32_e64 v225, 31, v1
    v_bfe_u32 v2, v1, 2, 2
    v_lshrrev_b32_e64 v3, 5, v1
    v_lshl_add_u32 v226, v3, 2, v2
    v_and_b32 v4, 3, v1
    v_lshlrev_b32 v4, 3, v4
    v_bfe_u32 v5, v1, 4, 1
    v_lshl_add_u32 v227, v5, 5, v4
    v_lshrrev_b32 v2, 1, v2
    v_lshlrev_b32 v2, 6, v2
    s_lshl_b32 s8, s7, 6
    v_add_u32 v3, s8, v227
    v_xor_b32_e64 v3, v3, v2
    v_lshl_add_u32 v230, v226, 7, v3
    v_xor_b32 v229, 64, v230
    s_mul_i32 s8, s7, 56
    v_add_u32 v3, s8, v227
    v_xor_b32 v3, v3, v2
    v_lshl_add_u32 v228, v226, 7, v3
    v_add_u32 v224, 65536, v230
    v_add_u32 v223, 65536, v228
    v_add_u32 v222, 131072, v228
    v_add_u32 v221, s18, v230
    v_add_u32 v220, s18, v229
    v_add_u32 v219, 65536, v221
    v_add_u32 v218, 65536, v220
    s_lshl_b32 s8, s13, 1
    s_add_u32 s8, s8, 0
    s_mul_i32 s9, s8, 37
    s_lshr_b32 s9, s9, 8
    s_lshr_b32 s10, s9, 1
    s_add_u32 s10, s10, 1
    s_sub_u32 s11, 0, s10
    s_bitcmp1_b32 s9, 0
    s_cselect_b32 s10, s11, s10
    s_lshl_b32 s9, s12, 5
    s_add_u32 s9, s9, s10
    v_add_u32 v2, s9, v225
    v_cmp_gt_u32 vcc, 0x800, v2
    v_bfe_u32 v5, v2, 5, 6
    v_mul_u32_u24 v5, 28672, v5
    v_cndmask_b32 v214, 0, -1, vcc
    v_and_b32_e64 v2, 31, v2
    v_and_or_b32 v2, v1, 32, v2
    v_lshl_add_u32 v5, v2, 4, v5
    s_lshl_b32 s8, s8, 10
    s_add_u32 s8, s8, 1048576
    v_add_u32 v216, s8, v5
    s_lshl_b32 s8, s13, 1
    s_add_u32 s8, s8, 1
    s_mul_i32 s9, s8, 37
    s_lshr_b32 s9, s9, 8
    s_lshr_b32 s10, s9, 1
    s_add_u32 s10, s10, 1
    s_sub_u32 s11, 0, s10
    s_bitcmp1_b32 s9, 0
    s_cselect_b32 s10, s11, s10
    s_lshl_b32 s9, s12, 5
    s_add_u32 s9, s9, s10
    v_add_u32 v2, s9, v225
    v_cmp_gt_u32 vcc, 0x800, v2
    v_bfe_u32 v5, v2, 5, 6
    v_mul_u32_u24 v5, 28672, v5
    v_cndmask_b32 v215, 0, -1, vcc
    v_and_b32_e64 v2, 31, v2
    v_and_or_b32 v2, v1, 32, v2
    v_lshl_add_u32 v5, v2, 4, v5
    s_lshl_b32 s8, s8, 10
    s_add_u32 s8, s8, 1048576
    v_add_u32 v217, s8, v5
    v_lshrrev_b32 v2, 2, v1
    s_lshl_b32 s8, s6, 4
    v_add_u32_e64 v2, s8, v2
    v_bfe_u32 v3, v1, 1, 1
    v_lshlrev_b32 v4, 2, v3
    v_xor_b32 v2, v2, v4
    v_lshlrev_b32_e64 v2, 4, v2
    v_lshl_add_u32 v2, v3, 10, v2
    v_and_b32_e64 v3, 1, v1
    v_lshl_add_u32 v2, v3, 3, v2
    s_mul_i32 s8, s7, 28672
    v_add_u32 v213, s8, v2
    s_lshl_b32 s8, s7, 12
    s_add_u32 s8, s8, 151552
    v_add_u32_e64 v210, s8, v2
    s_mul_i32 s8, s6, 28672
    v_add_u32 v212, s8, v252
    v_xor_b32 v211, 64, v212
    v_and_b32 v2, 60, v1
    s_lshl_b32 s8, s5, 6
    s_add_u32 s8, s8, 161792
    v_add_u32 v207, s8, v2
    s_mul_i32 s8, s91, 7
    s_add_u32 s8, s8, s13
    s_cmp_ge_u32 s8, 14
    s_cselect_b32 s9, 14, 0
    s_sub_u32 s8, s8, s9
    s_lshl_b32 s8, s8, 11
    v_add_u32 v204, s8, v212
    v_add_u32 v205, s8, v211
    s_lshl_b32 s8, s6, 1
    s_add_u32 s8, s8, s7
    s_lshl_b32 s8, s8, 11
    s_add_u32 s8, s8, 151552
    v_add_u32 v202, s8, v252
    v_xor_b32 v203, 64, v202
    s_lshl_b32 s8, s6, 7
    s_add_u32 s8, s8, 161792
    v_lshl_add_u32 v206, v225, 2, s8
    v_min_u32 v2, 48, v227
    s_mul_i32 s8, s7, 1568
    s_add_u32 s8, s8, 143360
    v_add_u32 v2, s8, v2
    v_and_b32 v3, 3, v226
    v_mul_u32_u24 v3, 56, v3
    v_add_u32 v209, v3, v2
    v_mul_u32_u24 v4, 56, v226
    v_add_u32 v208, v4, v2
    v_mov_b32 v76, 0
    v_mov_b32 v77, 0
    v_mov_b32 v78, 0
    v_mov_b32 v79, 0
    v_mov_b32 v80, 0x3f803f80
    v_mov_b32 v81, 0x3f803f80
    v_mov_b32 v82, 0x3f803f80
    v_mov_b32 v83, 0x3f803f80
    s_waitcnt vmcnt(14)
    s_mov_b32 s9, 1664525
    v_mul_lo_u32 v248, v248, s9
    v_add_u32 v248, 1013904223, v248
    v_mov_b32 v249, 1
    buffer_store_dwordx2 v[248:249], v250, s[68:71], s87 offen sc1
    buffer_store_dword v248, v250, s[72:75], s87 offen sc1
    s_waitcnt vmcnt(15)
    v_dot2c_f32_bf16 v76, v12, v80
    v_dot2c_f32_bf16 v77, v12, v12
    v_dot2c_f32_bf16 v78, v13, v80
    v_dot2c_f32_bf16 v79, v13, v13
    v_dot2c_f32_bf16 v76, v14, v80
    v_dot2c_f32_bf16 v77, v14, v14
    v_dot2c_f32_bf16 v78, v15, v80
    v_dot2c_f32_bf16 v79, v15, v15
    buffer_load_dwordx4 v[68:71], v255, s[32:35], s88 offen offset:0
    buffer_load_dwordx4 v[72:75], v255, s[32:35], s88 offen offset:64
    s_add_u32 m0, s76, 143360
    s_nop 0
    buffer_load_dwordx4 v252, s[40:43], s92 offen lds
    s_waitcnt vmcnt(17)
    v_dot2c_f32_bf16 v76, v16, v80
    v_dot2c_f32_bf16 v77, v16, v16
    v_dot2c_f32_bf16 v78, v17, v80
    v_dot2c_f32_bf16 v79, v17, v17
    v_dot2c_f32_bf16 v76, v18, v80
    v_dot2c_f32_bf16 v77, v18, v18
    v_dot2c_f32_bf16 v78, v19, v80
    v_dot2c_f32_bf16 v79, v19, v19
    s_waitcnt vmcnt(16)
    v_dot2c_f32_bf16 v76, v20, v80
    v_dot2c_f32_bf16 v77, v20, v20
    v_dot2c_f32_bf16 v78, v21, v80
    v_dot2c_f32_bf16 v79, v21, v21
    v_dot2c_f32_bf16 v76, v22, v80
    v_dot2c_f32_bf16 v77, v22, v22
    v_dot2c_f32_bf16 v78, v23, v80
    v_dot2c_f32_bf16 v79, v23, v23
    s_add_u32 m0, s18, 57344
    s_add_u32 s78, s79, 0
    buffer_load_dwordx4 v246, s[48:51], s78 offen offset:0  lds
    s_waitcnt vmcnt(16)
    v_dot2c_f32_bf16 v76, v24, v80
    v_dot2c_f32_bf16 v77, v24, v24
    v_dot2c_f32_bf16 v78, v25, v80
    v_dot2c_f32_bf16 v79, v25, v25
    v_dot2c_f32_bf16 v76, v26, v80
    v_dot2c_f32_bf16 v77, v26, v26
    v_dot2c_f32_bf16 v78, v27, v80
    v_dot2c_f32_bf16 v79, v27, v27
    buffer_load_dwordx4 v244, s[48:51], s78 offen offset:1024  lds
    s_waitcnt vmcnt(16)
    v_dot2c_f32_bf16 v76, v28, v80
    v_dot2c_f32_bf16 v77, v28, v28
    v_dot2c_f32_bf16 v78, v29, v80
    v_dot2c_f32_bf16 v79, v29, v29
    v_dot2c_f32_bf16 v76, v30, v80
    v_dot2c_f32_bf16 v77, v30, v30
    v_dot2c_f32_bf16 v78, v31, v80
    v_dot2c_f32_bf16 v79, v31, v31
    buffer_load_dwordx4 v243, s[48:51], s78 offen offset:2048  lds
    s_waitcnt vmcnt(16)
    v_dot2c_f32_bf16 v76, v32, v80
    v_dot2c_f32_bf16 v77, v32, v32
    v_dot2c_f32_bf16 v78, v33, v80
    v_dot2c_f32_bf16 v79, v33, v33
    v_dot2c_f32_bf16 v76, v34, v80
    v_dot2c_f32_bf16 v77, v34, v34
    v_dot2c_f32_bf16 v78, v35, v80
    v_dot2c_f32_bf16 v79, v35, v35
    buffer_load_dwordx4 v242, s[48:51], s78 offen offset:3072  lds
    s_waitcnt vmcnt(16)
    v_dot2c_f32_bf16 v76, v36, v80
    v_dot2c_f32_bf16 v77, v36, v36
    v_dot2c_f32_bf16 v78, v37, v80
    v_dot2c_f32_bf16 v79, v37, v37
    v_dot2c_f32_bf16 v76, v38, v80
    v_dot2c_f32_bf16 v77, v38, v38
    v_dot2c_f32_bf16 v78, v39, v80
    v_dot2c_f32_bf16 v79, v39, v39
    s_add_u32 m0, s18, 61440
    s_add_u32 s78, s79, 28672
    buffer_load_dwordx4 v246, s[48:51], s78 offen offset:0  lds
    s_waitcnt vmcnt(16)
    v_dot2c_f32_bf16 v76, v40, v80
    v_dot2c_f32_bf16 v77, v40, v40
    v_dot2c_f32_bf16 v78, v41, v80
    v_dot2c_f32_bf16 v79, v41, v41
    v_dot2c_f32_bf16 v76, v42, v80
    v_dot2c_f32_bf16 v77, v42, v42
    v_dot2c_f32_bf16 v78, v43, v80
    v_dot2c_f32_bf16 v79, v43, v43
    buffer_load_dwordx4 v244, s[48:51], s78 offen offset:1024  lds
    s_waitcnt vmcnt(16)
    v_dot2c_f32_bf16 v76, v44, v80
    v_dot2c_f32_bf16 v77, v44, v44
    v_dot2c_f32_bf16 v78, v45, v80
    v_dot2c_f32_bf16 v79, v45, v45
    v_dot2c_f32_bf16 v76, v46, v80
    v_dot2c_f32_bf16 v77, v46, v46
    v_dot2c_f32_bf16 v78, v47, v80
    v_dot2c_f32_bf16 v79, v47, v47
    buffer_load_dwordx4 v243, s[48:51], s78 offen offset:2048  lds
    s_waitcnt vmcnt(16)
    v_dot2c_f32_bf16 v76, v48, v80
    v_dot2c_f32_bf16 v77, v48, v48
    v_dot2c_f32_bf16 v78, v49, v80
    v_dot2c_f32_bf16 v79, v49, v49
    v_dot2c_f32_bf16 v76, v50, v80
    v_dot2c_f32_bf16 v77, v50, v50
    v_dot2c_f32_bf16 v78, v51, v80
    v_dot2c_f32_bf16 v79, v51, v51
    s_add_u32 m0, s18, 86016
    s_add_u32 s78, s80, 0
    buffer_load_dwordx4 v246, s[48:51], s78 offen offset:0  lds
    s_waitcnt vmcnt(16)
    v_dot2c_f32_bf16 v76, v52, v80
    v_dot2c_f32_bf16 v77, v52, v52
    v_dot2c_f32_bf16 v78, v53, v80
    v_dot2c_f32_bf16 v79, v53, v53
    v_dot2c_f32_bf16 v76, v54, v80
    v_dot2c_f32_bf16 v77, v54, v54
    v_dot2c_f32_bf16 v78, v55, v80
    v_dot2c_f32_bf16 v79, v55, v55
    buffer_load_dwordx4 v244, s[48:51], s78 offen offset:1024  lds
    s_waitcnt vmcnt(16)
    v_dot2c_f32_bf16 v76, v56, v80
    v_dot2c_f32_bf16 v77, v56, v56
    v_dot2c_f32_bf16 v78, v57, v80
    v_dot2c_f32_bf16 v79, v57, v57
    v_dot2c_f32_bf16 v76, v58, v80
    v_dot2c_f32_bf16 v77, v58, v58
    v_dot2c_f32_bf16 v78, v59, v80
    v_dot2c_f32_bf16 v79, v59, v59
    buffer_load_dwordx4 v243, s[48:51], s78 offen offset:2048  lds
    s_waitcnt vmcnt(16)
    v_dot2c_f32_bf16 v76, v60, v80
    v_dot2c_f32_bf16 v77, v60, v60
    v_dot2c_f32_bf16 v78, v61, v80
    v_dot2c_f32_bf16 v79, v61, v61
    v_dot2c_f32_bf16 v76, v62, v80
    v_dot2c_f32_bf16 v77, v62, v62
    v_dot2c_f32_bf16 v78, v63, v80
    v_dot2c_f32_bf16 v79, v63, v63
    buffer_load_dwordx4 v242, s[48:51], s78 offen offset:3072  lds
    s_waitcnt vmcnt(16)
    v_dot2c_f32_bf16 v76, v64, v80
    v_dot2c_f32_bf16 v77, v64, v64
    v_dot2c_f32_bf16 v78, v65, v80
    v_dot2c_f32_bf16 v79, v65, v65
    v_dot2c_f32_bf16 v76, v66, v80
    v_dot2c_f32_bf16 v77, v66, v66
    v_dot2c_f32_bf16 v78, v67, v80
    v_dot2c_f32_bf16 v79, v67, v67
    s_add_u32 m0, s18, 90112
    s_add_u32 s78, s80, 28672
    buffer_load_dwordx4 v246, s[48:51], s78 offen offset:0  lds
    v_pk_add_f32 v[76:77], v[76:77], v[78:79]
    s_nop 1
    v_add_f32_dpp v76, v76, v76 quad_perm:[1,0,3,2] row_mask:0xf bank_mask:0xf
    v_add_f32_dpp v77, v77, v77 quad_perm:[1,0,3,2] row_mask:0xf bank_mask:0xf
    s_nop 0
    s_nop 0
    v_add_f32_dpp v76, v76, v76 quad_perm:[2,3,0,1] row_mask:0xf bank_mask:0xf
    v_add_f32_dpp v77, v77, v77 quad_perm:[2,3,0,1] row_mask:0xf bank_mask:0xf
    v_mul_f32 v76, 0x3b124925, v76
    v_mul_f32 v77, 0x3b124925, v77
    v_fma_f32 v77, -v76, v76, v77
    v_max_f32_e64 v77, 0, v77
    v_add_f32 v78, 0x3727c5ac, v77
    v_rsq_f32 v78, v78
    s_nop 0
    v_mul_f32_e64 v79, -v76, v78
    v_lshlrev_b32 v200, 16, v12
    v_lshlrev_b32 v198, 16, v13
    v_and_b32 v201, 0xffff0000, v12
    v_and_b32 v199, 0xffff0000, v13
    v_pk_fma_f32 v[200:201], v[200:201], v[78:79], v[78:79] op_sel:[0,0,1] op_sel_hi:[1,0,1]
    v_pk_fma_f32 v[198:199], v[198:199], v[78:79], v[78:79] op_sel:[0,0,1] op_sel_hi:[1,0,1]
    v_cvt_pk_bf16_f32 v12, v200, v201
    v_cvt_pk_bf16_f32 v13, v198, v199
    v_lshlrev_b32 v200, 16, v14
    v_lshlrev_b32 v198, 16, v15
    v_and_b32 v201, 0xffff0000, v14
    v_and_b32 v199, 0xffff0000, v15
    v_pk_fma_f32 v[200:201], v[200:201], v[78:79], v[78:79] op_sel:[0,0,1] op_sel_hi:[1,0,1]
    v_pk_fma_f32 v[198:199], v[198:199], v[78:79], v[78:79] op_sel:[0,0,1] op_sel_hi:[1,0,1]
    v_cvt_pk_bf16_f32 v14, v200, v201
    v_cvt_pk_bf16_f32 v15, v198, v199
    ds_write2st64_b64 v213, v[12:13], v[14:15] offset0:0 offset1:1
    buffer_load_dwordx4 v244, s[48:51], s78 offen offset:1024  lds
    buffer_load_dwordx4 v243, s[48:51], s78 offen offset:2048  lds
    v_lshlrev_b32 v200, 16, v16
    v_lshlrev_b32 v198, 16, v17
    v_and_b32 v201, 0xffff0000, v16
    v_and_b32 v199, 0xffff0000, v17
    v_pk_fma_f32 v[200:201], v[200:201], v[78:79], v[78:79] op_sel:[0,0,1] op_sel_hi:[1,0,1]
    v_pk_fma_f32 v[198:199], v[198:199], v[78:79], v[78:79] op_sel:[0,0,1] op_sel_hi:[1,0,1]
    v_cvt_pk_bf16_f32 v16, v200, v201
    v_cvt_pk_bf16_f32 v17, v198, v199
    v_lshlrev_b32 v200, 16, v18
    v_lshlrev_b32 v198, 16, v19
    v_and_b32 v201, 0xffff0000, v18
    v_and_b32 v199, 0xffff0000, v19
    v_pk_fma_f32 v[200:201], v[200:201], v[78:79], v[78:79] op_sel:[0,0,1] op_sel_hi:[1,0,1]
    v_pk_fma_f32 v[198:199], v[198:199], v[78:79], v[78:79] op_sel:[0,0,1] op_sel_hi:[1,0,1]
    v_cvt_pk_bf16_f32 v18, v200, v201
    v_cvt_pk_bf16_f32 v19, v198, v199
    ds_write2st64_b64 v213, v[16:17], v[18:19] offset0:4 offset1:5
    v_lshlrev_b32 v200, 16, v20
    v_lshlrev_b32 v198, 16, v21
    v_and_b32 v201, 0xffff0000, v20
    v_and_b32 v199, 0xffff0000, v21
    v_pk_fma_f32 v[200:201], v[200:201], v[78:79], v[78:79] op_sel:[0,0,1] op_sel_hi:[1,0,1]
    v_pk_fma_f32 v[198:199], v[198:199], v[78:79], v[78:79] op_sel:[0,0,1] op_sel_hi:[1,0,1]
    v_cvt_pk_bf16_f32 v20, v200, v201
    v_cvt_pk_bf16_f32 v21, v198, v199
    v_lshlrev_b32 v200, 16, v22
    v_lshlrev_b32 v198, 16, v23
    v_and_b32 v201, 0xffff0000, v22
    v_and_b32 v199, 0xffff0000, v23
    v_pk_fma_f32 v[200:201], v[200:201], v[78:79], v[78:79] op_sel:[0,0,1] op_sel_hi:[1,0,1]
    v_pk_fma_f32 v[198:199], v[198:199], v[78:79], v[78:79] op_sel:[0,0,1] op_sel_hi:[1,0,1]
    v_cvt_pk_bf16_f32 v22, v200, v201
    v_cvt_pk_bf16_f32 v23, v198, v199
    ds_write2st64_b64 v213, v[20:21], v[22:23] offset0:8 offset1:9
    s_sub_u32 s90, s31, 0
    s_mul_i32 s90, s90, 49
    s_lshr_b32 s90, s90, 4
    s_lshl_b32 s90, s90, 7
    v_min_u32 v247, 384, v253
    buffer_load_dword v7, v247, s[52:55], s90 offen
    buffer_load_dword v7, v247, s[44:47], s90 offen
    s_sub_u32 s90, s31, 0
    s_mul_i32 s90, s90, 49
    s_lshr_b32 s90, s90, 2
    s_lshl_b32 s90, s90, 7
    v_min_u32 v247, 1536, v253
    buffer_load_dword v7, v247, s[60:63], s90 offen
    s_lshl_b32 s90, s3, 5
    s_add_u32 s90, s90, s4
    s_lshl_b32 s90, s90, 2
    s_add_u32 s90, s90, 4096
    v_lshlrev_b32 v247, 12, v1
    v_min_u32 v247, 28672, v247
    buffer_load_dword v7, v247, s[72:75], s90 offen sc1
    v_lshlrev_b32 v200, 16, v24
    v_lshlrev_b32 v198, 16, v25
    v_and_b32 v201, 0xffff0000, v24
    v_and_b32 v199, 0xffff0000, v25
    v_pk_fma_f32 v[200:201], v[200:201], v[78:79], v[78:79] op_sel:[0,0,1] op_sel_hi:[1,0,1]
    v_pk_fma_f32 v[198:199], v[198:199], v[78:79], v[78:79] op_sel:[0,0,1] op_sel_hi:[1,0,1]
    v_cvt_pk_bf16_f32 v24, v200, v201
    v_cvt_pk_bf16_f32 v25, v198, v199
    v_lshlrev_b32 v200, 16, v26
    v_lshlrev_b32 v198, 16, v27
    v_and_b32 v201, 0xffff0000, v26
    v_and_b32 v199, 0xffff0000, v27
    v_pk_fma_f32 v[200:201], v[200:201], v[78:79], v[78:79] op_sel:[0,0,1] op_sel_hi:[1,0,1]
    v_pk_fma_f32 v[198:199], v[198:199], v[78:79], v[78:79] op_sel:[0,0,1] op_sel_hi:[1,0,1]
    v_cvt_pk_bf16_f32 v26, v200, v201
    v_cvt_pk_bf16_f32 v27, v198, v199
    ds_write2st64_b64 v213, v[24:25], v[26:27] offset0:12 offset1:13
    v_lshlrev_b32 v200, 16, v28
    v_lshlrev_b32 v198, 16, v29
    v_and_b32 v201, 0xffff0000, v28
    v_and_b32 v199, 0xffff0000, v29
    v_pk_fma_f32 v[200:201], v[200:201], v[78:79], v[78:79] op_sel:[0,0,1] op_sel_hi:[1,0,1]
    v_pk_fma_f32 v[198:199], v[198:199], v[78:79], v[78:79] op_sel:[0,0,1] op_sel_hi:[1,0,1]
    v_cvt_pk_bf16_f32 v28, v200, v201
    v_cvt_pk_bf16_f32 v29, v198, v199
    v_lshlrev_b32 v200, 16, v30
    v_lshlrev_b32 v198, 16, v31
    v_and_b32 v201, 0xffff0000, v30
    v_and_b32 v199, 0xffff0000, v31
    v_pk_fma_f32 v[200:201], v[200:201], v[78:79], v[78:79] op_sel:[0,0,1] op_sel_hi:[1,0,1]
    v_pk_fma_f32 v[198:199], v[198:199], v[78:79], v[78:79] op_sel:[0,0,1] op_sel_hi:[1,0,1]
    v_cvt_pk_bf16_f32 v30, v200, v201
    v_cvt_pk_bf16_f32 v31, v198, v199
    ds_write2st64_b64 v213, v[28:29], v[30:31] offset0:16 offset1:17
    v_lshlrev_b32 v200, 16, v32
    v_lshlrev_b32 v198, 16, v33
    v_and_b32 v201, 0xffff0000, v32
    v_and_b32 v199, 0xffff0000, v33
    v_pk_fma_f32 v[200:201], v[200:201], v[78:79], v[78:79] op_sel:[0,0,1] op_sel_hi:[1,0,1]
    v_pk_fma_f32 v[198:199], v[198:199], v[78:79], v[78:79] op_sel:[0,0,1] op_sel_hi:[1,0,1]
    v_cvt_pk_bf16_f32 v32, v200, v201
    v_cvt_pk_bf16_f32 v33, v198, v199
    v_lshlrev_b32 v200, 16, v34
    v_lshlrev_b32 v198, 16, v35
    v_and_b32 v201, 0xffff0000, v34
    v_and_b32 v199, 0xffff0000, v35
    v_pk_fma_f32 v[200:201], v[200:201], v[78:79], v[78:79] op_sel:[0,0,1] op_sel_hi:[1,0,1]
    v_pk_fma_f32 v[198:199], v[198:199], v[78:79], v[78:79] op_sel:[0,0,1] op_sel_hi:[1,0,1]
    v_cvt_pk_bf16_f32 v34, v200, v201
    v_cvt_pk_bf16_f32 v35, v198, v199
    ds_write2st64_b64 v213, v[32:33], v[34:35] offset0:20 offset1:21
    v_lshlrev_b32 v200, 16, v36
    v_lshlrev_b32 v198, 16, v37
    v_and_b32 v201, 0xffff0000, v36
    v_and_b32 v199, 0xffff0000, v37
    v_pk_fma_f32 v[200:201], v[200:201], v[78:79], v[78:79] op_sel:[0,0,1] op_sel_hi:[1,0,1]
    v_pk_fma_f32 v[198:199], v[198:199], v[78:79], v[78:79] op_sel:[0,0,1] op_sel_hi:[1,0,1]
    v_cvt_pk_bf16_f32 v36, v200, v201
    v_cvt_pk_bf16_f32 v37, v198, v199
    v_lshlrev_b32 v200, 16, v38
    v_lshlrev_b32 v198, 16, v39
    v_and_b32 v201, 0xffff0000, v38
    v_and_b32 v199, 0xffff0000, v39
    v_pk_fma_f32 v[200:201], v[200:201], v[78:79], v[78:79] op_sel:[0,0,1] op_sel_hi:[1,0,1]
    v_pk_fma_f32 v[198:199], v[198:199], v[78:79], v[78:79] op_sel:[0,0,1] op_sel_hi:[1,0,1]
    v_cvt_pk_bf16_f32 v38, v200, v201
    v_cvt_pk_bf16_f32 v39, v198, v199
    ds_write2st64_b64 v213, v[36:37], v[38:39] offset0:24 offset1:25
    v_lshlrev_b32 v200, 16, v40
    v_lshlrev_b32 v198, 16, v41
    v_and_b32 v201, 0xffff0000, v40
    v_and_b32 v199, 0xffff0000, v41
    v_pk_fma_f32 v[200:201], v[200:201], v[78:79], v[78:79] op_sel:[0,0,1] op_sel_hi:[1,0,1]
    v_pk_fma_f32 v[198:199], v[198:199], v[78:79], v[78:79] op_sel:[0,0,1] op_sel_hi:[1,0,1]
    v_cvt_pk_bf16_f32 v40, v200, v201
    v_cvt_pk_bf16_f32 v41, v198, v199
    v_lshlrev_b32 v200, 16, v42
    v_lshlrev_b32 v198, 16, v43
    v_and_b32 v201, 0xffff0000, v42
    v_and_b32 v199, 0xffff0000, v43
    v_pk_fma_f32 v[200:201], v[200:201], v[78:79], v[78:79] op_sel:[0,0,1] op_sel_hi:[1,0,1]
    v_pk_fma_f32 v[198:199], v[198:199], v[78:79], v[78:79] op_sel:[0,0,1] op_sel_hi:[1,0,1]
    v_cvt_pk_bf16_f32 v42, v200, v201
    v_cvt_pk_bf16_f32 v43, v198, v199
    ds_write2st64_b64 v213, v[40:41], v[42:43] offset0:28 offset1:29
    v_lshlrev_b32 v200, 16, v44
    v_lshlrev_b32 v198, 16, v45
    v_and_b32 v201, 0xffff0000, v44
    v_and_b32 v199, 0xffff0000, v45
    v_pk_fma_f32 v[200:201], v[200:201], v[78:79], v[78:79] op_sel:[0,0,1] op_sel_hi:[1,0,1]
    v_pk_fma_f32 v[198:199], v[198:199], v[78:79], v[78:79] op_sel:[0,0,1] op_sel_hi:[1,0,1]
    v_cvt_pk_bf16_f32 v44, v200, v201
    v_cvt_pk_bf16_f32 v45, v198, v199
    v_lshlrev_b32 v200, 16, v46
    v_lshlrev_b32 v198, 16, v47
    v_and_b32 v201, 0xffff0000, v46
    v_and_b32 v199, 0xffff0000, v47
    v_pk_fma_f32 v[200:201], v[200:201], v[78:79], v[78:79] op_sel:[0,0,1] op_sel_hi:[1,0,1]
    v_pk_fma_f32 v[198:199], v[198:199], v[78:79], v[78:79] op_sel:[0,0,1] op_sel_hi:[1,0,1]
    v_cvt_pk_bf16_f32 v46, v200, v201
    v_cvt_pk_bf16_f32 v47, v198, v199
    ds_write2st64_b64 v213, v[44:45], v[46:47] offset0:32 offset1:33
    v_lshlrev_b32_e64 v200, 16, v48
    s_add_u32 m0, s18, 114688
    s_add_u32 s78, s83, 896
    buffer_load_dwordx4 v241, s[36:39], s78 offen offset:0  lds
    v_lshlrev_b32_e64 v198, 16, v49
    buffer_load_dwordx4 v240, s[36:39], s78 offen offset:1024  lds
    v_and_b32 v201, 0xffff0000, v48
    buffer_load_dwordx4 v239, s[36:39], s78 offen offset:2048  lds
    v_and_b32 v199, 0xffff0000, v49
    buffer_load_dwordx4 v238, s[36:39], s78 offen offset:3072  lds
    v_pk_fma_f32 v[200:201], v[200:201], v[78:79], v[78:79] op_sel:[0,0,1] op_sel_hi:[1,0,1]
    v_pk_fma_f32 v[198:199], v[198:199], v[78:79], v[78:79] op_sel:[0,0,1] op_sel_hi:[1,0,1]
    v_cvt_pk_bf16_f32 v48, v200, v201
    v_cvt_pk_bf16_f32 v49, v198, v199
    v_lshlrev_b32 v200, 16, v50
    v_lshlrev_b32 v198, 16, v51
    v_and_b32 v201, 0xffff0000, v50
    v_and_b32 v199, 0xffff0000, v51
    v_pk_fma_f32 v[200:201], v[200:201], v[78:79], v[78:79] op_sel:[0,0,1] op_sel_hi:[1,0,1]
    v_pk_fma_f32 v[198:199], v[198:199], v[78:79], v[78:79] op_sel:[0,0,1] op_sel_hi:[1,0,1]
    v_cvt_pk_bf16_f32 v50, v200, v201
    v_cvt_pk_bf16_f32 v51, v198, v199
    ds_write2st64_b64 v213, v[48:49], v[50:51] offset0:36 offset1:37
    v_lshlrev_b32 v200, 16, v52
    v_lshlrev_b32 v198, 16, v53
    v_and_b32 v201, 0xffff0000, v52
    v_and_b32 v199, 0xffff0000, v53
    v_pk_fma_f32 v[200:201], v[200:201], v[78:79], v[78:79] op_sel:[0,0,1] op_sel_hi:[1,0,1]
    v_pk_fma_f32 v[198:199], v[198:199], v[78:79], v[78:79] op_sel:[0,0,1] op_sel_hi:[1,0,1]
    s_add_u32 m0, s18, 118784
    s_add_u32 s78, s83, 86912
    buffer_load_dwordx4 v241, s[36:39], s78 offen offset:0  lds
    v_cvt_pk_bf16_f32 v52, v200, v201
    v_cvt_pk_bf16_f32 v53, v198, v199
    v_lshlrev_b32 v200, 16, v54
    v_lshlrev_b32 v198, 16, v55
    v_and_b32 v201, 0xffff0000, v54
    v_and_b32 v199, 0xffff0000, v55
    v_pk_fma_f32 v[200:201], v[200:201], v[78:79], v[78:79] op_sel:[0,0,1] op_sel_hi:[1,0,1]
    v_pk_fma_f32 v[198:199], v[198:199], v[78:79], v[78:79] op_sel:[0,0,1] op_sel_hi:[1,0,1]
    v_cvt_pk_bf16_f32 v54, v200, v201
    v_cvt_pk_bf16_f32 v55, v198, v199
    ds_write2st64_b64 v213, v[52:53], v[54:55] offset0:40 offset1:41
    v_lshlrev_b32 v200, 16, v56
    v_lshlrev_b32 v198, 16, v57
    v_and_b32 v201, 0xffff0000, v56
    v_and_b32 v199, 0xffff0000, v57
    v_pk_fma_f32 v[200:201], v[200:201], v[78:79], v[78:79] op_sel:[0,0,1] op_sel_hi:[1,0,1]
    v_pk_fma_f32 v[198:199], v[198:199], v[78:79], v[78:79] op_sel:[0,0,1] op_sel_hi:[1,0,1]
    v_cvt_pk_bf16_f32 v56, v200, v201
    v_cvt_pk_bf16_f32 v57, v198, v199
    v_lshlrev_b32 v200, 16, v58
    v_lshlrev_b32 v198, 16, v59
    v_and_b32 v201, 0xffff0000, v58
    v_and_b32 v199, 0xffff0000, v59
    v_pk_fma_f32 v[200:201], v[200:201], v[78:79], v[78:79] op_sel:[0,0,1] op_sel_hi:[1,0,1]
    v_pk_fma_f32 v[198:199], v[198:199], v[78:79], v[78:79] op_sel:[0,0,1] op_sel_hi:[1,0,1]
    v_cvt_pk_bf16_f32 v58, v200, v201
    v_cvt_pk_bf16_f32 v59, v198, v199
    ds_write2st64_b64 v213, v[56:57], v[58:59] offset0:44 offset1:45
    v_lshlrev_b32 v200, 16, v60
    v_lshlrev_b32 v198, 16, v61
    buffer_load_dwordx4 v240, s[36:39], s78 offen offset:1024  lds
    v_and_b32 v201, 0xffff0000, v60
    v_and_b32 v199, 0xffff0000, v61
    v_pk_fma_f32 v[200:201], v[200:201], v[78:79], v[78:79] op_sel:[0,0,1] op_sel_hi:[1,0,1]
    v_pk_fma_f32 v[198:199], v[198:199], v[78:79], v[78:79] op_sel:[0,0,1] op_sel_hi:[1,0,1]
    v_cvt_pk_bf16_f32 v60, v200, v201
    v_cvt_pk_bf16_f32 v61, v198, v199
    v_lshlrev_b32 v200, 16, v62
    v_lshlrev_b32 v198, 16, v63
    v_and_b32 v201, 0xffff0000, v62
    v_and_b32 v199, 0xffff0000, v63
    v_pk_fma_f32 v[200:201], v[200:201], v[78:79], v[78:79] op_sel:[0,0,1] op_sel_hi:[1,0,1]
    v_pk_fma_f32 v[198:199], v[198:199], v[78:79], v[78:79] op_sel:[0,0,1] op_sel_hi:[1,0,1]
    v_cvt_pk_bf16_f32 v62, v200, v201
    v_cvt_pk_bf16_f32 v63, v198, v199
    ds_write2st64_b64 v213, v[60:61], v[62:63] offset0:48 offset1:49
    v_lshlrev_b32 v200, 16, v64
    v_lshlrev_b32 v198, 16, v65
    v_and_b32 v201, 0xffff0000, v64
    v_and_b32 v199, 0xffff0000, v65
    v_pk_fma_f32 v[200:201], v[200:201], v[78:79], v[78:79] op_sel:[0,0,1] op_sel_hi:[1,0,1]
    v_pk_fma_f32 v[198:199], v[198:199], v[78:79], v[78:79] op_sel:[0,0,1] op_sel_hi:[1,0,1]
    v_cvt_pk_bf16_f32 v64, v200, v201
    v_cvt_pk_bf16_f32 v65, v198, v199
    v_lshlrev_b32_e64 v200, 16, v66
    buffer_load_dwordx4 v239, s[36:39], s78 offen offset:2048  lds
    v_lshlrev_b32_e64 v198, 16, v67
    v_and_b32 v201, 0xffff0000, v66
    v_and_b32 v199, 0xffff0000, v67
    v_pk_fma_f32 v[200:201], v[200:201], v[78:79], v[78:79] op_sel:[0,0,1] op_sel_hi:[1,0,1]
    v_pk_fma_f32 v[198:199], v[198:199], v[78:79], v[78:79] op_sel:[0,0,1] op_sel_hi:[1,0,1]
    v_cvt_pk_bf16_f32 v66, v200, v201
    v_cvt_pk_bf16_f32 v67, v198, v199
    ds_write2st64_b64 v213, v[64:65], v[66:67] offset0:52 offset1:53
    s_waitcnt vmcnt(26)
    ds_write2st64_b64 v210, v[68:69], v[70:71] offset0:0 offset1:1
    ds_write2st64_b64 v210, v[72:73], v[74:75] offset0:4 offset1:5
    v_mul_f32 v77, v77, v78
    v_mul_f32_e64 v77, v77, v78
    v_add_f32 v77, 0x3727c5ac, v77
    v_rsq_f32 v77, v77
    s_nop 0
    ds_write_b32 v207, v77
    s_waitcnt lgkmcnt(0)
    s_waitcnt vmcnt(11)
    s_barrier
    s_nop 0
    ds_read_b128 a[0:3], v212 offset:0
    ds_read_b64_tr_b16 v[12:13], v230 offset:57344
    ds_read_b64_tr_b16 v[14:15], v230 offset:58368
    ds_read_b128 a[4:7], v211 offset:1024
    ds_read_b64_tr_b16 v[16:17], v230 offset:59392
    ds_read_b64_tr_b16 v[18:19], v230 offset:60416
    ds_read_b128 a[8:11], v212 offset:2048
    ds_read_b64_tr_b16 v[20:21], v230 offset:61440
    ds_read_b64_tr_b16 v[22:23], v230 offset:62464
    s_waitcnt lgkmcnt(6)
    v_mfma_f32_32x32x16_bf16 v[44:59], v[12:15], a[0:3], 0
    ds_read_b128 a[12:15], v211 offset:3072
    ds_read_b64_tr_b16 v[24:25], v230 offset:63488
    ds_read_b64_tr_b16 v[26:27], v230 offset:64512
    s_waitcnt lgkmcnt(6)
    v_mfma_f32_32x32x16_bf16 v[44:59], v[16:19], a[4:7], v[44:59]
    ds_read_b128 a[16:19], v212 offset:4096
    ds_read_b64_tr_b16 v[12:13], v224 offset:0
    ds_read_b64_tr_b16 v[14:15], v224 offset:1024
    s_waitcnt lgkmcnt(6)
    v_mfma_f32_32x32x16_bf16 v[44:59], v[20:23], a[8:11], v[44:59]
    ds_read_b128 a[20:23], v211 offset:5120
    ds_read_b64_tr_b16 v[16:17], v224 offset:2048
    ds_read_b64_tr_b16 v[18:19], v224 offset:3072
    s_waitcnt lgkmcnt(6)
    v_mfma_f32_32x32x16_bf16 v[44:59], v[24:27], a[12:15], v[44:59]
    ds_read_b128 a[24:27], v212 offset:6144
    ds_read_b64_tr_b16 v[20:21], v224 offset:4096
    ds_read_b64_tr_b16 v[22:23], v224 offset:5120
    s_waitcnt lgkmcnt(6)
    s_nop 0
    v_mfma_f32_32x32x16_bf16 v[44:59], v[12:15], a[16:19], v[44:59]
    ds_read_b128 a[28:31], v211 offset:7168
    ds_read_b64_tr_b16 v[24:25], v224 offset:6144
    ds_read_b64_tr_b16 v[26:27], v224 offset:7168
    buffer_load_dwordx4 v[8:11], v254, s[68:71], 0 offen sc1
    s_waitcnt lgkmcnt(6)
    v_mfma_f32_32x32x16_bf16 v[44:59], v[16:19], a[20:23], v[44:59]
    ds_read_b128 a[32:35], v212 offset:8192
    ds_read_b64_tr_b16 v[12:13], v224 offset:8192
    ds_read_b64_tr_b16 v[14:15], v224 offset:9216
    s_waitcnt lgkmcnt(6)
    v_mfma_f32_32x32x16_bf16 v[44:59], v[20:23], a[24:27], v[44:59]
    ds_read_b128 a[36:39], v211 offset:9216
    ds_read_b64_tr_b16 v[16:17], v224 offset:10240
    ds_read_b64_tr_b16 v[18:19], v224 offset:11264
    s_waitcnt lgkmcnt(6)
    v_mfma_f32_32x32x16_bf16 v[44:59], v[24:27], a[28:31], v[44:59]
    ds_read_b128 a[40:43], v212 offset:10240
    ds_read_b64_tr_b16 v[20:21], v224 offset:12288
    ds_read_b64_tr_b16 v[22:23], v224 offset:13312
    s_waitcnt lgkmcnt(6)
    v_mfma_f32_32x32x16_bf16 v[44:59], v[12:15], a[32:35], v[44:59]
    ds_read_b128 a[44:47], v211 offset:11264
    ds_read_b64_tr_b16 v[24:25], v224 offset:14336
    ds_read_b64_tr_b16 v[26:27], v224 offset:15360
    s_waitcnt lgkmcnt(6)
    v_mfma_f32_32x32x16_bf16 v[44:59], v[16:19], a[36:39], v[44:59]
    ds_read_b128 a[48:51], v212 offset:12288
    ds_read_b64_tr_b16 v[12:13], v224 offset:16384
    ds_read_b64_tr_b16 v[14:15], v224 offset:17408
    s_waitcnt lgkmcnt(6)
    v_mfma_f32_32x32x16_bf16 v[44:59], v[20:23], a[40:43], v[44:59]
    ds_read_b128 a[52:55], v211 offset:13312
    ds_read_b64_tr_b16 v[16:17], v224 offset:18432
    ds_read_b64_tr_b16 v[18:19], v224 offset:19456
    s_waitcnt lgkmcnt(6)
    v_mfma_f32_32x32x16_bf16 v[44:59], v[24:27], a[44:47], v[44:59]
    ds_read_b128 a[56:59], v212 offset:14336
    ds_read_b64_tr_b16 v[20:21], v224 offset:20480
    ds_read_b64_tr_b16 v[22:23], v224 offset:21504
    s_waitcnt lgkmcnt(6)
    v_mfma_f32_32x32x16_bf16 v[44:59], v[12:15], a[48:51], v[44:59]
    ds_read_b128 a[60:63], v211 offset:15360
    ds_read_b64_tr_b16 v[24:25], v224 offset:22528
    ds_read_b64_tr_b16 v[26:27], v224 offset:23552
    s_waitcnt lgkmcnt(6)
    v_mfma_f32_32x32x16_bf16 v[44:59], v[16:19], a[52:55], v[44:59]
    ds_read_b128 a[64:67], v212 offset:16384
    ds_read_b64_tr_b16 v[12:13], v224 offset:24576
    ds_read_b64_tr_b16 v[14:15], v224 offset:25600
    s_waitcnt lgkmcnt(6)
    v_mfma_f32_32x32x16_bf16 v[44:59], v[20:23], a[56:59], v[44:59]
    ds_read_b128 a[68:71], v211 offset:17408
    ds_read_b64_tr_b16 v[16:17], v224 offset:26624
    ds_read_b64_tr_b16 v[18:19], v224 offset:27648
    s_barrier
    s_waitcnt lgkmcnt(6)
    v_mfma_f32_32x32x16_bf16 v[44:59], v[24:27], a[60:63], v[44:59]
    ds_read_b128 a[72:75], v212 offset:18432
    ds_read_b64_tr_b16 v[20:21], v224 offset:28672
    ds_read_b64_tr_b16 v[22:23], v224 offset:29696
    s_add_u32 m0, s18, 57344
    s_add_u32 s78, s85, 896
    buffer_load_dwordx4 v241, s[36:39], s78 offen offset:0  lds
    s_waitcnt lgkmcnt(6)
    s_nop 0
    v_mfma_f32_32x32x16_bf16 v[44:59], v[12:15], a[64:67], v[44:59]
    ds_read_b128 a[76:79], v211 offset:19456
    ds_read_b64_tr_b16 v[24:25], v224 offset:30720
    ds_read_b64_tr_b16 v[26:27], v224 offset:31744
    buffer_load_dwordx4 v240, s[36:39], s78 offen offset:1024  lds
    buffer_load_dwordx4 v239, s[36:39], s78 offen offset:2048  lds
    buffer_load_dwordx4 v238, s[36:39], s78 offen offset:3072  lds
    s_waitcnt lgkmcnt(6)
    s_nop 0
    v_mfma_f32_32x32x16_bf16 v[44:59], v[16:19], a[68:71], v[44:59]
    ds_read_b128 a[80:83], v212 offset:20480
    ds_read_b64_tr_b16 v[12:13], v224 offset:32768
    ds_read_b64_tr_b16 v[14:15], v224 offset:33792
    s_add_u32 m0, s18, 61440
    s_add_u32 s78, s85, 86912
    buffer_load_dwordx4 v241, s[36:39], s78 offen offset:0  lds
    s_waitcnt lgkmcnt(6)
    v_mfma_f32_32x32x16_bf16 v[44:59], v[20:23], a[72:75], v[44:59]
    ds_read_b128 a[84:87], v211 offset:21504
    ds_read_b64_tr_b16 v[16:17], v224 offset:34816
    ds_read_b64_tr_b16 v[18:19], v224 offset:35840
    s_waitcnt lgkmcnt(6)
    v_mfma_f32_32x32x16_bf16 v[44:59], v[24:27], a[76:79], v[44:59]
    ds_read_b128 a[88:91], v212 offset:22528
    ds_read_b64_tr_b16 v[20:21], v224 offset:36864
    ds_read_b64_tr_b16 v[22:23], v224 offset:37888
    s_waitcnt lgkmcnt(6)
    v_mfma_f32_32x32x16_bf16 v[44:59], v[12:15], a[80:83], v[44:59]
    ds_read_b128 a[92:95], v211 offset:23552
    ds_read_b64_tr_b16 v[24:25], v224 offset:38912
    ds_read_b64_tr_b16 v[26:27], v224 offset:39936
    s_waitcnt lgkmcnt(6)
    v_mfma_f32_32x32x16_bf16 v[44:59], v[16:19], a[84:87], v[44:59]
    ds_read_b128 a[96:99], v212 offset:24576
    ds_read_b64_tr_b16 v[12:13], v224 offset:40960
    ds_read_b64_tr_b16 v[14:15], v224 offset:41984
    s_waitcnt lgkmcnt(6)
    v_mfma_f32_32x32x16_bf16 v[44:59], v[20:23], a[88:91], v[44:59]
    ds_read_b128 a[100:103], v211 offset:25600
    ds_read_b64_tr_b16 v[16:17], v224 offset:43008
    ds_read_b64_tr_b16 v[18:19], v224 offset:44032
    s_waitcnt lgkmcnt(6)
    v_mfma_f32_32x32x16_bf16 v[44:59], v[24:27], a[92:95], v[44:59]
    ds_read_b128 a[104:107], v212 offset:26624
    ds_read_b64_tr_b16 v[20:21], v224 offset:45056
    ds_read_b64_tr_b16 v[22:23], v224 offset:46080
    s_waitcnt lgkmcnt(6)
    v_mfma_f32_32x32x16_bf16 v[44:59], v[12:15], a[96:99], v[44:59]
    ds_read_b128 a[108:111], v211 offset:27648
    ds_read_b64_tr_b16 v[24:25], v224 offset:47104
    ds_read_b64_tr_b16 v[26:27], v224 offset:48128
    s_waitcnt lgkmcnt(6)
    v_mfma_f32_32x32x16_bf16 v[44:59], v[16:19], a[100:103], v[44:59]
    ds_read_b32 v206, v206
    ds_read_b128 v[60:63], v204
    ds_read_b128 v[64:67], v205 offset:1024
    ds_read_b128 v[68:71], v202
    ds_read_b128 v[72:75], v203 offset:1024
    s_waitcnt lgkmcnt(8)
    s_nop 0
    v_mfma_f32_32x32x16_bf16 v[44:59], v[20:23], a[104:107], v[44:59]
    ds_read_b64_tr_b16 a[112:113], v208 offset:0
    ds_read_b64_tr_b16 a[114:115], v208 offset:448
    ds_read_b64_tr_b16 a[116:117], v208 offset:896
    ds_read_b64_tr_b16 a[118:119], v209 offset:1344
    s_waitcnt lgkmcnt(9)
    v_mfma_f32_32x32x16_bf16 v[44:59], v[24:27], a[108:111], v[44:59]
    s_waitcnt vmcnt(5)
    v_readfirstlane_b32 s8, v9
    s_nop 0
    s_cmp_lt_u32 s8, 1
    s_cbranch_scc1 L_tok_retry_m
L_tok_ok_m:
    v_mov_b32 v251, v8
    s_waitcnt lgkmcnt(0)
    s_barrier
    v_rcp_f32 v200, v206
    v_mul_f32 v248, 0xc0135761, v206
    v_mul_f32 v249, v206, v206
    v_mul_f32 v249, v249, v206
    v_mul_f32 v249, 0xbdd2d3e8, v249
    v_pk_mul_f32 v[198:199], v[44:45], v[44:45]
    v_pk_mul_f32 v[196:197], v[46:47], v[46:47]
    v_pk_fma_f32 v[198:199], v[198:199], v[248:249], v[248:249] op_sel:[0,1,0] op_sel_hi:[1,1,0]
    v_pk_fma_f32 v[196:197], v[196:197], v[248:249], v[248:249] op_sel:[0,1,0] op_sel_hi:[1,1,0]
    v_pk_mul_f32 v[198:199], v[198:199], v[44:45]
    v_pk_mul_f32 v[196:197], v[196:197], v[46:47]
    v_exp_f32 v198, v198
    v_exp_f32 v199, v199
    v_exp_f32_e64 v196, v196
    buffer_load_dwordx4 v240, s[36:39], s78 offen offset:1024  lds
    v_exp_f32_e64 v197, v197
    v_pk_fma_f32 v[198:199], v[198:199], v[200:201], v[200:201] op_sel_hi:[1,0,0]
    v_pk_fma_f32 v[196:197], v[196:197], v[200:201], v[200:201] op_sel_hi:[1,0,0]
    v_rcp_f32 v198, v198
    v_rcp_f32 v199, v199
    v_rcp_f32 v196, v196
    v_rcp_f32 v197, v197
    v_pk_mul_f32 v[198:199], v[198:199], v[44:45]
    v_pk_mul_f32 v[196:197], v[196:197], v[46:47]
    v_cvt_pk_bf16_f32 v84, v198, v199
    v_cvt_pk_bf16_f32 v85, v196, v197
    v_pk_mul_f32 v[198:199], v[48:49], v[48:49]
    v_pk_mul_f32 v[196:197], v[50:51], v[50:51]
    v_pk_fma_f32 v[198:199], v[198:199], v[248:249], v[248:249] op_sel:[0,1,0] op_sel_hi:[1,1,0]
    v_pk_fma_f32 v[196:197], v[196:197], v[248:249], v[248:249] op_sel:[0,1,0] op_sel_hi:[1,1,0]
    v_pk_mul_f32 v[198:199], v[198:199], v[48:49]
    v_pk_mul_f32 v[196:197], v[196:197], v[50:51]
    v_exp_f32 v198, v198
    v_exp_f32 v199, v199
    v_exp_f32 v196, v196
    v_exp_f32 v197, v197
    v_pk_fma_f32 v[198:199], v[198:199], v[200:201], v[200:201] op_sel_hi:[1,0,0]
    buffer_load_dwordx4 v239, s[36:39], s78 offen offset:2048  lds
    v_pk_fma_f32 v[196:197], v[196:197], v[200:201], v[200:201] op_sel_hi:[1,0,0]
    v_rcp_f32 v198, v198
    v_rcp_f32 v199, v199
    v_rcp_f32 v196, v196
    v_rcp_f32 v197, v197
    v_pk_mul_f32 v[198:199], v[198:199], v[48:49]
    v_pk_mul_f32 v[196:197], v[196:197], v[50:51]
    v_cvt_pk_bf16_f32 v86, v198, v199
    v_cvt_pk_bf16_f32 v87, v196, v197
    v_and_b32 v84, v84, v214
    v_and_b32 v85, v85, v214
    v_and_b32 v86, v86, v214
    v_and_b32 v87, v87, v214
    buffer_store_dwordx4 v[84:87], v216, s[72:75], 0 offen sc1
    v_pk_mul_f32 v[198:199], v[52:53], v[52:53]
    v_pk_mul_f32 v[196:197], v[54:55], v[54:55]
    v_pk_fma_f32 v[198:199], v[198:199], v[248:249], v[248:249] op_sel:[0,1,0] op_sel_hi:[1,1,0]
    v_pk_fma_f32 v[196:197], v[196:197], v[248:249], v[248:249] op_sel:[0,1,0] op_sel_hi:[1,1,0]
    v_pk_mul_f32 v[198:199], v[198:199], v[52:53]
    v_pk_mul_f32 v[196:197], v[196:197], v[54:55]
    v_exp_f32 v198, v198
    v_exp_f32 v199, v199
    s_add_u32 m0, s18, 0
    s_add_u32 s78, s79, 0
    buffer_load_dwordx4 v246, s[52:55], s78 offen offset:0  lds
    v_exp_f32 v196, v196
    v_exp_f32 v197, v197
    v_pk_fma_f32 v[198:199], v[198:199], v[200:201], v[200:201] op_sel_hi:[1,0,0]
    v_pk_fma_f32 v[196:197], v[196:197], v[200:201], v[200:201] op_sel_hi:[1,0,0]
    v_rcp_f32 v198, v198
    v_rcp_f32 v199, v199
    v_rcp_f32 v196, v196
    v_rcp_f32 v197, v197
    v_pk_mul_f32 v[198:199], v[198:199], v[52:53]
    v_pk_mul_f32 v[196:197], v[196:197], v[54:55]
    v_cvt_pk_bf16_f32 v88, v198, v199
    v_cvt_pk_bf16_f32 v89, v196, v197
    v_pk_mul_f32 v[198:199], v[56:57], v[56:57]
    v_pk_mul_f32 v[196:197], v[58:59], v[58:59]
    v_pk_fma_f32 v[198:199], v[198:199], v[248:249], v[248:249] op_sel:[0,1,0] op_sel_hi:[1,1,0]
    v_pk_fma_f32 v[196:197], v[196:197], v[248:249], v[248:249] op_sel:[0,1,0] op_sel_hi:[1,1,0]
    v_pk_mul_f32 v[198:199], v[198:199], v[56:57]
    v_pk_mul_f32 v[196:197], v[196:197], v[58:59]
    v_exp_f32 v198, v198
    v_exp_f32 v199, v199
    v_exp_f32_e64 v196, v196
    buffer_load_dwordx4 v244, s[52:55], s78 offen offset:1024  lds
    v_exp_f32_e64 v197, v197
    buffer_load_dwordx4 v243, s[52:55], s78 offen offset:2048  lds
    v_pk_fma_f32 v[198:199], v[198:199], v[200:201], v[200:201] op_sel_hi:[1,0,0]
    v_pk_fma_f32 v[196:197], v[196:197], v[200:201], v[200:201] op_sel_hi:[1,0,0]
    v_rcp_f32 v198, v198
    v_rcp_f32 v199, v199
    v_rcp_f32 v196, v196
    v_rcp_f32 v197, v197
    v_pk_mul_f32 v[198:199], v[198:199], v[56:57]
    v_pk_mul_f32 v[196:197], v[196:197], v[58:59]
    v_cvt_pk_bf16_f32 v90, v198, v199
    v_cvt_pk_bf16_f32 v91, v196, v197
    v_and_b32 v88, v88, v215
    v_and_b32 v89, v89, v215
    v_and_b32 v90, v90, v215
    v_and_b32 v91, v91, v215
    buffer_store_dwordx4 v[88:91], v217, s[72:75], 0 offen sc1
    ds_read_b64_tr_b16 v[12:13], v223 offset:49152
    ds_read_b64_tr_b16 v[14:15], v223 offset:50176
    ds_read_b64_tr_b16 v[16:17], v223 offset:51200
    ds_read_b64_tr_b16 v[18:19], v223 offset:52224
    ds_read_b64_tr_b16 v[20:21], v223 offset:53248
    ds_read_b64_tr_b16 v[22:23], v223 offset:54272
    s_waitcnt lgkmcnt(4)
    s_nop 0
    v_mfma_f32_32x32x16_bf16 v[44:59], v[12:15], a[0:3], 0
    ds_read_b64_tr_b16 v[24:25], v223 offset:55296
    ds_read_b64_tr_b16 v[26:27], v223 offset:56320
    buffer_load_dwordx4 v242, s[52:55], s78 offen offset:3072  lds
    s_mul_i32 s8, s5, 4608
    s_add_u32 s8, s8, 143360
    s_waitcnt lgkmcnt(4)
    s_nop 0
    v_mfma_f32_32x32x16_bf16 v[44:59], v[16:19], a[4:7], v[44:59]
    ds_read_b64_tr_b16 v[12:13], v223 offset:57344
    ds_read_b64_tr_b16 v[14:15], v223 offset:58368
    s_add_u32 m0, s18, 4096
    s_add_u32 s78, s79, 28672
    buffer_load_dwordx4 v246, s[52:55], s78 offen offset:0  lds
    s_waitcnt lgkmcnt(4)
    s_nop 0
    v_mfma_f32_32x32x16_bf16 v[44:59], v[20:23], a[8:11], v[44:59]
    ds_read_b64_tr_b16 v[16:17], v223 offset:59392
    ds_read_b64_tr_b16 v[18:19], v223 offset:60416
    buffer_load_dwordx4 v244, s[52:55], s78 offen offset:1024  lds
    buffer_load_dwordx4 v243, s[52:55], s78 offen offset:2048  lds
    v_mul_u32_u24 v2, 144, v225
    s_waitcnt lgkmcnt(4)
    v_mfma_f32_32x32x16_bf16 v[44:59], v[24:27], a[12:15], v[44:59]
    ds_read_b64_tr_b16 v[20:21], v223 offset:61440
    ds_read_b64_tr_b16 v[22:23], v223 offset:62464
    v_and_b32 v3, 32, v1
    v_add3_u32 v217, v2, v3, s8
    v_bfe_u32 v3, v227, 3, 1
    s_waitcnt lgkmcnt(4)
    v_mfma_f32_32x32x16_bf16 v[44:59], v[12:15], a[16:19], v[44:59]
    ds_read_b64_tr_b16 v[24:25], v223 offset:63488
    ds_read_b64_tr_b16 v[26:27], v223 offset:64512
    v_lshlrev_b32 v3, 5, v3
    v_lshrrev_b32_e64 v4, 4, v227
    v_lshl_add_u32 v3, v4, 3, v3
    s_waitcnt lgkmcnt(4)
    s_nop 0
    v_mfma_f32_32x32x16_bf16 v[44:59], v[16:19], a[20:23], v[44:59]
    ds_read_b64_tr_b16 v[12:13], v222 offset:0
    ds_read_b64_tr_b16 v[14:15], v222 offset:1024
    v_mul_u32_u24 v4, 144, v226
    v_add3_u32 v3, v3, v4, s8
    v_add_u32 v249, s8, v252
    s_waitcnt lgkmcnt(4)
    v_mfma_f32_32x32x16_bf16 v[44:59], v[20:23], a[24:27], v[44:59]
    ds_read_b64_tr_b16 v[16:17], v222 offset:2048
    ds_read_b64_tr_b16 v[18:19], v222 offset:3072
    s_add_u32 m0, s18, 28672
    s_add_u32 s78, s80, 0
    buffer_load_dwordx4 v246, s[52:55], s78 offen offset:0  lds
    s_waitcnt lgkmcnt(4)
    v_mfma_f32_32x32x16_bf16 v[44:59], v[24:27], a[28:31], v[44:59]
    ds_read_b64_tr_b16 v[20:21], v222 offset:4096
    ds_read_b64_tr_b16 v[22:23], v222 offset:5120
    s_lshl_b32 s9, s6, 6
    v_add_u32 v215, s9, v3
    s_xor_b32 s9, s9, 64
    s_waitcnt lgkmcnt(4)
    v_mfma_f32_32x32x16_bf16 v[44:59], v[12:15], a[32:35], v[44:59]
    ds_read_b64_tr_b16 v[24:25], v222 offset:6144
    ds_read_b64_tr_b16 v[26:27], v222 offset:7168
    buffer_load_dword v11, v254, s[68:71], 0 offen offset:12 sc1
    s_waitcnt lgkmcnt(4)
    v_mfma_f32_32x32x16_bf16 v[44:59], v[16:19], a[36:39], v[44:59]
    ds_read_b64_tr_b16 v[12:13], v222 offset:8192
    ds_read_b64_tr_b16 v[14:15], v222 offset:9216
    buffer_load_dwordx4 v244, s[52:55], s78 offen offset:1024  lds
    v_add_u32 v214, s9, v3
    s_xor_b32 s9, s5, 1
    s_waitcnt lgkmcnt(4)
    v_mfma_f32_32x32x16_bf16 v[44:59], v[20:23], a[40:43], v[44:59]
    ds_read_b64_tr_b16 v[16:17], v222 offset:10240
    ds_read_b64_tr_b16 v[18:19], v222 offset:11264
    buffer_load_dwordx4 v243, s[52:55], s78 offen offset:2048  lds
    s_mul_i32 s9, s9, 4608
    s_add_u32 s9, s9, 143360
    s_waitcnt lgkmcnt(4)
    v_mfma_f32_32x32x16_bf16 v[44:59], v[24:27], a[44:47], v[44:59]
    s_waitcnt vmcnt(13)
    s_barrier
    ds_read_b64_tr_b16 v[20:21], v228 offset:57344
    ds_read_b64_tr_b16 v[22:23], v228 offset:58368
    s_waitcnt lgkmcnt(4)
    v_mfma_f32_32x32x16_bf16 v[44:59], v[12:15], a[48:51], v[44:59]
    ds_read_b64_tr_b16 v[24:25], v228 offset:59392
    ds_read_b64_tr_b16 v[26:27], v228 offset:60416
    buffer_load_dwordx4 v242, s[52:55], s78 offen offset:3072  lds
    v_add_u32 v248, s9, v252
    s_xor_b32 s9, s5, 2
    s_waitcnt lgkmcnt(4)
    s_nop 0
    v_mfma_f32_32x32x16_bf16 v[44:59], v[16:19], a[52:55], v[44:59]
    ds_read_b64_tr_b16 v[12:13], v228 offset:61440
    ds_read_b64_tr_b16 v[14:15], v228 offset:62464
    s_mul_i32 s9, s9, 4608
    s_add_u32 s9, s9, 143360
    v_add_u32 v247, s9, v252
    s_waitcnt lgkmcnt(4)
    v_mfma_f32_32x32x16_bf16 v[44:59], v[20:23], a[56:59], v[44:59]
    ds_read_b64_tr_b16 v[16:17], v228 offset:63488
    ds_read_b64_tr_b16 v[18:19], v228 offset:64512
    s_barrier
    s_waitcnt lgkmcnt(4)
    v_mfma_f32_32x32x16_bf16 v[44:59], v[24:27], a[60:63], v[44:59]
    ds_read_b64_tr_b16 v[20:21], v223 offset:0
    ds_read_b64_tr_b16 v[22:23], v223 offset:1024
    s_add_u32 m0, s18, 32768
    s_add_u32 s78, s80, 28672
    buffer_load_dwordx4 v246, s[52:55], s78 offen offset:0  lds
    s_waitcnt lgkmcnt(4)
    v_mfma_f32_32x32x16_bf16 v[44:59], v[12:15], a[64:67], v[44:59]
    ds_read_b64_tr_b16 v[24:25], v223 offset:2048
    ds_read_b64_tr_b16 v[26:27], v223 offset:3072
    s_waitcnt vmcnt(10)
    s_barrier
    s_add_u32 s77, s90, 4096
    buffer_store_dword v251, v250, s[72:75], s77 offen sc1
    s_waitcnt lgkmcnt(4)
    v_mfma_f32_32x32x16_bf16 v[44:59], v[16:19], a[68:71], v[44:59]
    ds_read_b64_tr_b16 v[12:13], v223 offset:4096
    ds_read_b64_tr_b16 v[14:15], v223 offset:5120
    buffer_load_dwordx4 v244, s[52:55], s78 offen offset:1024  lds
    buffer_load_dwordx4 v243, s[52:55], s78 offen offset:2048  lds
    s_lshl_b32 s14, s13, 1
    s_waitcnt lgkmcnt(4)
    v_mfma_f32_32x32x16_bf16 v[44:59], v[20:23], a[72:75], v[44:59]
    ds_read_b64_tr_b16 v[16:17], v223 offset:6144
    ds_read_b64_tr_b16 v[18:19], v223 offset:7168
    s_add_u32 s14, s14, s6
    s_lshl_b32 s14, s14, 5
    s_add_u32 s14, s14, s3
    s_waitcnt lgkmcnt(4)
    v_mfma_f32_32x32x16_bf16 v[44:59], v[24:27], a[76:79], v[44:59]
    ds_read_b64_tr_b16 v[20:21], v223 offset:8192
    ds_read_b64_tr_b16 v[22:23], v223 offset:9216
    s_lshl_b32 s14, s14, 11
    s_add_u32 s14, s14, 6553600
    v_lshrrev_b32 v2, 3, v1
    s_waitcnt lgkmcnt(4)
    v_mfma_f32_32x32x16_bf16 v[44:59], v[12:15], a[80:83], v[44:59]
    ds_read_b64_tr_b16 v[24:25], v223 offset:10240
    ds_read_b64_tr_b16 v[26:27], v223 offset:11264
    v_min_u32 v2, 2, v2
    s_add_u32 s8, s3, 31
    v_add_u32 v2, s8, v2
    s_waitcnt lgkmcnt(4)
    v_mfma_f32_32x32x16_bf16 v[44:59], v[16:19], a[84:87], v[44:59]
    ds_read_b64_tr_b16 v[12:13], v223 offset:12288
    ds_read_b64_tr_b16 v[14:15], v223 offset:13312
    v_and_b32 v2, 31, v2
    v_and_b32 v3, 7, v1
    v_min_u32 v3, 6, v3
    s_waitcnt lgkmcnt(4)
    v_mfma_f32_32x32x16_bf16 v[44:59], v[20:23], a[88:91], v[44:59]
    ds_read_b64_tr_b16 v[16:17], v223 offset:14336
    ds_read_b64_tr_b16 v[18:19], v223 offset:15360
    v_lshlrev_b32 v3, 2, v3
    v_lshl_add_u32 v255, v2, 7, v3
    v_bfe_u32 v2, v1, 3, 1
    s_waitcnt lgkmcnt(4)
    v_mfma_f32_32x32x16_bf16 v[44:59], v[24:27], a[92:95], v[44:59]
    ds_read_b64_tr_b16 v[20:21], v223 offset:16384
    ds_read_b64_tr_b16 v[22:23], v223 offset:17408
    v_lshl_add_u32 v253, v2, 7, v3
    s_lshl_b32 s15, s12, 1
    s_add_u32 s15, s15, s7
    s_waitcnt lgkmcnt(4)
    v_mfma_f32_32x32x16_bf16 v[44:59], v[12:15], a[96:99], v[44:59]
    ds_read_b64_tr_b16 v[24:25], v223 offset:18432
    ds_read_b64_tr_b16 v[26:27], v223 offset:19456
    s_mul_i32 s15, s15, 14336
    s_add_u32 s15, s15, 1048576
    s_waitcnt lgkmcnt(4)
    v_mfma_f32_32x32x16_bf16 v[44:59], v[16:19], a[100:103], v[44:59]
    s_waitcnt lgkmcnt(2)
    v_mfma_f32_32x32x16_bf16 v[44:59], v[20:23], a[104:107], v[44:59]
    s_waitcnt vmcnt(7)
    v_readfirstlane_b32 s77, v11
    s_nop 0
    s_cmp_lt_u32 s77, 32
    s_cbranch_scc1 L_c2_retry
L_c2_ok:
    s_waitcnt lgkmcnt(0)
    v_mfma_f32_32x32x16_bf16 v[44:59], v[24:27], a[108:111], v[44:59]
    s_barrier
    s_nop 10
    v_cvt_pk_bf16_f32 v116, v44, v45
    s_add_u32 m0, s18, 86016
    s_add_u32 s78, s81, 6029312
    buffer_load_dwordx4 v245, s[72:75], s78 offen offset:0 sc1 lds
    v_cvt_pk_bf16_f32 v117, v46, v47
    buffer_load_dwordx4 v245, s[72:75], s78 offen offset:1024 sc1 lds
    v_cvt_pk_bf16_f32 v118, v48, v49
    buffer_load_dwordx4 v245, s[72:75], s78 offen offset:2048 sc1 lds
    v_cvt_pk_bf16_f32 v119, v50, v51
    buffer_load_dwordx4 v245, s[72:75], s78 offen offset:3072 sc1 lds
    v_cvt_pk_bf16_f32 v120, v52, v53
    s_add_u32 m0, s18, 90112
    s_add_u32 s78, s81, 6033408
    buffer_load_dwordx4 v245, s[72:75], s78 offen offset:0 sc1 lds
    v_cvt_pk_bf16_f32 v121, v54, v55
    buffer_load_dwordx4 v245, s[72:75], s78 offen offset:1024 sc1 lds
    v_cvt_pk_bf16_f32 v122, v56, v57
    v_cvt_pk_bf16_f32 v123, v58, v59
    v_and_b32 v122, v122, v231
    v_and_b32 v123, v123, v231
    v_mfma_f32_32x32x16_bf16 v[44:59], a[112:115], v[116:119], 0
    s_nop 0
    v_mfma_f32_32x32x16_bf16 v[44:59], a[116:119], v[120:123], v[44:59]
    buffer_load_dwordx4 v245, s[72:75], s78 offen offset:2048 sc1 lds
    s_nop 10
    v_max3_f32 v240, v44, v45, v46
    v_max3_f32 v241, -v44, -v45, -v46
    v_max3_f32 v240, v240, v47, v48
    v_max3_f32 v241, v241, -v47, -v48
    v_max3_f32 v240, v240, v49, v50
    v_max3_f32 v241, v241, -v49, -v50
    v_max3_f32 v240, v240, v51, v52
    v_max3_f32 v241, v241, -v51, -v52
    v_max3_f32 v240, v240, v53, v54
    s_add_u32 m0, s18, 114688
    s_add_u32 s78, s82, 6029312
    buffer_load_dwordx4 v245, s[72:75], s78 offen offset:0 sc1 lds
    v_max3_f32 v241, v241, -v53, -v54
    v_max3_f32 v240, v240, v55, v56
    v_max3_f32 v241, v241, -v55, -v56
    v_max3_f32 v240, v240, v57, v58
    v_max3_f32 v241, v241, -v57, -v58
    v_max_f32_e64 v240, v240, v59
    v_max_f32_e64 v241, v241, -v59
    s_nop 1
    v_permlane32_swap_b32 v240, v241
    v_max_f32_e64 v240, v240, v241
    v_mul_f32 v240, 0xbfb8aa3b, v240
    v_mov_b32 v241, v240
    s_nop 1
    v_permlane32_swap_b32 v240, v241
    s_nop 0
    v_pk_fma_f32 v[116:117], v[44:45], s[98:99], v[240:241] op_sel:[0,0,1] op_sel_hi:[1,0,1] neg_lo:[1,0,0] neg_hi:[1,0,0]
    v_pk_fma_f32 v[44:45], v[44:45], s[98:99], v[240:241] op_sel_hi:[1,0,0]
    v_pk_fma_f32 v[118:119], v[46:47], s[98:99], v[240:241] op_sel:[0,0,1] op_sel_hi:[1,0,1] neg_lo:[1,0,0] neg_hi:[1,0,0]
    v_pk_fma_f32 v[46:47], v[46:47], s[98:99], v[240:241] op_sel_hi:[1,0,0]
    v_pk_fma_f32 v[120:121], v[48:49], s[98:99], v[240:241] op_sel:[0,0,1] op_sel_hi:[1,0,1] neg_lo:[1,0,0] neg_hi:[1,0,0]
    v_pk_fma_f32 v[48:49], v[48:49], s[98:99], v[240:241] op_sel_hi:[1,0,0]
    v_pk_fma_f32 v[122:123], v[50:51], s[98:99], v[240:241] op_sel:[0,0,1] op_sel_hi:[1,0,1] neg_lo:[1,0,0] neg_hi:[1,0,0]
    v_pk_fma_f32 v[50:51], v[50:51], s[98:99], v[240:241] op_sel_hi:[1,0,0]
    v_pk_fma_f32 v[124:125], v[52:53], s[98:99], v[240:241] op_sel:[0,0,1] op_sel_hi:[1,0,1] neg_lo:[1,0,0] neg_hi:[1,0,0]
    v_pk_fma_f32 v[52:53], v[52:53], s[98:99], v[240:241] op_sel_hi:[1,0,0]
    v_pk_fma_f32 v[126:127], v[54:55], s[98:99], v[240:241] op_sel:[0,0,1] op_sel_hi:[1,0,1] neg_lo:[1,0,0] neg_hi:[1,0,0]
    v_pk_fma_f32 v[54:55], v[54:55], s[98:99], v[240:241] op_sel_hi:[1,0,0]
    v_pk_fma_f32 v[128:129], v[56:57], s[98:99], v[240:241] op_sel:[0,0,1] op_sel_hi:[1,0,1] neg_lo:[1,0,0] neg_hi:[1,0,0]
    v_pk_fma_f32 v[56:57], v[56:57], s[98:99], v[240:241] op_sel_hi:[1,0,0]
    v_pk_fma_f32 v[130:131], v[58:59], s[98:99], v[240:241] op_sel:[0,0,1] op_sel_hi:[1,0,1] neg_lo:[1,0,0] neg_hi:[1,0,0]
    v_pk_fma_f32 v[58:59], v[58:59], s[98:99], v[240:241] op_sel_hi:[1,0,0]
    v_exp_f32 v44, v44
    v_exp_f32 v116, v116
    v_exp_f32 v45, v45
    v_exp_f32 v117, v117
    v_exp_f32 v46, v46
    v_exp_f32 v118, v118
    v_exp_f32 v47, v47
    v_exp_f32 v119, v119
    v_exp_f32 v48, v48
    v_exp_f32 v120, v120
    v_exp_f32 v49, v49
    v_exp_f32 v121, v121
    v_exp_f32 v50, v50
    v_exp_f32 v122, v122
    v_exp_f32_e64 v51, v51
    buffer_load_dwordx4 v245, s[72:75], s78 offen offset:1024 sc1 lds
    v_exp_f32 v123, v123
    v_exp_f32 v52, v52
    v_exp_f32 v124, v124
    v_exp_f32 v53, v53
    v_exp_f32 v125, v125
    v_exp_f32 v54, v54
    v_exp_f32 v126, v126
    v_exp_f32 v55, v55
    buffer_load_dwordx4 v245, s[72:75], s78 offen offset:2048 sc1 lds
    v_exp_f32 v127, v127
    v_exp_f32 v56, v56
    v_exp_f32 v128, v128
    v_exp_f32 v57, v57
    v_exp_f32 v129, v129
    v_exp_f32 v58, v58
    v_exp_f32 v130, v130
    v_exp_f32 v59, v59
    buffer_load_dwordx4 v245, s[72:75], s78 offen offset:3072 sc1 lds
    v_exp_f32_e64 v131, v131
    v_pk_add_f32 v[238:239], v[44:45], v[46:47]
    v_pk_add_f32 v[212:213], v[116:117], v[118:119]
    v_pk_add_f32 v[210:211], v[56:57], v[58:59]
    v_pk_add_f32 v[208:209], v[128:129], v[130:131]
    v_pk_add_f32 v[238:239], v[238:239], v[48:49]
    v_pk_add_f32 v[212:213], v[212:213], v[120:121]
    v_pk_add_f32 v[238:239], v[238:239], v[50:51]
    v_pk_add_f32 v[212:213], v[212:213], v[122:123]
    v_pk_add_f32 v[238:239], v[238:239], v[52:53]
    v_pk_add_f32 v[212:213], v[212:213], v[124:125]
    v_pk_add_f32 v[238:239], v[238:239], v[54:55]
    v_pk_add_f32 v[212:213], v[212:213], v[126:127]
    v_pk_fma_f32 v[238:239], v[210:211], v[232:233], v[238:239] op_sel_hi:[1,0,1]
    v_pk_fma_f32 v[212:213], v[208:209], v[232:233], v[212:213] op_sel_hi:[1,0,1]
    s_add_u32 m0, s18, 118784
    s_add_u32 s78, s82, 6033408
    buffer_load_dwordx4 v245, s[72:75], s78 offen offset:0 sc1 lds
    v_add_f32 v238, v238, v239
    v_add_f32 v212, v212, v213
    s_nop 1
    v_permlane32_swap_b32 v238, v212
    v_add_f32 v238, v238, v212
    v_rcp_f32 v238, v238
    s_nop 0
    v_mov_b32 v212, v238
    s_nop 1
    v_permlane32_swap_b32 v238, v212
    buffer_load_dwordx4 v245, s[72:75], s78 offen offset:1024 sc1 lds
    v_mul_f32 v239, v238, v232
    v_mul_f32 v213, v212, v232
    v_pk_mul_f32 v[44:45], v[44:45], v[238:239] op_sel_hi:[1,0]
    v_pk_mul_f32 v[46:47], v[46:47], v[238:239] op_sel_hi:[1,0]
    v_pk_mul_f32 v[48:49], v[48:49], v[238:239] op_sel_hi:[1,0]
    v_pk_mul_f32 v[50:51], v[50:51], v[238:239] op_sel_hi:[1,0]
    v_pk_mul_f32 v[52:53], v[52:53], v[238:239] op_sel_hi:[1,0]
    v_pk_mul_f32 v[54:55], v[54:55], v[238:239] op_sel_hi:[1,0]
    v_pk_mul_f32 v[56:57], v[56:57], v[238:239] op_sel:[0,1] op_sel_hi:[1,1]
    v_pk_mul_f32 v[58:59], v[58:59], v[238:239] op_sel:[0,1] op_sel_hi:[1,1]
    v_cvt_pk_bf16_f32 v84, v44, v45
    v_cvt_pk_bf16_f32 v85, v46, v47
    v_cvt_pk_bf16_f32 v86, v48, v49
    v_cvt_pk_bf16_f32 v87, v50, v51
    v_cvt_pk_bf16_f32 v88, v52, v53
    v_cvt_pk_bf16_f32 v89, v54, v55
    buffer_load_dwordx4 v245, s[72:75], s78 offen offset:2048 sc1 lds
    v_cvt_pk_bf16_f32 v90, v56, v57
    v_cvt_pk_bf16_f32 v91, v58, v59
    v_pk_mul_f32 v[116:117], v[116:117], v[212:213] op_sel_hi:[1,0]
    v_pk_mul_f32 v[118:119], v[118:119], v[212:213] op_sel_hi:[1,0]
    v_pk_mul_f32 v[120:121], v[120:121], v[212:213] op_sel_hi:[1,0]
    v_pk_mul_f32 v[122:123], v[122:123], v[212:213] op_sel_hi:[1,0]
    v_pk_mul_f32 v[124:125], v[124:125], v[212:213] op_sel_hi:[1,0]
    v_pk_mul_f32 v[126:127], v[126:127], v[212:213] op_sel_hi:[1,0]
    v_pk_mul_f32 v[128:129], v[128:129], v[212:213] op_sel:[0,1] op_sel_hi:[1,1]
    v_pk_mul_f32 v[130:131], v[130:131], v[212:213] op_sel:[0,1] op_sel_hi:[1,1]
    v_cvt_pk_bf16_f32 v92, v116, v117
    v_cvt_pk_bf16_f32 v93, v118, v119
    v_cvt_pk_bf16_f32 v94, v120, v121
    v_cvt_pk_bf16_f32 v95, v122, v123
    v_cvt_pk_bf16_f32 v96, v124, v125
    v_cvt_pk_bf16_f32 v97, v126, v127
    v_cvt_pk_bf16_f32 v98, v128, v129
    s_add_u32 m0, s18, 57344
    s_add_u32 s78, s81, 5111808
    buffer_load_dwordx4 v245, s[72:75], s78 offen offset:0 sc1 lds
    v_cvt_pk_bf16_f32 v99, v130, v131
    s_mov_b32 s77, 8192
    buffer_load_dword v241, v255, s[72:75], s77 offen sc1
    ds_write_b128 v217, v[84:87] offset:0
    ds_write_b128 v217, v[88:91] offset:16
    ds_write_b128 v217, v[92:95] offset:64
    ds_write_b128 v217, v[96:99] offset:80
    s_waitcnt vmcnt(9)
    s_barrier
    ds_read_b64_tr_b16 v[12:13], v223 offset:20480
    ds_read_b64_tr_b16 v[14:15], v223 offset:21504
    ds_read_b64_tr_b16 v[16:17], v223 offset:22528
    ds_read_b64_tr_b16 v[18:19], v223 offset:23552
    ds_read_b64_tr_b16 v[20:21], v223 offset:24576
    ds_read_b64_tr_b16 v[22:23], v223 offset:25600
    s_waitcnt lgkmcnt(4)
    s_nop 0
    v_mfma_f32_32x32x16_bf16 v[100:115], a[0:3], v[12:15], 0
    ds_read_b64_tr_b16 v[24:25], v223 offset:26624
    ds_read_b64_tr_b16 v[26:27], v223 offset:27648
    buffer_load_dwordx4 v245, s[72:75], s78 offen offset:1024 sc1 lds
    buffer_load_dwordx4 v245, s[72:75], s78 offen offset:2048 sc1 lds
    buffer_load_dwordx4 v245, s[72:75], s78 offen offset:3072 sc1 lds
    s_waitcnt lgkmcnt(4)
    s_nop 0
    v_mfma_f32_32x32x16_bf16 v[100:115], a[4:7], v[16:19], v[100:115]
    ds_read_b64_tr_b16 v[12:13], v223 offset:28672
    ds_read_b64_tr_b16 v[14:15], v223 offset:29696
    s_add_u32 m0, s18, 61440
    s_add_u32 s78, s81, 5115904
    buffer_load_dwordx4 v245, s[72:75], s78 offen offset:0 sc1 lds
    s_waitcnt lgkmcnt(4)
    v_mfma_f32_32x32x16_bf16 v[100:115], a[8:11], v[20:23], v[100:115]
    ds_read_b64_tr_b16 v[16:17], v223 offset:30720
    ds_read_b64_tr_b16 v[18:19], v223 offset:31744
    s_lshr_b32 s88, s3, 3
    s_lshl_b32 s88, s88, 2
    s_and_b32 s87, s3, 3
    s_waitcnt lgkmcnt(4)
    v_mfma_f32_32x32x16_bf16 v[100:115], a[12:15], v[24:27], v[100:115]
    ds_read_b64_tr_b16 v[20:21], v223 offset:32768
    ds_read_b64_tr_b16 v[22:23], v223 offset:33792
    buffer_load_dwordx4 v245, s[72:75], s78 offen offset:1024 sc1 lds
    s_add_u32 s88, s88, s87
    s_bfe_u32 s87, s3, 0x10002
    s_waitcnt lgkmcnt(4)
    v_mfma_f32_32x32x16_bf16 v[100:115], a[16:19], v[12:15], v[100:115]
    ds_read_b64_tr_b16 v[24:25], v223 offset:34816
    ds_read_b64_tr_b16 v[26:27], v223 offset:35840
    s_mul_i32 s87, s87, 7
    s_add_u32 s87, s87, s4
    s_lshl_b32 s92, s88, 0
    s_waitcnt lgkmcnt(4)
    v_mfma_f32_32x32x16_bf16 v[100:115], a[20:23], v[16:19], v[100:115]
    ds_read_b64_tr_b16 v[12:13], v223 offset:36864
    ds_read_b64_tr_b16 v[14:15], v223 offset:37888
    buffer_load_dwordx4 v245, s[72:75], s78 offen offset:2048 sc1 lds
    s_add_u32 s92, s92, s87
    s_and_b32 s92, s92, 3
    s_waitcnt lgkmcnt(4)
    v_mfma_f32_32x32x16_bf16 v[100:115], a[24:27], v[20:23], v[100:115]
    ds_read_b64_tr_b16 v[16:17], v223 offset:38912
    ds_read_b64_tr_b16 v[18:19], v223 offset:39936
    s_lshl_b32 s8, s88, 8
    v_add_u32 v253, s8, v253
    s_waitcnt lgkmcnt(4)
    v_mfma_f32_32x32x16_bf16 v[100:115], a[28:31], v[24:27], v[100:115]
    ds_read_b64_tr_b16 v[20:21], v223 offset:40960
    ds_read_b64_tr_b16 v[22:23], v223 offset:41984
    s_waitcnt lgkmcnt(4)
    v_mfma_f32_32x32x16_bf16 v[100:115], a[32:35], v[12:15], v[100:115]
    ds_read_b64_tr_b16 v[24:25], v223 offset:43008
    ds_read_b64_tr_b16 v[26:27], v223 offset:44032
    s_waitcnt lgkmcnt(4)
    v_mfma_f32_32x32x16_bf16 v[100:115], a[36:39], v[16:19], v[100:115]
    ds_read_b64_tr_b16 v[12:13], v223 offset:45056
    ds_read_b64_tr_b16 v[14:15], v223 offset:46080
    s_waitcnt vmcnt(6)
    v_cmp_eq_u32 vcc, v241, v251
    s_nop 0
    s_cmp_eq_u64 vcc, -1
    s_cbranch_scc0 L_spin0
L_pok0:
    s_waitcnt lgkmcnt(4)
    s_nop 0
    v_mfma_f32_32x32x16_bf16 v[100:115], a[40:43], v[20:23], v[100:115]
    ds_read_b64_tr_b16 v[16:17], v223 offset:47104
    ds_read_b64_tr_b16 v[18:19], v223 offset:48128
    buffer_load_dwordx4 a[144:147], v252, s[72:75], s15 offen offset:0 sc1
    buffer_load_dwordx4 a[148:151], v252, s[72:75], s15 offen offset:1024 sc1
    s_waitcnt lgkmcnt(4)
    v_mfma_f32_32x32x16_bf16 v[100:115], a[44:47], v[24:27], v[100:115]
    s_barrier
    ds_read_b64_tr_b16 v[20:21], v223 offset:49152
    ds_read_b64_tr_b16 v[22:23], v223 offset:50176
    s_waitcnt lgkmcnt(4)
    s_nop 0
    v_mfma_f32_32x32x16_bf16 v[100:115], a[48:51], v[12:15], v[100:115]
    ds_read_b64_tr_b16 v[24:25], v223 offset:51200
    ds_read_b64_tr_b16 v[26:27], v223 offset:52224
    buffer_load_dwordx4 a[152:155], v252, s[72:75], s15 offen offset:2048 sc1
    buffer_load_dwordx4 a[156:159], v252, s[72:75], s15 offen offset:3072 sc1
    s_waitcnt lgkmcnt(4)
    v_mfma_f32_32x32x16_bf16 v[100:115], a[52:55], v[16:19], v[100:115]
    ds_read_b64_tr_b16 v[12:13], v223 offset:53248
    ds_read_b64_tr_b16 v[14:15], v223 offset:54272
    s_waitcnt lgkmcnt(4)
    v_mfma_f32_32x32x16_bf16 v[100:115], a[56:59], v[20:23], v[100:115]
    ds_read_b64_tr_b16 v[16:17], v223 offset:55296
    ds_read_b64_tr_b16 v[18:19], v223 offset:56320
    s_barrier
    s_waitcnt lgkmcnt(4)
    v_mfma_f32_32x32x16_bf16 v[100:115], a[60:63], v[24:27], v[100:115]
    ds_read_b64_tr_b16 v[20:21], v223 offset:57344
    ds_read_b64_tr_b16 v[22:23], v223 offset:58368
    s_add_u32 s15, s15, 4096
    buffer_load_dwordx4 a[160:163], v252, s[72:75], s15 offen offset:0 sc1
    s_waitcnt lgkmcnt(4)
    v_mfma_f32_32x32x16_bf16 v[100:115], a[64:67], v[12:15], v[100:115]
    ds_read_b64_tr_b16 v[24:25], v223 offset:59392
    ds_read_b64_tr_b16 v[26:27], v223 offset:60416
    buffer_load_dwordx4 a[164:167], v252, s[72:75], s15 offen offset:1024 sc1
    s_waitcnt lgkmcnt(4)
    v_mfma_f32_32x32x16_bf16 v[100:115], a[68:71], v[16:19], v[100:115]
    ds_read_b64_tr_b16 v[12:13], v223 offset:61440
    ds_read_b64_tr_b16 v[14:15], v223 offset:62464
    buffer_load_dwordx4 a[168:171], v252, s[72:75], s15 offen offset:2048 sc1
    buffer_load_dwordx4 a[172:175], v252, s[72:75], s15 offen offset:3072 sc1
    s_waitcnt lgkmcnt(4)
    v_mfma_f32_32x32x16_bf16 v[100:115], a[72:75], v[20:23], v[100:115]
    ds_read_b64_tr_b16 v[16:17], v223 offset:63488
    ds_read_b64_tr_b16 v[18:19], v223 offset:64512
    s_waitcnt lgkmcnt(4)
    v_mfma_f32_32x32x16_bf16 v[100:115], a[76:79], v[24:27], v[100:115]
    ds_read_b64_tr_b16 v[20:21], v222 offset:0
    ds_read_b64_tr_b16 v[22:23], v222 offset:1024
    s_waitcnt lgkmcnt(4)
    s_nop 0
    v_mfma_f32_32x32x16_bf16 v[100:115], a[80:83], v[12:15], v[100:115]
    ds_read_b64_tr_b16 v[24:25], v222 offset:2048
    ds_read_b64_tr_b16 v[26:27], v222 offset:3072
    s_add_u32 s15, s15, 4096
    buffer_load_dwordx4 a[176:179], v252, s[72:75], s15 offen offset:0 sc1
    s_waitcnt lgkmcnt(4)
    v_mfma_f32_32x32x16_bf16 v[100:115], a[84:87], v[16:19], v[100:115]
    ds_read_b64_tr_b16 v[12:13], v222 offset:4096
    ds_read_b64_tr_b16 v[14:15], v222 offset:5120
    s_waitcnt lgkmcnt(4)
    v_mfma_f32_32x32x16_bf16 v[100:115], a[88:91], v[20:23], v[100:115]
    ds_read_b64_tr_b16 v[16:17], v222 offset:6144
    ds_read_b64_tr_b16 v[18:19], v222 offset:7168
    buffer_load_dwordx4 a[180:183], v252, s[72:75], s15 offen offset:1024 sc1
    s_waitcnt lgkmcnt(4)
    v_mfma_f32_32x32x16_bf16 v[100:115], a[92:95], v[24:27], v[100:115]
    ds_read_b64_tr_b16 v[20:21], v222 offset:8192
    ds_read_b64_tr_b16 v[22:23], v222 offset:9216
    s_waitcnt lgkmcnt(4)
    v_mfma_f32_32x32x16_bf16 v[100:115], a[96:99], v[12:15], v[100:115]
    ds_read_b64_tr_b16 v[24:25], v222 offset:10240
    ds_read_b64_tr_b16 v[26:27], v222 offset:11264
    s_waitcnt lgkmcnt(4)
    s_nop 0
    v_mfma_f32_32x32x16_bf16 v[100:115], a[100:103], v[16:19], v[100:115]
    ds_read_b64_tr_b16 v[84:85], v214 offset:0
    ds_read_b64_tr_b16 v[86:87], v214 offset:1152
    ds_read_b64_tr_b16 v[88:89], v214 offset:2304
    ds_read_b64_tr_b16 v[90:91], v214 offset:3456
    s_waitcnt lgkmcnt(6)
    s_nop 0
    v_mfma_f32_32x32x16_bf16 v[100:115], a[104:107], v[20:23], v[100:115]
    ds_read_b64_tr_b16 v[92:93], v215 offset:0
    ds_read_b64_tr_b16 v[94:95], v215 offset:1152
    ds_read_b64_tr_b16 v[96:97], v215 offset:2304
    ds_read_b64_tr_b16 v[98:99], v215 offset:3456
    s_waitcnt lgkmcnt(8)
    s_nop 0
    v_mfma_f32_32x32x16_bf16 v[100:115], a[108:111], v[24:27], v[100:115]
    buffer_load_dwordx4 a[184:187], v252, s[72:75], s15 offen offset:2048 sc1
    buffer_load_dwordx4 a[188:191], v252, s[72:75], s15 offen offset:3072 sc1
    s_add_u32 s15, s15, 4096
    buffer_load_dwordx4 a[192:195], v252, s[72:75], s15 offen offset:0 sc1
    buffer_load_dwordx4 a[196:199], v252, s[72:75], s15 offen offset:1024 sc1
    s_lshl_b32 s8, s87, 8
    s_mul_i32 s83, s5, 200704
    s_add_u32 s83, s83, s8
    v_lshrrev_b32_e64 v2, 3, v1
    v_mul_u32_u24 v2, 2688, v2
    v_add_u32_e64 v237, v246, v2
    v_add_u32 v236, 27648, v237
    v_add_u32 v235, 55296, v237
    v_add_u32 v234, 82944, v237
    s_cmp_eq_u32 s7, s91
    s_mov_b32 s17, 28672
    s_cselect_b32 s17, 0, s17
    v_add_u32 v241, s17, v230
    v_add_u32 v240, s17, v229
    ds_read_b64_tr_b16 v[12:13], v241 offset:0
    ds_read_b64_tr_b16 v[14:15], v241 offset:1024
    ds_read_b64_tr_b16 v[16:17], v240 offset:0
    ds_read_b64_tr_b16 v[18:19], v240 offset:1024
    ds_read_b64_tr_b16 v[20:21], v241 offset:2048
    ds_read_b64_tr_b16 v[22:23], v241 offset:3072
    ds_read_b64_tr_b16 v[24:25], v240 offset:2048
    ds_read_b64_tr_b16 v[26:27], v240 offset:3072
    s_waitcnt vmcnt(13) lgkmcnt(4)
    s_nop 0
    v_mfma_f32_32x32x16_bf16 v[124:139], v[12:15], a[144:147], 0
    ds_read_b64_tr_b16 v[28:29], v241 offset:4096
    ds_read_b64_tr_b16 v[30:31], v241 offset:5120
    s_add_u32 m0, s18, 86016
    s_add_u32 s78, s82, 5111808
    buffer_load_dwordx4 v245, s[72:75], s78 offen offset:0 sc1 lds
    v_mfma_f32_32x32x16_bf16 v[44:59], v[16:19], a[144:147], 0
    ds_read_b64_tr_b16 v[32:33], v240 offset:4096
    ds_read_b64_tr_b16 v[34:35], v240 offset:5120
    v_lshlrev_b32_e64 v140, 16, v60
    v_and_b32 v141, 0xffff0000, v60
    buffer_load_dwordx4 v245, s[72:75], s78 offen offset:1024 sc1 lds
    s_waitcnt vmcnt(14) lgkmcnt(4)
    v_mfma_f32_32x32x16_bf16 v[124:139], v[20:23], a[148:151], v[124:139]
    ds_read_b64_tr_b16 v[12:13], v241 offset:6144
    ds_read_b64_tr_b16 v[14:15], v241 offset:7168
    s_barrier
    v_mfma_f32_32x32x16_bf16 v[44:59], v[24:27], a[148:151], v[44:59]
    ds_read_b64_tr_b16 v[16:17], v240 offset:6144
    ds_read_b64_tr_b16 v[18:19], v240 offset:7168
    buffer_load_dwordx4 v245, s[72:75], s78 offen offset:2048 sc1 lds
    v_lshlrev_b32_e64 v142, 16, v61
    v_and_b32 v143, 0xffff0000, v61
    s_waitcnt vmcnt(14) lgkmcnt(4)
    s_nop 0
    v_mfma_f32_32x32x16_bf16 v[124:139], v[28:31], a[152:155], v[124:139]
    ds_read_b64_tr_b16 v[20:21], v241 offset:8192
    ds_read_b64_tr_b16 v[22:23], v241 offset:9216
    v_mfma_f32_32x32x16_bf16 v[44:59], v[32:35], a[152:155], v[44:59]
    ds_read_b64_tr_b16 v[24:25], v240 offset:8192
    ds_read_b64_tr_b16 v[26:27], v240 offset:9216
    buffer_load_dwordx4 v245, s[72:75], s78 offen offset:3072 sc1 lds
    v_lshlrev_b32_e64 v144, 16, v62
    v_and_b32 v145, 0xffff0000, v62
    s_waitcnt vmcnt(14) lgkmcnt(4)
    s_nop 0
    v_mfma_f32_32x32x16_bf16 v[124:139], v[12:15], a[156:159], v[124:139]
    ds_read_b64_tr_b16 v[28:29], v241 offset:10240
    ds_read_b64_tr_b16 v[30:31], v241 offset:11264
    v_mfma_f32_32x32x16_bf16 v[44:59], v[16:19], a[156:159], v[44:59]
    ds_read_b64_tr_b16 v[32:33], v240 offset:10240
    ds_read_b64_tr_b16 v[34:35], v240 offset:11264
    s_add_u32 m0, s18, 90112
    s_add_u32 s78, s82, 5115904
    buffer_load_dwordx4 v245, s[72:75], s78 offen offset:0 sc1 lds
    s_waitcnt vmcnt(14) lgkmcnt(4)
    s_nop 0
    v_mfma_f32_32x32x16_bf16 v[124:139], v[20:23], a[160:163], v[124:139]
    ds_read_b64_tr_b16 v[12:13], v241 offset:12288
    ds_read_b64_tr_b16 v[14:15], v241 offset:13312
    v_mfma_f32_32x32x16_bf16 v[44:59], v[24:27], a[160:163], v[44:59]
    ds_read_b64_tr_b16 v[16:17], v240 offset:12288
    ds_read_b64_tr_b16 v[18:19], v240 offset:13312
    v_lshlrev_b32_e64 v146, 16, v63
    buffer_load_dwordx4 v245, s[72:75], s78 offen offset:1024 sc1 lds
    v_and_b32 v147, 0xffff0000, v63
    s_waitcnt vmcnt(14) lgkmcnt(4)
    s_nop 0
    v_mfma_f32_32x32x16_bf16 v[124:139], v[28:31], a[164:167], v[124:139]
    ds_read_b64_tr_b16 v[20:21], v241 offset:14336
    ds_read_b64_tr_b16 v[22:23], v241 offset:15360
    v_mfma_f32_32x32x16_bf16 v[44:59], v[32:35], a[164:167], v[44:59]
    ds_read_b64_tr_b16 v[24:25], v240 offset:14336
    ds_read_b64_tr_b16 v[26:27], v240 offset:15360
    v_lshlrev_b32_e64 v148, 16, v64
    buffer_load_dwordx4 v245, s[72:75], s78 offen offset:2048 sc1 lds
    v_and_b32 v149, 0xffff0000, v64
    s_waitcnt vmcnt(14) lgkmcnt(4)
    s_nop 0
    v_mfma_f32_32x32x16_bf16 v[124:139], v[12:15], a[168:171], v[124:139]
    ds_read_b64_tr_b16 v[28:29], v241 offset:16384
    ds_read_b64_tr_b16 v[30:31], v241 offset:17408
    v_mfma_f32_32x32x16_bf16 v[44:59], v[16:19], a[168:171], v[44:59]
    ds_read_b64_tr_b16 v[32:33], v240 offset:16384
    ds_read_b64_tr_b16 v[34:35], v240 offset:17408
    v_lshlrev_b32_e64 v150, 16, v65
    v_and_b32 v151, 0xffff0000, v65
    v_lshlrev_b32 v152, 16, v66
    s_waitcnt vmcnt(13) lgkmcnt(4)
    v_mfma_f32_32x32x16_bf16 v[124:139], v[20:23], a[172:175], v[124:139]
    ds_read_b64_tr_b16 v[12:13], v241 offset:18432
    ds_read_b64_tr_b16 v[14:15], v241 offset:19456
    v_mfma_f32_32x32x16_bf16 v[44:59], v[24:27], a[172:175], v[44:59]
    ds_read_b64_tr_b16 v[16:17], v240 offset:18432
    ds_read_b64_tr_b16 v[18:19], v240 offset:19456
    v_and_b32 v153, 0xffff0000, v66
    v_lshlrev_b32_e64 v154, 16, v67
    v_and_b32 v155, 0xffff0000, v67
    s_waitcnt vmcnt(12) lgkmcnt(4)
    v_mfma_f32_32x32x16_bf16 v[124:139], v[28:31], a[176:179], v[124:139]
    ds_read_b64_tr_b16 v[20:21], v241 offset:20480
    ds_read_b64_tr_b16 v[22:23], v241 offset:21504
    s_add_u32 m0, s18, 114688
    s_add_u32 s19, s84, 0
    buffer_load_dwordx4 v246, s[60:63], s19 offen offset:0  lds
    v_mfma_f32_32x32x16_bf16 v[44:59], v[32:35], a[176:179], v[44:59]
    ds_read_b64_tr_b16 v[24:25], v240 offset:20480
    ds_read_b64_tr_b16 v[26:27], v240 offset:21504
    v_mov_b32 v8, 0
    v_mov_b32 v9, 0
    v_mov_b32 v10, 0
    s_waitcnt vmcnt(12) lgkmcnt(4)
    v_mfma_f32_32x32x16_bf16 v[124:139], v[12:15], a[180:183], v[124:139]
    ds_read_b64_tr_b16 v[28:29], v241 offset:22528
    ds_read_b64_tr_b16 v[30:31], v241 offset:23552
    buffer_load_dwordx4 v244, s[60:63], s19 offen offset:1024  lds
    v_mfma_f32_32x32x16_bf16 v[44:59], v[16:19], a[180:183], v[44:59]
    ds_read_b64_tr_b16 v[32:33], v240 offset:22528
    ds_read_b64_tr_b16 v[34:35], v240 offset:23552
    v_mov_b32 v11, 0
    s_mul_i32 s8, s12, 14
    s_add_u32 s8, s8, s13
    s_waitcnt vmcnt(12) lgkmcnt(4)
    v_mfma_f32_32x32x16_bf16 v[124:139], v[20:23], a[184:187], v[124:139]
    ds_read_b64_tr_b16 v[12:13], v241 offset:24576
    ds_read_b64_tr_b16 v[14:15], v241 offset:25600
    v_mfma_f32_32x32x16_bf16 v[44:59], v[24:27], a[184:187], v[44:59]
    ds_read_b64_tr_b16 v[16:17], v240 offset:24576
    ds_read_b64_tr_b16 v[18:19], v240 offset:25600
    s_lshl_b32 s10, s8, 11
    s_add_u32 s10, s10, 2883584
    s_lshl_b32 s11, s8, 8
    s_waitcnt vmcnt(11) lgkmcnt(4)
    s_nop 0
    v_mfma_f32_32x32x16_bf16 v[124:139], v[28:31], a[188:191], v[124:139]
    ds_read_b64_tr_b16 v[20:21], v241 offset:26624
    ds_read_b64_tr_b16 v[22:23], v241 offset:27648
    buffer_load_dwordx4 v243, s[60:63], s19 offen offset:2048  lds
    v_mfma_f32_32x32x16_bf16 v[44:59], v[32:35], a[188:191], v[44:59]
    ds_read_b64_tr_b16 v[24:25], v240 offset:26624
    ds_read_b64_tr_b16 v[26:27], v240 offset:27648
    s_add_u32 s11, s11, 4718592
    v_lshlrev_b32_e64 v2, 3, v1
    v_mov_b32 v3, 0x7fffff00
    s_waitcnt vmcnt(11) lgkmcnt(4)
    s_nop 0
    v_mfma_f32_32x32x16_bf16 v[124:139], v[12:15], a[192:195], v[124:139]
    buffer_load_dwordx4 v242, s[60:63], s19 offen offset:3072  lds
    v_mfma_f32_32x32x16_bf16 v[44:59], v[16:19], a[192:195], v[44:59]
    v_cndmask_b32 v2, v2, v3, s[94:95]
    v_cvt_pk_bf16_f32 v116, v100, v101
    v_cvt_pk_bf16_f32 v117, v102, v103
    v_cvt_pk_bf16_f32 v118, v104, v105
    v_cvt_pk_bf16_f32 v119, v106, v107
    s_waitcnt vmcnt(11) lgkmcnt(0)
    s_nop 0
    v_mfma_f32_32x32x16_bf16 v[124:139], v[20:23], a[196:199], v[124:139]
    s_add_u32 m0, s18, 118784
    s_add_u32 s19, s84, 28672
    buffer_load_dwordx4 v246, s[60:63], s19 offen offset:0  lds
    v_mfma_f32_32x32x16_bf16 v[44:59], v[24:27], a[196:199], v[44:59]
    v_cvt_pk_bf16_f32 v120, v108, v109
    v_cvt_pk_bf16_f32 v121, v110, v111
    v_cvt_pk_bf16_f32 v122, v112, v113
    v_cvt_pk_bf16_f32 v123, v114, v115
    v_cndmask_b32 v116, v116, v80, s[96:97]
    v_cndmask_b32 v117, v117, v80, s[96:97]
    v_cndmask_b32 v118, v118, v80, s[96:97]
    v_cndmask_b32 v119, v119, v80, s[96:97]
    v_cndmask_b32 v120, v120, v80, s[96:97]
    v_cndmask_b32 v121, v121, v80, s[96:97]
    v_cndmask_b32 v122, v122, v80, s[96:97]
    v_cndmask_b32 v123, v123, v80, s[96:97]
    ds_write_b128 v249, v[44:47] offset:0
    ds_write_b128 v249, v[48:51] offset:1024
    ds_write_b128 v249, v[52:55] offset:2048
    ds_write_b128 v249, v[56:59] offset:3072
    v_pk_add_f32 v[124:125], v[124:125], v[140:141]
    v_pk_add_f32 v[126:127], v[126:127], v[142:143]
    v_pk_add_f32 v[128:129], v[128:129], v[144:145]
    v_pk_add_f32 v[130:131], v[130:131], v[146:147]
    v_pk_add_f32 v[132:133], v[132:133], v[148:149]
    v_pk_add_f32 v[134:135], v[134:135], v[150:151]
    v_pk_add_f32 v[136:137], v[136:137], v[152:153]
    v_pk_add_f32 v[138:139], v[138:139], v[154:155]
    s_waitcnt lgkmcnt(0)
    s_barrier
    ds_read_b128 v[44:47], v247 offset:0
    ds_read_b128 v[48:51], v247 offset:1024
    ds_read_b128 v[52:55], v247 offset:2048
    ds_read_b128 v[56:59], v247 offset:3072
    s_add_u32 m0, s18, 0
    s_add_u32 s78, s83, 0
    buffer_load_dwordx4 v237, s[56:59], s78 offen offset:0  lds
    buffer_load_dwordx4 v236, s[56:59], s78 offen offset:1024  lds
    s_waitcnt lgkmcnt(3)
    v_pk_add_f32 v[124:125], v[124:125], v[44:45]
    v_pk_add_f32 v[126:127], v[126:127], v[46:47]
    v_cvt_pk_bf16_f32 v156, v124, v125
    v_cvt_pk_bf16_f32 v157, v126, v127
    s_waitcnt lgkmcnt(2)
    v_pk_add_f32 v[128:129], v[128:129], v[48:49]
    v_pk_add_f32 v[130:131], v[130:131], v[50:51]
    v_cvt_pk_bf16_f32 v158, v128, v129
    v_cvt_pk_bf16_f32 v159, v130, v131
    buffer_store_dwordx4 v[156:159], v252, s[72:75], s10 offen offset:0 sc1
    s_waitcnt lgkmcnt(1)
    v_pk_add_f32 v[132:133], v[132:133], v[52:53]
    v_pk_add_f32 v[134:135], v[134:135], v[54:55]
    v_cvt_pk_bf16_f32 v160, v132, v133
    v_cvt_pk_bf16_f32 v161, v134, v135
    s_waitcnt lgkmcnt(0)
    v_pk_add_f32 v[136:137], v[136:137], v[56:57]
    v_pk_add_f32 v[138:139], v[138:139], v[58:59]
    v_cvt_pk_bf16_f32 v162, v136, v137
    v_cvt_pk_bf16_f32 v163, v138, v139
    buffer_store_dwordx4 v[160:163], v252, s[72:75], s10 offen offset:1024 sc1
    v_dot2c_f32_bf16 v8, v156, v80
    v_dot2c_f32_bf16 v9, v156, v156
    v_dot2c_f32_bf16 v10, v157, v80
    v_dot2c_f32_bf16 v11, v157, v157
    v_dot2c_f32_bf16 v8, v158, v80
    v_dot2c_f32_bf16 v9, v158, v158
    v_dot2c_f32_bf16 v10, v159, v80
    v_dot2c_f32_bf16 v11, v159, v159
    v_dot2c_f32_bf16 v8, v160, v80
    v_dot2c_f32_bf16 v9, v160, v160
    v_dot2c_f32_bf16 v10, v161, v80
    v_dot2c_f32_bf16 v11, v161, v161
    v_dot2c_f32_bf16 v8, v162, v80
    v_dot2c_f32_bf16 v9, v162, v162
    v_dot2c_f32_bf16 v10, v163, v80
    v_dot2c_f32_bf16 v11, v163, v163
    s_nop 2
    v_pk_add_f32 v[8:9], v[8:9], v[10:11]
    v_mov_b32 v10, v8
    v_mov_b32 v11, v9
    s_nop 0
    v_permlane32_swap_b32 v8, v10
    v_permlane32_swap_b32 v9, v11
    v_pk_add_f32 v[8:9], v[8:9], v[10:11]
    buffer_store_dwordx2 v[8:9], v2, s[72:75], s11 offen sc1
    v_mfma_f32_32x32x16_bf16 v[100:115], v[84:87], v[116:119], 0
    buffer_load_dwordx4 v235, s[56:59], s78 offen offset:2048  lds
    buffer_load_dwordx4 v234, s[56:59], s78 offen offset:3072  lds
    s_add_u32 m0, s18, 4096
    s_add_u32 s78, s83, 114688
    buffer_load_dwordx4 v237, s[56:59], s78 offen offset:0  lds
    v_mfma_f32_32x32x16_bf16 v[100:115], v[88:91], v[120:123], v[100:115]
    buffer_load_dwordx4 v236, s[56:59], s78 offen offset:1024  lds
    buffer_load_dwordx4 v235, s[56:59], s78 offen offset:2048  lds
    s_add_u32 m0, s18, 28672
    s_add_u32 s78, s83, 802816
    buffer_load_dwordx4 v237, s[56:59], s78 offen offset:0  lds
    v_mfma_f32_32x32x16_bf16 v[44:59], v[92:95], v[116:119], 0
    s_waitcnt vmcnt(14)
    s_nop 0
    ds_read_b64_tr_b16 a[120:121], v219 offset:49152
    ds_read_b64_tr_b16 a[122:123], v219 offset:50176
    ds_read_b64_tr_b16 a[124:125], v218 offset:49152
    ds_read_b64_tr_b16 a[126:127], v218 offset:50176
    v_mfma_f32_32x32x16_bf16 v[44:59], v[96:99], v[120:123], v[44:59]
    s_waitcnt vmcnt(12)
    ds_read_b64_tr_b16 a[128:129], v219 offset:51200
    ds_read_b64_tr_b16 a[130:131], v219 offset:52224
    ds_read_b64_tr_b16 a[132:133], v218 offset:51200
    ds_read_b64_tr_b16 a[134:135], v218 offset:52224
    s_barrier
    ds_write_b128 v249, v[100:103] offset:0
    ds_write_b128 v249, v[104:107] offset:1024
    ds_write_b128 v249, v[108:111] offset:2048
    ds_write_b128 v249, v[112:115] offset:3072
    s_waitcnt lgkmcnt(0)
    s_barrier
    ds_read_b128 v[100:103], v248 offset:0
    ds_read_b128 v[104:107], v248 offset:1024
    ds_read_b128 v[108:111], v248 offset:2048
    ds_read_b128 v[112:115], v248 offset:3072
    s_waitcnt lgkmcnt(3)
    s_nop 0
    v_pk_add_f32 v[44:45], v[44:45], v[100:101]
    buffer_load_dwordx4 v236, s[56:59], s78 offen offset:1024  lds
    v_pk_add_f32 v[46:47], v[46:47], v[102:103]
    buffer_load_dwordx4 v235, s[56:59], s78 offen offset:2048  lds
    v_cvt_pk_bf16_f32 v116, v44, v45
    buffer_load_dwordx4 v234, s[56:59], s78 offen offset:3072  lds
    v_cvt_pk_bf16_f32 v117, v46, v47
    s_waitcnt lgkmcnt(2)
    v_pk_add_f32 v[48:49], v[48:49], v[104:105]
    v_pk_add_f32 v[50:51], v[50:51], v[106:107]
    v_cvt_pk_bf16_f32 v118, v48, v49
    v_cvt_pk_bf16_f32 v119, v50, v51
    s_waitcnt lgkmcnt(1)
    v_pk_add_f32 v[52:53], v[52:53], v[108:109]
    v_pk_add_f32 v[54:55], v[54:55], v[110:111]
    v_cvt_pk_bf16_f32 v120, v52, v53
    v_cvt_pk_bf16_f32 v121, v54, v55
    s_waitcnt lgkmcnt(0)
    s_nop 0
    v_pk_add_f32 v[56:57], v[56:57], v[112:113]
    s_add_u32 m0, s18, 32768
    s_add_u32 s78, s83, 917504
    buffer_load_dwordx4 v237, s[56:59], s78 offen offset:0  lds
    v_pk_add_f32 v[58:59], v[58:59], v[114:115]
    v_cvt_pk_bf16_f32 v122, v56, v57
    v_cvt_pk_bf16_f32 v123, v58, v59
    s_waitcnt vmcnt(10)
    s_barrier
    s_add_u32 s77, s90, 12288
    buffer_store_dword v251, v250, s[72:75], s77 offen sc1
    buffer_store_dwordx4 v[116:119], v252, s[72:75], s14 offen offset:0 sc1
    buffer_store_dwordx4 v[120:123], v252, s[72:75], s14 offen offset:1024 sc1
    ds_read_b64_tr_b16 v[12:13], v228 offset:57344
    ds_read_b64_tr_b16 v[14:15], v228 offset:58368
    ds_read_b64_tr_b16 v[16:17], v228 offset:59392
    ds_read_b64_tr_b16 v[18:19], v228 offset:60416
    ds_read_b64_tr_b16 v[20:21], v228 offset:61440
    ds_read_b64_tr_b16 v[22:23], v228 offset:62464
    s_waitcnt lgkmcnt(4)
    s_nop 0
    v_mfma_f32_32x32x16_bf16 v[44:59], v[12:15], a[0:3], 0
    ds_read_b64_tr_b16 v[24:25], v228 offset:63488
    ds_read_b64_tr_b16 v[26:27], v228 offset:64512
    buffer_load_dwordx4 v236, s[56:59], s78 offen offset:1024  lds
    buffer_load_dwordx4 v235, s[56:59], s78 offen offset:2048  lds
    v_and_b32 v2, 3, v226
    s_waitcnt lgkmcnt(4)
    v_mfma_f32_32x32x16_bf16 v[44:59], v[16:19], a[4:7], v[44:59]
    ds_read_b64_tr_b16 v[12:13], v223 offset:0
    ds_read_b64_tr_b16 v[14:15], v223 offset:1024
    v_lshlrev_b32_e64 v2, 6, v2
    v_lshl_add_u32 v3, v226, 8, v227
    v_add_u32 v241, v2, v3
    s_waitcnt lgkmcnt(4)
    v_mfma_f32_32x32x16_bf16 v[44:59], v[20:23], a[8:11], v[44:59]
    ds_read_b64_tr_b16 v[16:17], v223 offset:2048
    ds_read_b64_tr_b16 v[18:19], v223 offset:3072
    v_xor_b32_e64 v240, 64, v241
    v_xor_b32 v239, 128, v241
    v_xor_b32 v238, 192, v241
    s_waitcnt lgkmcnt(4)
    v_mfma_f32_32x32x16_bf16 v[44:59], v[24:27], a[12:15], v[44:59]
    ds_read_b64_tr_b16 v[20:21], v223 offset:4096
    ds_read_b64_tr_b16 v[22:23], v223 offset:5120
    s_lshl_b32 s10, s88, 2
    s_add_u32 s10, s10, s5
    s_mul_i32 s14, s10, 28672
    s_waitcnt lgkmcnt(4)
    v_mfma_f32_32x32x16_bf16 v[44:59], v[12:15], a[16:19], v[44:59]
    ds_read_b64_tr_b16 v[24:25], v223 offset:6144
    ds_read_b64_tr_b16 v[26:27], v223 offset:7168
    s_add_u32 s14, s14, 2883584
    s_add_u32 s15, s14, 28672
    s_mul_i32 s8, s92, 7168
    s_waitcnt lgkmcnt(4)
    v_mfma_f32_32x32x16_bf16 v[44:59], v[16:19], a[20:23], v[44:59]
    ds_read_b64_tr_b16 v[12:13], v223 offset:8192
    ds_read_b64_tr_b16 v[14:15], v223 offset:9216
    s_add_u32 s14, s14, s8
    s_mul_i32 s8, s10, 3584
    s_add_u32 s8, s8, 4718592
    s_waitcnt lgkmcnt(4)
    v_mfma_f32_32x32x16_bf16 v[44:59], v[20:23], a[24:27], v[44:59]
    ds_read_b64_tr_b16 v[16:17], v223 offset:10240
    ds_read_b64_tr_b16 v[18:19], v223 offset:11264
    v_mov_b32 v3, s13
    v_mov_b32_e64 v4, s87
    v_cndmask_b32 v3, v3, v4, s[94:95]
    s_waitcnt lgkmcnt(4)
    v_mfma_f32_32x32x16_bf16 v[44:59], v[24:27], a[28:31], v[44:59]
    ds_read_b64_tr_b16 v[20:21], v223 offset:12288
    ds_read_b64_tr_b16 v[22:23], v223 offset:13312
    v_and_b32 v4, 1, v1
    v_lshl_add_u32 v3, v3, 1, v4
    v_lshlrev_b32 v3, 7, v3
    s_waitcnt lgkmcnt(4)
    v_mfma_f32_32x32x16_bf16 v[44:59], v[12:15], a[32:35], v[44:59]
    ds_read_b64_tr_b16 v[24:25], v223 offset:14336
    ds_read_b64_tr_b16 v[26:27], v223 offset:15360
    v_add_u32 v255, 28, v3
    v_mov_b32 v3, s87
    v_lshl_add_u32 v3, v3, 1, v4
    s_waitcnt lgkmcnt(4)
    v_mfma_f32_32x32x16_bf16 v[44:59], v[16:19], a[36:39], v[44:59]
    ds_read_b64_tr_b16 v[12:13], v223 offset:16384
    ds_read_b64_tr_b16 v[14:15], v223 offset:17408
    v_lshlrev_b32 v3, 7, v3
    v_add_u32 v3, 16412, v3
    v_mov_b32 v248, v3
    s_waitcnt lgkmcnt(4)
    v_mfma_f32_32x32x16_bf16 v[44:59], v[20:23], a[40:43], v[44:59]
    ds_read_b64_tr_b16 v[16:17], v223 offset:18432
    ds_read_b64_tr_b16 v[18:19], v223 offset:19456
    v_mov_b32_e64 v3, s13
    v_lshl_add_u32 v3, v3, 1, v4
    v_lshlrev_b32 v3, 7, v3
    s_waitcnt lgkmcnt(4)
    v_mfma_f32_32x32x16_bf16 v[44:59], v[24:27], a[44:47], v[44:59]
    ds_read_b64_tr_b16 v[20:21], v223 offset:20480
    ds_read_b64_tr_b16 v[22:23], v223 offset:21504
    v_add_u32 v255, 28, v3
    v_lshlrev_b32 v2, 3, v225
    v_lshrrev_b32 v3, 5, v1
    s_waitcnt lgkmcnt(4)
    v_mfma_f32_32x32x16_bf16 v[44:59], v[12:15], a[48:51], v[44:59]
    ds_read_b64_tr_b16 v[24:25], v223 offset:22528
    ds_read_b64_tr_b16 v[26:27], v223 offset:23552
    v_mul_u32_u24 v4, 1792, v3
    v_add_u32_e64 v2, v2, v4
    v_add_u32 v217, 65536, v241
    s_waitcnt lgkmcnt(4)
    v_mfma_f32_32x32x16_bf16 v[44:59], v[16:19], a[52:55], v[44:59]
    ds_read_b64_tr_b16 v[12:13], v223 offset:24576
    ds_read_b64_tr_b16 v[14:15], v223 offset:25600
    s_waitcnt vmcnt(2)
    s_barrier
    s_lshl_b32 s77, s4, 5
    s_add_u32 s77, s77, s3
    s_lshl_b32 s77, s77, 7
    s_add_u32 s77, s77, 65536
    buffer_store_dword v251, v250, s[72:75], s77 offen sc1
    s_waitcnt lgkmcnt(4)
    v_mfma_f32_32x32x16_bf16 v[44:59], v[20:23], a[56:59], v[44:59]
    ds_read_b64_tr_b16 v[16:17], v223 offset:26624
    ds_read_b64_tr_b16 v[18:19], v223 offset:27648
    s_barrier
    s_waitcnt lgkmcnt(4)
    s_nop 0
    v_mfma_f32_32x32x16_bf16 v[44:59], v[24:27], a[60:63], v[44:59]
    ds_read_b64_tr_b16 v[20:21], v223 offset:28672
    ds_read_b64_tr_b16 v[22:23], v223 offset:29696
    s_add_u32 m0, s18, 57344
    s_add_u32 s78, s83, 128
    buffer_load_dwordx4 v237, s[56:59], s78 offen offset:0  lds
    s_waitcnt lgkmcnt(4)
    s_nop 0
    v_mfma_f32_32x32x16_bf16 v[44:59], v[12:15], a[64:67], v[44:59]
    ds_read_b64_tr_b16 v[24:25], v223 offset:30720
    ds_read_b64_tr_b16 v[26:27], v223 offset:31744
    buffer_load_dwordx4 v236, s[56:59], s78 offen offset:1024  lds
    buffer_load_dwordx4 v235, s[56:59], s78 offen offset:2048  lds
    buffer_load_dwordx4 v234, s[56:59], s78 offen offset:3072  lds
    s_waitcnt lgkmcnt(4)
    s_nop 0
    v_mfma_f32_32x32x16_bf16 v[44:59], v[16:19], a[68:71], v[44:59]
    ds_read_b64_tr_b16 v[12:13], v223 offset:32768
    ds_read_b64_tr_b16 v[14:15], v223 offset:33792
    s_add_u32 m0, s18, 61440
    s_add_u32 s78, s83, 114816
    buffer_load_dwordx4 v237, s[56:59], s78 offen offset:0  lds
    s_waitcnt lgkmcnt(4)
    s_nop 0
    v_mfma_f32_32x32x16_bf16 v[44:59], v[20:23], a[72:75], v[44:59]
    ds_read_b64_tr_b16 v[16:17], v223 offset:34816
    ds_read_b64_tr_b16 v[18:19], v223 offset:35840
    buffer_load_dwordx4 v236, s[56:59], s78 offen offset:1024  lds
    buffer_load_dwordx4 v235, s[56:59], s78 offen offset:2048  lds
    v_add_u32 v216, 65536, v240
    s_waitcnt lgkmcnt(4)
    s_nop 0
    v_mfma_f32_32x32x16_bf16 v[44:59], v[24:27], a[76:79], v[44:59]
    ds_read_b64_tr_b16 v[20:21], v223 offset:36864
    ds_read_b64_tr_b16 v[22:23], v223 offset:37888
    v_add_u32 v215, 65536, v239
    v_add_u32 v214, 65536, v238
    s_waitcnt lgkmcnt(4)
    v_mfma_f32_32x32x16_bf16 v[44:59], v[12:15], a[80:83], v[44:59]
    ds_read_b64_tr_b16 v[24:25], v223 offset:38912
    ds_read_b64_tr_b16 v[26:27], v223 offset:39936
    s_add_u32 m0, s18, 113664
    s_nop 0
    buffer_load_dwordx4 v244, s[60:63], s19 offen offset:1024  lds
    s_waitcnt lgkmcnt(4)
    v_mfma_f32_32x32x16_bf16 v[44:59], v[16:19], a[84:87], v[44:59]
    ds_read_b64_tr_b16 v[12:13], v223 offset:40960
    ds_read_b64_tr_b16 v[14:15], v223 offset:41984
    s_waitcnt lgkmcnt(4)
    v_mfma_f32_32x32x16_bf16 v[44:59], v[20:23], a[88:91], v[44:59]
    ds_read_b64_tr_b16 v[16:17], v223 offset:43008
    ds_read_b64_tr_b16 v[18:19], v223 offset:44032
    s_waitcnt lgkmcnt(4)
    v_mfma_f32_32x32x16_bf16 v[44:59], v[24:27], a[92:95], v[44:59]
    ds_read_b64_tr_b16 v[20:21], v223 offset:45056
    ds_read_b64_tr_b16 v[22:23], v223 offset:46080
    s_waitcnt lgkmcnt(4)
    v_mfma_f32_32x32x16_bf16 v[44:59], v[12:15], a[96:99], v[44:59]
    ds_read_b64_tr_b16 v[24:25], v223 offset:47104
    ds_read_b64_tr_b16 v[26:27], v223 offset:48128
    s_waitcnt lgkmcnt(4)
    v_mfma_f32_32x32x16_bf16 v[44:59], v[16:19], a[100:103], v[44:59]
    s_waitcnt lgkmcnt(2)
    v_mfma_f32_32x32x16_bf16 v[44:59], v[20:23], a[104:107], v[44:59]
    s_waitcnt lgkmcnt(0)
    v_mfma_f32_32x32x16_bf16 v[44:59], v[24:27], a[108:111], v[44:59]
    s_barrier
    s_nop 10
    s_nop 0
    v_cvt_pk_bf16_f32 v60, v44, v45
    v_cvt_pk_bf16_f32 v61, v46, v47
    v_cvt_pk_bf16_f32 v62, v48, v49
    v_cvt_pk_bf16_f32 v63, v50, v51
    v_cvt_pk_bf16_f32 v64, v52, v53
    v_cvt_pk_bf16_f32 v65, v54, v55
    v_cvt_pk_bf16_f32 v66, v56, v57
    v_cvt_pk_bf16_f32 v67, v58, v59
    v_and_b32 v66, v66, v231
    v_and_b32 v67, v67, v231
    v_mfma_f32_32x32x16_bf16 v[44:59], a[112:115], v[60:63], 0
    s_add_u32 m0, s18, 86016
    s_add_u32 s78, s83, 802944
    buffer_load_dwordx4 v237, s[56:59], s78 offen offset:0  lds
    v_mfma_f32_32x32x16_bf16 v[44:59], a[116:119], v[64:67], v[44:59]
    s_nop 11
    s_nop 0
    v_max3_f32 v222, v44, v45, v46
    buffer_load_dwordx4 v236, s[56:59], s78 offen offset:1024  lds
    v_max3_f32 v223, -v44, -v45, -v46
    v_max3_f32 v222, v222, v47, v48
    v_max3_f32 v223, v223, -v47, -v48
    v_max3_f32 v222, v222, v49, v50
    v_max3_f32 v223, v223, -v49, -v50
    v_max3_f32 v222, v222, v51, v52
    v_max3_f32 v223, v223, -v51, -v52
    v_max3_f32 v222, v222, v53, v54
    v_max3_f32 v223, v223, -v53, -v54
    v_max3_f32 v222, v222, v55, v56
    v_max3_f32 v223, v223, -v55, -v56
    v_max3_f32 v222, v222, v57, v58
    v_max3_f32 v223, v223, -v57, -v58
    v_max_f32_e64 v222, v222, v59
    v_max_f32_e64 v223, v223, -v59
    s_nop 1
    v_permlane32_swap_b32 v222, v223
    buffer_load_dwordx4 v235, s[56:59], s78 offen offset:2048  lds
    v_max_f32_e64 v222, v222, v223
    v_mul_f32 v222, 0xbfb8aa3b, v222
    v_mov_b32 v223, v222
    s_nop 1
    v_permlane32_swap_b32 v222, v223
    s_nop 0
    s_mov_b32 s77, 16384
    buffer_load_dword v228, v253, s[72:75], s77 offen sc1
    v_pk_fma_f32 v[132:133], v[44:45], s[98:99], v[222:223] op_sel:[0,0,1] op_sel_hi:[1,0,1] neg_lo:[1,0,0] neg_hi:[1,0,0]
    buffer_load_dwordx4 v234, s[56:59], s78 offen offset:3072  lds
    v_pk_fma_f32 v[44:45], v[44:45], s[98:99], v[222:223] op_sel_hi:[1,0,0]
    v_pk_fma_f32 v[134:135], v[46:47], s[98:99], v[222:223] op_sel:[0,0,1] op_sel_hi:[1,0,1] neg_lo:[1,0,0] neg_hi:[1,0,0]
    v_pk_fma_f32 v[46:47], v[46:47], s[98:99], v[222:223] op_sel_hi:[1,0,0]
    v_pk_fma_f32 v[136:137], v[48:49], s[98:99], v[222:223] op_sel:[0,0,1] op_sel_hi:[1,0,1] neg_lo:[1,0,0] neg_hi:[1,0,0]
    v_pk_fma_f32 v[48:49], v[48:49], s[98:99], v[222:223] op_sel_hi:[1,0,0]
    v_pk_fma_f32 v[138:139], v[50:51], s[98:99], v[222:223] op_sel:[0,0,1] op_sel_hi:[1,0,1] neg_lo:[1,0,0] neg_hi:[1,0,0]
    v_pk_fma_f32 v[50:51], v[50:51], s[98:99], v[222:223] op_sel_hi:[1,0,0]
    v_pk_fma_f32 v[140:141], v[52:53], s[98:99], v[222:223] op_sel:[0,0,1] op_sel_hi:[1,0,1] neg_lo:[1,0,0] neg_hi:[1,0,0]
    v_pk_fma_f32 v[52:53], v[52:53], s[98:99], v[222:223] op_sel_hi:[1,0,0]
    v_pk_fma_f32 v[142:143], v[54:55], s[98:99], v[222:223] op_sel:[0,0,1] op_sel_hi:[1,0,1] neg_lo:[1,0,0] neg_hi:[1,0,0]
    v_pk_fma_f32 v[54:55], v[54:55], s[98:99], v[222:223] op_sel_hi:[1,0,0]
    v_pk_fma_f32 v[144:145], v[56:57], s[98:99], v[222:223] op_sel:[0,0,1] op_sel_hi:[1,0,1] neg_lo:[1,0,0] neg_hi:[1,0,0]
    v_pk_fma_f32 v[56:57], v[56:57], s[98:99], v[222:223] op_sel_hi:[1,0,0]
    v_pk_fma_f32 v[146:147], v[58:59], s[98:99], v[222:223] op_sel:[0,0,1] op_sel_hi:[1,0,1] neg_lo:[1,0,0] neg_hi:[1,0,0]
    v_pk_fma_f32 v[58:59], v[58:59], s[98:99], v[222:223] op_sel_hi:[1,0,0]
    v_exp_f32_e64 v44, v44
    s_add_u32 m0, s18, 90112
    s_add_u32 s78, s83, 917632
    buffer_load_dwordx4 v237, s[56:59], s78 offen offset:0  lds
    v_exp_f32 v132, v132
    v_exp_f32 v45, v45
    v_exp_f32 v133, v133
    v_exp_f32 v46, v46
    v_exp_f32 v134, v134
    v_exp_f32 v47, v47
    v_exp_f32_e64 v135, v135
    buffer_load_dwordx4 v236, s[56:59], s78 offen offset:1024  lds
    v_exp_f32 v48, v48
    v_exp_f32 v136, v136
    v_exp_f32 v49, v49
    v_exp_f32 v137, v137
    v_exp_f32 v50, v50
    v_exp_f32 v138, v138
    v_exp_f32 v51, v51
    v_exp_f32 v139, v139
    v_exp_f32_e64 v52, v52
    buffer_load_dwordx4 v235, s[56:59], s78 offen offset:2048  lds
    v_exp_f32 v140, v140
    v_exp_f32 v53, v53
    v_exp_f32 v141, v141
    v_exp_f32 v54, v54
    v_exp_f32 v142, v142
    v_exp_f32 v55, v55
    v_exp_f32 v143, v143
    v_exp_f32 v56, v56
    s_add_u32 m0, s18, 113664
    s_nop 0
    buffer_load_dwordx4 v243, s[60:63], s19 offen offset:2048  lds
    v_exp_f32 v144, v144
    v_exp_f32 v57, v57
    v_exp_f32 v145, v145
    v_exp_f32 v58, v58
    v_exp_f32 v146, v146
    v_exp_f32 v59, v59
    v_exp_f32 v147, v147
    buffer_load_dwordx4 v242, s[60:63], s19 offen offset:3072  lds
    v_pk_add_f32 v[212:213], v[44:45], v[46:47]
    v_pk_add_f32 v[210:211], v[132:133], v[134:135]
    v_pk_add_f32 v[208:209], v[56:57], v[58:59]
    v_pk_add_f32 v[206:207], v[144:145], v[146:147]
    v_pk_add_f32 v[212:213], v[212:213], v[48:49]
    v_pk_add_f32 v[210:211], v[210:211], v[136:137]
    v_pk_add_f32 v[212:213], v[212:213], v[50:51]
    v_pk_add_f32 v[210:211], v[210:211], v[138:139]
    v_pk_add_f32 v[212:213], v[212:213], v[52:53]
    v_pk_add_f32 v[210:211], v[210:211], v[140:141]
    v_pk_add_f32 v[212:213], v[212:213], v[54:55]
    v_pk_add_f32 v[210:211], v[210:211], v[142:143]
    s_waitcnt vmcnt(10)
    s_nop 0
    ds_read_b64_tr_b16 a[136:137], v219 offset:53248
    ds_read_b64_tr_b16 a[138:139], v219 offset:49152
    ds_read_b64_tr_b16 a[140:141], v218 offset:53248
    ds_read_b64_tr_b16 a[142:143], v218 offset:49152
    s_add_u32 s84, s84, 114688
    s_cmp_ge_u32 s84, s86
    s_cselect_b32 s89, 401408, 0
    s_sub_u32 s84, s84, s89
    s_add_u32 m0, s18, 117760
    s_add_u32 s19, s84, 0
    buffer_load_dwordx4 v246, s[60:63], s19 offen offset:0  lds
    v_pk_fma_f32 v[212:213], v[208:209], v[232:233], v[212:213] op_sel_hi:[1,0,1]
    v_pk_fma_f32 v[210:211], v[206:207], v[232:233], v[210:211] op_sel_hi:[1,0,1]
    v_add_f32 v212, v212, v213
    v_add_f32 v210, v210, v211
    s_nop 1
    v_permlane32_swap_b32 v212, v210
    v_add_f32 v212, v212, v210
    v_rcp_f32_e64 v212, v212
    s_add_u32 m0, s18, 118784
    s_nop 0
    buffer_load_dwordx4 v244, s[60:63], s19 offen offset:1024  lds
    v_mov_b32 v210, v212
    s_nop 1
    v_permlane32_swap_b32 v212, v210
    v_mul_f32 v213, v212, v232
    v_mul_f32 v211, v210, v232
    s_waitcnt vmcnt(8)
    v_cmp_eq_u32 vcc, v228, v251
    s_nop 0
    s_cmp_eq_u64 vcc, -1
    s_cbranch_scc0 L_spin1
L_pok1:
    s_nop 0
    s_sub_u32 s15, s15, 28672
    buffer_load_dwordx4 a[144:147], v252, s[72:75], s15 offen offset:0 sc1
    buffer_load_dwordx4 a[148:151], v252, s[72:75], s15 offen offset:1024 sc1
    buffer_load_dwordx4 a[152:155], v252, s[72:75], s15 offen offset:2048 sc1
    buffer_load_dwordx4 a[156:159], v252, s[72:75], s15 offen offset:3072 sc1
    s_add_u32 s15, s15, 4096
    buffer_load_dwordx4 a[160:163], v252, s[72:75], s15 offen offset:0 sc1
    buffer_load_dwordx4 a[164:167], v252, s[72:75], s15 offen offset:1024 sc1
    buffer_load_dwordx4 a[168:171], v252, s[72:75], s15 offen offset:2048 sc1
    buffer_load_dwordx4 a[172:175], v252, s[72:75], s15 offen offset:3072 sc1
    v_pk_mul_f32 v[44:45], v[44:45], v[212:213] op_sel_hi:[1,0]
    v_pk_mul_f32 v[46:47], v[46:47], v[212:213] op_sel_hi:[1,0]
    v_pk_mul_f32 v[48:49], v[48:49], v[212:213] op_sel_hi:[1,0]
    v_pk_mul_f32 v[50:51], v[50:51], v[212:213] op_sel_hi:[1,0]
    v_pk_mul_f32 v[52:53], v[52:53], v[212:213] op_sel_hi:[1,0]
    v_pk_mul_f32 v[54:55], v[54:55], v[212:213] op_sel_hi:[1,0]
    v_pk_mul_f32 v[56:57], v[56:57], v[212:213] op_sel:[0,1] op_sel_hi:[1,1]
    v_pk_mul_f32 v[58:59], v[58:59], v[212:213] op_sel:[0,1] op_sel_hi:[1,1]
    v_cvt_pk_bf16_f32 v84, v44, v45
    v_cvt_pk_bf16_f32 v85, v46, v47
    v_cvt_pk_bf16_f32 v86, v48, v49
    v_cvt_pk_bf16_f32 v87, v50, v51
    v_cvt_pk_bf16_f32 v88, v52, v53
    v_cvt_pk_bf16_f32 v89, v54, v55
    v_cvt_pk_bf16_f32 v90, v56, v57
    v_cvt_pk_bf16_f32 v91, v58, v59
    v_pk_mul_f32 v[132:133], v[132:133], v[210:211] op_sel_hi:[1,0]
    s_add_u32 s15, s15, 4096
    buffer_load_dwordx4 a[176:179], v252, s[72:75], s15 offen offset:0 sc1
    v_pk_mul_f32 v[134:135], v[134:135], v[210:211] op_sel_hi:[1,0]
    v_pk_mul_f32 v[136:137], v[136:137], v[210:211] op_sel_hi:[1,0]
    v_pk_mul_f32 v[138:139], v[138:139], v[210:211] op_sel_hi:[1,0]
    v_pk_mul_f32 v[140:141], v[140:141], v[210:211] op_sel_hi:[1,0]
    v_pk_mul_f32 v[142:143], v[142:143], v[210:211] op_sel_hi:[1,0]
    v_pk_mul_f32 v[144:145], v[144:145], v[210:211] op_sel:[0,1] op_sel_hi:[1,1]
    v_pk_mul_f32 v[146:147], v[146:147], v[210:211] op_sel:[0,1] op_sel_hi:[1,1]
    v_cvt_pk_bf16_f32 v92, v132, v133
    v_cvt_pk_bf16_f32 v93, v134, v135
    v_cvt_pk_bf16_f32 v94, v136, v137
    v_cvt_pk_bf16_f32 v95, v138, v139
    v_cvt_pk_bf16_f32 v96, v140, v141
    v_cvt_pk_bf16_f32 v97, v142, v143
    v_cvt_pk_bf16_f32 v98, v144, v145
    v_cvt_pk_bf16_f32 v99, v146, v147
    buffer_load_dwordx4 a[180:183], v252, s[72:75], s15 offen offset:1024 sc1
    s_lshl_b32 s16, s87, 2
    s_add_u32 s16, s16, s7
    s_xor_b32 s14, s16, 1
    s_lshl_b32 s16, s16, 10
    s_lshl_b32 s14, s14, 10
    s_nop 0
    s_add_u32 s16, s16, 4980736
    s_add_u32 s14, s14, 4980736
    v_add_u32 v240, 65536, v229
    buffer_load_dwordx2 v[132:133], v2, s[72:75], s8 offen offset:0 sc1
    buffer_load_dwordx2 v[134:135], v2, s[72:75], s8 offen offset:256 sc1
    buffer_load_dwordx2 v[136:137], v2, s[72:75], s8 offen offset:512 sc1
    buffer_load_dwordx2 v[138:139], v2, s[72:75], s8 offen offset:768 sc1
    buffer_load_dwordx2 v[140:141], v2, s[72:75], s8 offen offset:1024 sc1
    buffer_load_dwordx2 v[142:143], v2, s[72:75], s8 offen offset:1280 sc1
    buffer_load_dwordx2 v[144:145], v2, s[72:75], s8 offen offset:1536 sc1
    ds_read_b64_tr_b16 v[12:13], v230 offset:0
    ds_read_b64_tr_b16 v[14:15], v230 offset:1024
    ds_read_b64_tr_b16 v[16:17], v229 offset:0
    ds_read_b64_tr_b16 v[18:19], v229 offset:1024
    ds_read_b64_tr_b16 v[20:21], v230 offset:2048
    ds_read_b64_tr_b16 v[22:23], v230 offset:3072
    ds_read_b64_tr_b16 v[24:25], v229 offset:2048
    ds_read_b64_tr_b16 v[26:27], v229 offset:3072
    ds_read_b64_tr_b16 v[28:29], v230 offset:4096
    ds_read_b64_tr_b16 v[30:31], v230 offset:5120
    ds_read_b64_tr_b16 v[32:33], v229 offset:4096
    ds_read_b64_tr_b16 v[34:35], v229 offset:5120
    s_waitcnt vmcnt(16) lgkmcnt(8)
    s_nop 0
    v_mfma_f32_32x32x16_bf16 v[44:59], v[12:15], a[144:147], 0
    ds_read_b64_tr_b16 v[36:37], v230 offset:6144
    ds_read_b64_tr_b16 v[38:39], v230 offset:7168
    buffer_load_dwordx4 a[184:187], v252, s[72:75], s15 offen offset:2048 sc1
    ds_read_b64_tr_b16 a[0:1], v219 offset:50176
    ds_read_b64_tr_b16 a[2:3], v219 offset:51200
    buffer_load_dwordx4 v243, s[60:63], s19 offen offset:2048  lds
    v_mfma_f32_32x32x16_bf16 v[100:115], v[16:19], a[144:147], 0
    ds_read_b64_tr_b16 v[40:41], v229 offset:6144
    ds_read_b64_tr_b16 v[42:43], v229 offset:7168
    ds_read_b64_tr_b16 a[4:5], v218 offset:50176
    ds_read_b64_tr_b16 a[6:7], v218 offset:51200
    s_waitcnt vmcnt(17) lgkmcnt(12)
    s_nop 0
    v_mfma_f32_32x32x16_bf16 v[44:59], v[20:23], a[148:151], v[44:59]
    ds_read_b64_tr_b16 v[12:13], v230 offset:8192
    ds_read_b64_tr_b16 v[14:15], v230 offset:9216
    buffer_load_dwordx4 a[188:191], v252, s[72:75], s15 offen offset:3072 sc1
    v_mfma_f32_32x32x16_bf16 v[100:115], v[24:27], a[148:151], v[100:115]
    ds_read_b64_tr_b16 v[16:17], v229 offset:8192
    ds_read_b64_tr_b16 v[18:19], v229 offset:9216
    ds_read_b64_tr_b16 a[8:9], v219 offset:52224
    ds_read_b64_tr_b16 a[10:11], v219 offset:54272
    s_waitcnt vmcnt(17) lgkmcnt(14)
    v_mfma_f32_32x32x16_bf16 v[44:59], v[28:31], a[152:155], v[44:59]
    s_barrier
    ds_read_b64_tr_b16 v[20:21], v230 offset:57344
    ds_read_b64_tr_b16 v[22:23], v230 offset:58368
    s_add_u32 s15, s15, 4096
    buffer_load_dwordx4 a[192:195], v252, s[72:75], s15 offen offset:0 sc1
    v_mfma_f32_32x32x16_bf16 v[100:115], v[32:35], a[152:155], v[100:115]
    ds_read_b64_tr_b16 v[24:25], v229 offset:57344
    ds_read_b64_tr_b16 v[26:27], v229 offset:58368
    ds_read_b64_tr_b16 a[12:13], v218 offset:52224
    ds_read_b64_tr_b16 a[14:15], v218 offset:54272
    s_waitcnt vmcnt(17) lgkmcnt(14)
    s_nop 0
    v_mfma_f32_32x32x16_bf16 v[44:59], v[36:39], a[156:159], v[44:59]
    ds_read_b64_tr_b16 v[28:29], v230 offset:10240
    ds_read_b64_tr_b16 v[30:31], v230 offset:11264
    buffer_load_dwordx4 a[196:199], v252, s[72:75], s15 offen offset:1024 sc1
    v_mfma_f32_32x32x16_bf16 v[100:115], v[40:43], a[156:159], v[100:115]
    ds_read_b64_tr_b16 v[32:33], v229 offset:10240
    ds_read_b64_tr_b16 v[34:35], v229 offset:11264
    s_waitcnt vmcnt(17) lgkmcnt(12)
    s_nop 0
    v_mfma_f32_32x32x16_bf16 v[44:59], v[12:15], a[160:163], v[44:59]
    ds_read_b64_tr_b16 v[36:37], v230 offset:12288
    ds_read_b64_tr_b16 v[38:39], v230 offset:13312
    buffer_load_dwordx4 a[200:203], v252, s[72:75], s15 offen offset:2048 sc1
    v_mfma_f32_32x32x16_bf16 v[100:115], v[16:19], a[160:163], v[100:115]
    ds_read_b64_tr_b16 v[40:41], v229 offset:12288
    ds_read_b64_tr_b16 v[42:43], v229 offset:13312
    s_waitcnt lgkmcnt(10)
    s_nop 0
    v_mfma_f32_32x32x16_bf16 v[180:195], v[20:23], a[144:147], 0
    ds_read_b64_tr_b16 v[12:13], v230 offset:14336
    ds_read_b64_tr_b16 v[14:15], v230 offset:15360
    buffer_load_dwordx4 a[204:207], v252, s[72:75], s15 offen offset:3072 sc1
    v_mfma_f32_32x32x16_bf16 v[196:211], v[24:27], a[144:147], 0
    ds_read_b64_tr_b16 v[16:17], v229 offset:14336
    ds_read_b64_tr_b16 v[18:19], v229 offset:15360
    s_waitcnt vmcnt(18) lgkmcnt(8)
    s_nop 0
    v_mfma_f32_32x32x16_bf16 v[44:59], v[28:31], a[164:167], v[44:59]
    ds_read_b64_tr_b16 v[20:21], v230 offset:16384
    ds_read_b64_tr_b16 v[22:23], v230 offset:17408
    s_mov_b32 s77, 16384
    buffer_load_dword v239, v248, s[72:75], s77 offen sc1
    v_mfma_f32_32x32x16_bf16 v[100:115], v[32:35], a[164:167], v[100:115]
    ds_read_b64_tr_b16 v[24:25], v229 offset:16384
    ds_read_b64_tr_b16 v[26:27], v229 offset:17408
    s_add_u32 s15, s15, 4096
    buffer_load_dwordx4 a[208:211], v252, s[72:75], s15 offen offset:0 sc1
    s_waitcnt vmcnt(19) lgkmcnt(8)
    s_nop 0
    v_mfma_f32_32x32x16_bf16 v[44:59], v[36:39], a[168:171], v[44:59]
    ds_read_b64_tr_b16 v[28:29], v230 offset:18432
    ds_read_b64_tr_b16 v[30:31], v230 offset:19456
    buffer_load_dwordx4 a[212:215], v252, s[72:75], s15 offen offset:1024 sc1
    v_mfma_f32_32x32x16_bf16 v[100:115], v[40:43], a[168:171], v[100:115]
    ds_read_b64_tr_b16 v[32:33], v229 offset:18432
    ds_read_b64_tr_b16 v[34:35], v229 offset:19456
    s_waitcnt vmcnt(19) lgkmcnt(8)
    s_nop 0
    v_mfma_f32_32x32x16_bf16 v[44:59], v[12:15], a[172:175], v[44:59]
    ds_read_b64_tr_b16 v[36:37], v230 offset:59392
    ds_read_b64_tr_b16 v[38:39], v230 offset:60416
    buffer_load_dwordx4 a[216:219], v252, s[72:75], s15 offen offset:2048 sc1
    v_mfma_f32_32x32x16_bf16 v[100:115], v[16:19], a[172:175], v[100:115]
    ds_read_b64_tr_b16 v[40:41], v229 offset:59392
    ds_read_b64_tr_b16 v[42:43], v229 offset:60416
    s_waitcnt vmcnt(19) lgkmcnt(8)
    s_nop 0
    v_mfma_f32_32x32x16_bf16 v[44:59], v[20:23], a[176:179], v[44:59]
    ds_read_b64_tr_b16 v[12:13], v230 offset:20480
    ds_read_b64_tr_b16 v[14:15], v230 offset:21504
    buffer_load_dwordx4 a[220:223], v252, s[72:75], s15 offen offset:3072 sc1
    v_mfma_f32_32x32x16_bf16 v[100:115], v[24:27], a[176:179], v[100:115]
    ds_read_b64_tr_b16 v[16:17], v229 offset:20480
    ds_read_b64_tr_b16 v[18:19], v229 offset:21504
    s_waitcnt vmcnt(19) lgkmcnt(8)
    s_nop 0
    v_mfma_f32_32x32x16_bf16 v[44:59], v[28:31], a[180:183], v[44:59]
    ds_read_b64_tr_b16 v[20:21], v230 offset:22528
    ds_read_b64_tr_b16 v[22:23], v230 offset:23552
    s_add_u32 s15, s15, 4096
    buffer_load_dwordx4 a[224:227], v252, s[72:75], s15 offen offset:0 sc1
    v_mfma_f32_32x32x16_bf16 v[100:115], v[32:35], a[180:183], v[100:115]
    ds_read_b64_tr_b16 v[24:25], v229 offset:22528
    ds_read_b64_tr_b16 v[26:27], v229 offset:23552
    s_waitcnt lgkmcnt(8)
    s_nop 0
    v_mfma_f32_32x32x16_bf16 v[180:195], v[36:39], a[148:151], v[180:195]
    ds_read_b64_tr_b16 v[28:29], v230 offset:24576
    ds_read_b64_tr_b16 v[30:31], v230 offset:25600
    v_mfma_f32_32x32x16_bf16 v[196:211], v[40:43], a[148:151], v[196:211]
    ds_read_b64_tr_b16 v[32:33], v229 offset:24576
    ds_read_b64_tr_b16 v[34:35], v229 offset:25600
    buffer_load_dwordx4 a[228:231], v252, s[72:75], s15 offen offset:1024 sc1
    s_waitcnt vmcnt(14)
    v_add_f32 v132, v132, v134
    s_waitcnt vmcnt(13) lgkmcnt(8)
    s_nop 0
    v_mfma_f32_32x32x16_bf16 v[44:59], v[12:15], a[184:187], v[44:59]
    ds_read_b64_tr_b16 v[36:37], v230 offset:26624
    ds_read_b64_tr_b16 v[38:39], v230 offset:27648
    buffer_load_dwordx4 a[232:235], v252, s[72:75], s15 offen offset:2048 sc1
    v_mfma_f32_32x32x16_bf16 v[100:115], v[16:19], a[184:187], v[100:115]
    ds_read_b64_tr_b16 v[40:41], v229 offset:26624
    ds_read_b64_tr_b16 v[42:43], v229 offset:27648
    v_add_f32 v133, v133, v135
    v_add_f32 v132, v132, v136
    v_add_f32 v133, v133, v137
    s_waitcnt vmcnt(12) lgkmcnt(8)
    v_mfma_f32_32x32x16_bf16 v[44:59], v[20:23], a[188:191], v[44:59]
    ds_read_b64_tr_b16 v[12:13], v230 offset:61440
    ds_read_b64_tr_b16 v[14:15], v230 offset:62464
    buffer_load_dwordx4 a[236:239], v252, s[72:75], s15 offen offset:3072 sc1
    v_mfma_f32_32x32x16_bf16 v[100:115], v[24:27], a[188:191], v[100:115]
    ds_read_b64_tr_b16 v[16:17], v229 offset:61440
    ds_read_b64_tr_b16 v[18:19], v229 offset:62464
    v_add_f32 v132, v132, v138
    v_add_f32 v133, v133, v139
    v_add_f32 v132, v132, v140
    s_waitcnt vmcnt(12) lgkmcnt(8)
    v_mfma_f32_32x32x16_bf16 v[44:59], v[28:31], a[192:195], v[44:59]
    ds_read_b64_tr_b16 v[20:21], v230 offset:28672
    ds_read_b64_tr_b16 v[22:23], v230 offset:29696
    s_add_u32 s15, s15, 4096
    buffer_load_dwordx4 a[240:243], v252, s[72:75], s15 offen offset:0 sc1
    v_mfma_f32_32x32x16_bf16 v[100:115], v[32:35], a[192:195], v[100:115]
    ds_read_b64_tr_b16 v[24:25], v229 offset:28672
    ds_read_b64_tr_b16 v[26:27], v229 offset:29696
    v_add_f32 v133, v133, v141
    v_add_f32 v132, v132, v142
    v_add_f32 v133, v133, v143
    s_waitcnt vmcnt(12) lgkmcnt(8)
    v_mfma_f32_32x32x16_bf16 v[44:59], v[36:39], a[196:199], v[44:59]
    ds_read_b64_tr_b16 v[28:29], v230 offset:30720
    ds_read_b64_tr_b16 v[30:31], v230 offset:31744
    buffer_load_dwordx4 a[244:247], v252, s[72:75], s15 offen offset:1024 sc1
    v_mfma_f32_32x32x16_bf16 v[100:115], v[40:43], a[196:199], v[100:115]
    ds_read_b64_tr_b16 v[32:33], v229 offset:30720
    ds_read_b64_tr_b16 v[34:35], v229 offset:31744
    v_add_f32 v132, v132, v144
    v_add_f32 v133, v133, v145
    v_mov_b32 v134, v132
    s_waitcnt lgkmcnt(8)
    v_mfma_f32_32x32x16_bf16 v[180:195], v[12:15], a[152:155], v[180:195]
    ds_read_b64_tr_b16 v[36:37], v230 offset:32768
    ds_read_b64_tr_b16 v[38:39], v230 offset:33792
    v_mov_b32 v135, v133
    v_mov_b32 v10, 0
    v_mov_b32_e64 v11, 0
    v_mfma_f32_32x32x16_bf16 v[196:211], v[16:19], a[152:155], v[196:211]
    ds_read_b64_tr_b16 v[40:41], v229 offset:32768
    ds_read_b64_tr_b16 v[42:43], v229 offset:33792
    buffer_load_dwordx4 a[248:251], v252, s[72:75], s15 offen offset:2048 sc1
    v_permlane32_swap_b32 v132, v134
    s_waitcnt vmcnt(13) lgkmcnt(8)
    v_mfma_f32_32x32x16_bf16 v[44:59], v[20:23], a[200:203], v[44:59]
    ds_read_b64_tr_b16 v[12:13], v230 offset:34816
    ds_read_b64_tr_b16 v[14:15], v230 offset:35840
    buffer_load_dwordx4 a[252:255], v252, s[72:75], s15 offen offset:3072 sc1
    v_mfma_f32_32x32x16_bf16 v[100:115], v[24:27], a[200:203], v[100:115]
    ds_read_b64_tr_b16 v[16:17], v229 offset:34816
    ds_read_b64_tr_b16 v[18:19], v229 offset:35840
    s_barrier
    s_waitcnt vmcnt(13) lgkmcnt(8)
    v_mfma_f32_32x32x16_bf16 v[44:59], v[28:31], a[204:207], v[44:59]
    ds_read_b64_tr_b16 v[20:21], v230 offset:36864
    ds_read_b64_tr_b16 v[22:23], v230 offset:37888
    v_permlane32_swap_b32 v133, v135
    v_add_f32 v132, v132, v134
    v_add_f32_e64 v133, v133, v135
    v_mfma_f32_32x32x16_bf16 v[100:115], v[32:35], a[204:207], v[100:115]
    ds_read_b64_tr_b16 v[24:25], v229 offset:36864
    ds_read_b64_tr_b16 v[26:27], v229 offset:37888
    s_waitcnt vmcnt(12)
    v_cmp_eq_u32 vcc, v239, v251
    s_nop 0
    s_cmp_eq_u64 vcc, -1
    s_cbranch_scc0 L_spin2
L_pok2:
    s_waitcnt vmcnt(11) lgkmcnt(8)
    v_mfma_f32_32x32x16_bf16 v[44:59], v[36:39], a[208:211], v[44:59]
    ds_read_b64_tr_b16 v[28:29], v230 offset:63488
    ds_read_b64_tr_b16 v[30:31], v230 offset:64512
    buffer_load_dwordx4 v[116:119], v252, s[72:75], s16 offen offset:0 sc1
    buffer_load_dwordx4 v[120:123], v252, s[72:75], s14 offen offset:0 sc1
    v_mfma_f32_32x32x16_bf16 v[100:115], v[40:43], a[208:211], v[100:115]
    ds_read_b64_tr_b16 v[32:33], v229 offset:63488
    ds_read_b64_tr_b16 v[34:35], v229 offset:64512
    s_waitcnt vmcnt(12) lgkmcnt(8)
    s_nop 0
    v_mfma_f32_32x32x16_bf16 v[44:59], v[12:15], a[212:215], v[44:59]
    ds_read_b64_tr_b16 v[36:37], v230 offset:38912
    ds_read_b64_tr_b16 v[38:39], v230 offset:39936
    v_mfma_f32_32x32x16_bf16 v[100:115], v[16:19], a[212:215], v[100:115]
    ds_read_b64_tr_b16 v[40:41], v229 offset:38912
    ds_read_b64_tr_b16 v[42:43], v229 offset:39936
    buffer_load_dwordx4 v[124:127], v252, s[72:75], s16 offen offset:2048 sc1
    s_waitcnt vmcnt(12) lgkmcnt(8)
    s_nop 0
    v_mfma_f32_32x32x16_bf16 v[44:59], v[20:23], a[216:219], v[44:59]
    ds_read_b64_tr_b16 v[12:13], v230 offset:40960
    ds_read_b64_tr_b16 v[14:15], v230 offset:41984
    v_mfma_f32_32x32x16_bf16 v[100:115], v[24:27], a[216:219], v[100:115]
    ds_read_b64_tr_b16 v[16:17], v229 offset:40960
    ds_read_b64_tr_b16 v[18:19], v229 offset:41984
    buffer_load_dwordx4 v[128:131], v252, s[72:75], s14 offen offset:2048 sc1
    v_mul_f32 v132, 0xbb124925, v132
    v_mul_f32 v133, 0x3b124925, v133
    s_waitcnt lgkmcnt(8)
    s_nop 0
    v_mfma_f32_32x32x16_bf16 v[180:195], v[28:31], a[156:159], v[180:195]
    ds_read_b64_tr_b16 v[20:21], v230 offset:43008
    ds_read_b64_tr_b16 v[22:23], v230 offset:44032
    v_fma_f32 v133, -v132, v132, v133
    v_cvt_pk_bf16_f32 v9, v132, v132
    v_max_f32_e64 v133, 0, v133
    v_and_b32 v134, 0xffff0000, v9
    v_mfma_f32_32x32x16_bf16 v[196:211], v[32:35], a[156:159], v[196:211]
    ds_read_b64_tr_b16 v[24:25], v229 offset:43008
    ds_read_b64_tr_b16 v[26:27], v229 offset:44032
    v_add_f32 v133, 0x3727c5ac, v133
    v_sub_f32 v134, v132, v134
    s_waitcnt vmcnt(12) lgkmcnt(8)
    v_mfma_f32_32x32x16_bf16 v[44:59], v[36:39], a[220:223], v[44:59]
    ds_read_b64_tr_b16 v[28:29], v230 offset:45056
    ds_read_b64_tr_b16 v[30:31], v230 offset:46080
    v_rsq_f32_e64 v135, v133
    v_cvt_pk_bf16_f32 v8, v132, v134
    v_mfma_f32_32x32x16_bf16 v[100:115], v[40:43], a[220:223], v[100:115]
    ds_read_b64_tr_b16 v[32:33], v229 offset:45056
    ds_read_b64_tr_b16 v[34:35], v229 offset:46080
    v_sqrt_f32_e64 v138, v133
    v_mul_f32 v136, 0xc0135761, v135
    s_waitcnt vmcnt(11) lgkmcnt(8)
    v_mfma_f32_32x32x16_bf16 v[44:59], v[12:15], a[224:227], v[44:59]
    ds_read_b64_tr_b16 v[36:37], v230 offset:47104
    ds_read_b64_tr_b16 v[38:39], v230 offset:48128
    v_mul_f32 v137, v135, v135
    v_mul_f32_e64 v137, v137, v135
    v_mul_f32 v137, 0xbdd2d3e8, v137
    s_mul_i32 s8, s10, 14
    v_mfma_f32_32x32x16_bf16 v[100:115], v[16:19], a[224:227], v[100:115]
    ds_read_b64_tr_b16 v[40:41], v229 offset:47104
    ds_read_b64_tr_b16 v[42:43], v229 offset:48128
    s_add_u32 s8, s8, s87
    s_lshl_b32 s8, s8, 2
    s_add_u32 s8, s8, s7
    s_waitcnt vmcnt(10) lgkmcnt(8)
    v_mfma_f32_32x32x16_bf16 v[44:59], v[20:23], a[228:231], v[44:59]
    ds_read_b64_tr_b16 v[12:13], v224 offset:0
    ds_read_b64_tr_b16 v[14:15], v224 offset:1024
    s_xor_b32 s10, s8, 1
    s_lshl_b32 s8, s8, 11
    s_lshl_b32 s10, s10, 11
    s_add_u32 s8, s8, 10747904
    v_mfma_f32_32x32x16_bf16 v[100:115], v[24:27], a[228:231], v[100:115]
    ds_read_b64_tr_b16 v[16:17], v240 offset:0
    ds_read_b64_tr_b16 v[18:19], v240 offset:1024
    s_add_u32 s10, s10, 10747904
    s_lshl_b32 s9, s13, 12
    s_add_u32 s9, s9, 5046272
    s_waitcnt vmcnt(9) lgkmcnt(8)
    v_mfma_f32_32x32x16_bf16 v[44:59], v[28:31], a[232:235], v[44:59]
    ds_read_b64_tr_b16 v[20:21], v230 offset:49152
    ds_read_b64_tr_b16 v[22:23], v230 offset:50176
    s_lshl_b32 s11, s12, 4
    s_add_u32 s11, s11, s13
    s_lshl_b32 s11, s11, 11
    s_nop 0
    s_add_u32 s11, s11, 8650752
    v_mfma_f32_32x32x16_bf16 v[100:115], v[32:35], a[232:235], v[100:115]
    ds_read_b64_tr_b16 v[24:25], v229 offset:49152
    ds_read_b64_tr_b16 v[26:27], v229 offset:50176
    s_add_u32 m0, s18, 111616
    s_nop 0
    buffer_load_dwordx4 v242, s[60:63], s19 offen offset:3072  lds
    s_waitcnt vmcnt(9) lgkmcnt(8)
    v_mfma_f32_32x32x16_bf16 v[44:59], v[36:39], a[236:239], v[44:59]
    ds_read_b64_tr_b16 v[28:29], v230 offset:51200
    ds_read_b64_tr_b16 v[30:31], v230 offset:52224
    s_add_u32 m0, s18, 115712
    s_add_u32 s19, s84, 28672
    buffer_load_dwordx4 v246, s[60:63], s19 offen offset:0  lds
    buffer_load_dwordx4 v244, s[60:63], s19 offen offset:1024  lds
    v_mfma_f32_32x32x16_bf16 v[100:115], v[40:43], a[236:239], v[100:115]
    ds_read_b64_tr_b16 v[32:33], v229 offset:51200
    ds_read_b64_tr_b16 v[34:35], v229 offset:52224
    buffer_load_dwordx4 v243, s[60:63], s19 offen offset:2048  lds
    s_waitcnt lgkmcnt(8)
    s_nop 0
    v_mfma_f32_32x32x16_bf16 v[180:195], v[12:15], a[160:163], v[180:195]
    ds_read_b64_tr_b16 v[36:37], v230 offset:53248
    ds_read_b64_tr_b16 v[38:39], v230 offset:54272
    buffer_load_dwordx4 v242, s[60:63], s19 offen offset:3072  lds
    v_mfma_f32_32x32x16_bf16 v[196:211], v[16:19], a[160:163], v[196:211]
    ds_read_b64_tr_b16 v[40:41], v229 offset:53248
    ds_read_b64_tr_b16 v[42:43], v229 offset:54272
    s_waitcnt vmcnt(12) lgkmcnt(8)
    s_nop 0
    v_mfma_f32_32x32x16_bf16 v[44:59], v[20:23], a[240:243], v[44:59]
    ds_read_b64_tr_b16 v[12:13], v230 offset:55296
    ds_read_b64_tr_b16 v[14:15], v230 offset:56320
    v_mfma_f32_32x32x16_bf16 v[100:115], v[24:27], a[240:243], v[100:115]
    ds_read_b64_tr_b16 v[16:17], v229 offset:55296
    ds_read_b64_tr_b16 v[18:19], v229 offset:56320
    s_waitcnt vmcnt(11) lgkmcnt(8)
    s_nop 0
    v_mfma_f32_32x32x16_bf16 v[44:59], v[28:31], a[244:247], v[44:59]
    ds_read_b64_tr_b16 v[20:21], v224 offset:2048
    ds_read_b64_tr_b16 v[22:23], v224 offset:3072
    v_mfma_f32_32x32x16_bf16 v[100:115], v[32:35], a[244:247], v[100:115]
    ds_read_b64_tr_b16 v[24:25], v240 offset:2048
    ds_read_b64_tr_b16 v[26:27], v240 offset:3072
    s_waitcnt vmcnt(10) lgkmcnt(8)
    v_mfma_f32_32x32x16_bf16 v[44:59], v[36:39], a[248:251], v[44:59]
    v_mfma_f32_32x32x16_bf16 v[100:115], v[40:43], a[248:251], v[100:115]
    s_waitcnt vmcnt(9) lgkmcnt(4)
    v_mfma_f32_32x32x16_bf16 v[44:59], v[12:15], a[252:255], v[44:59]
    s_add_u32 s84, s84, 114688
    s_cmp_ge_u32 s84, s86
    s_cselect_b32 s89, 401408, 0
    s_sub_u32 s84, s84, s89
    s_add_u32 m0, s18, 119808
    s_add_u32 s19, s84, 0
    buffer_load_dwordx4 v246, s[60:63], s19 offen offset:0  lds
    v_mfma_f32_32x32x16_bf16 v[100:115], v[16:19], a[252:255], v[100:115]
    s_waitcnt lgkmcnt(0)
    v_mfma_f32_32x32x16_bf16 v[180:195], v[20:23], a[164:167], v[180:195]
    s_add_u32 m0, s18, 0
    s_nop 0
    buffer_load_dwordx4 v244, s[60:63], s19 offen offset:1024  lds
    v_mfma_f32_32x32x16_bf16 v[196:211], v[24:27], a[164:167], v[196:211]
    s_waitcnt vmcnt(7)
    v_mfma_f32_32x32x16_bf16 v[44:59], v[116:119], v[8:11], v[44:59]
    s_barrier
    v_mfma_f32_32x32x16_bf16 v[100:115], v[120:123], v[8:11], v[100:115]
    s_nop 9
    s_nop 0
    v_pk_mul_f32 v[238:239], v[44:45], v[44:45]
    buffer_load_dwordx4 v243, s[60:63], s19 offen offset:2048  lds
    v_pk_mul_f32 v[222:223], v[46:47], v[46:47]
    buffer_load_dwordx4 v242, s[60:63], s19 offen offset:3072  lds
    v_pk_fma_f32 v[238:239], v[238:239], v[136:137], v[136:137] op_sel:[0,1,0] op_sel_hi:[1,1,0]
    v_pk_fma_f32 v[222:223], v[222:223], v[136:137], v[136:137] op_sel:[0,1,0] op_sel_hi:[1,1,0]
    v_pk_mul_f32 v[238:239], v[238:239], v[44:45]
    v_pk_mul_f32 v[222:223], v[222:223], v[46:47]
    v_exp_f32 v238, v238
    v_exp_f32 v239, v239
    s_add_u32 s19, s84, 28672
    buffer_load_dwordx4 v246, s[60:63], s19 offen offset:0  lds
    v_exp_f32 v222, v222
    v_exp_f32 v223, v223
    v_pk_fma_f32 v[238:239], v[238:239], v[138:139], v[138:139] op_sel_hi:[1,0,0]
    v_pk_fma_f32 v[222:223], v[222:223], v[138:139], v[138:139] op_sel_hi:[1,0,0]
    v_rcp_f32 v238, v238
    v_rcp_f32 v239, v239
    s_waitcnt vmcnt(9)
    s_nop 0
    ds_read_b64_tr_b16 a[16:17], v219 offset:55296
    ds_read_b64_tr_b16 a[18:19], v219 offset:49152
    ds_read_b64_tr_b16 a[20:21], v218 offset:55296
    ds_read_b64_tr_b16 a[22:23], v218 offset:49152
    s_add_u32 m0, s18, 3072
    s_nop 0
    buffer_load_dwordx4 v244, s[60:63], s19 offen offset:1024  lds
    v_rcp_f32 v222, v222
    v_rcp_f32_e64 v223, v223
    v_pk_mul_f32 v[238:239], v[238:239], v[44:45]
    v_pk_mul_f32 v[222:223], v[222:223], v[46:47]
    v_cvt_pk_bf16_f32 v28, v238, v239
    v_cvt_pk_bf16_f32 v29, v222, v223
    v_pk_mul_f32 v[238:239], v[48:49], v[48:49]
    v_pk_mul_f32 v[222:223], v[50:51], v[50:51]
    v_pk_fma_f32 v[238:239], v[238:239], v[136:137], v[136:137] op_sel:[0,1,0] op_sel_hi:[1,1,0]
    v_pk_fma_f32 v[222:223], v[222:223], v[136:137], v[136:137] op_sel:[0,1,0] op_sel_hi:[1,1,0]
    v_pk_mul_f32 v[238:239], v[238:239], v[48:49]
    v_pk_mul_f32 v[222:223], v[222:223], v[50:51]
    buffer_load_dwordx4 v243, s[60:63], s19 offen offset:2048  lds
    v_exp_f32 v238, v238
    v_exp_f32 v239, v239
    v_exp_f32 v222, v222
    v_exp_f32 v223, v223
    v_pk_fma_f32 v[238:239], v[238:239], v[138:139], v[138:139] op_sel_hi:[1,0,0]
    v_pk_fma_f32 v[222:223], v[222:223], v[138:139], v[138:139] op_sel_hi:[1,0,0]
    v_rcp_f32 v238, v238
    s_waitcnt vmcnt(9)
    ds_read_b64_tr_b16 a[24:25], v219 offset:50176
    ds_read_b64_tr_b16 a[26:27], v219 offset:51200
    ds_read_b64_tr_b16 a[28:29], v218 offset:50176
    ds_read_b64_tr_b16 a[30:31], v218 offset:51200
    buffer_load_dwordx4 v242, s[60:63], s19 offen offset:3072  lds
    v_rcp_f32 v239, v239
    v_rcp_f32 v222, v222
    v_rcp_f32_e64 v223, v223
    v_pk_mul_f32 v[238:239], v[238:239], v[48:49]
    v_pk_mul_f32 v[222:223], v[222:223], v[50:51]
    v_cvt_pk_bf16_f32 v30, v238, v239
    v_cvt_pk_bf16_f32 v31, v222, v223
    buffer_store_dwordx4 v[28:31], v252, s[72:75], s8 offen offset:0 sc1
    v_pk_mul_f32 v[238:239], v[52:53], v[52:53]
    v_pk_mul_f32 v[222:223], v[54:55], v[54:55]
    s_add_u32 s84, s84, 114688
    s_cmp_ge_u32 s84, s86
    s_cselect_b32 s89, 401408, 0
    s_sub_u32 s84, s84, s89
    s_add_u32 m0, s18, 28672
    s_add_u32 s19, s84, 0
    s_nop 0
    buffer_load_dwordx4 v246, s[60:63], s19 offen offset:0  lds
    v_pk_fma_f32 v[238:239], v[238:239], v[136:137], v[136:137] op_sel:[0,1,0] op_sel_hi:[1,1,0]
    v_pk_fma_f32 v[222:223], v[222:223], v[136:137], v[136:137] op_sel:[0,1,0] op_sel_hi:[1,1,0]
    v_pk_mul_f32 v[238:239], v[238:239], v[52:53]
    v_pk_mul_f32 v[222:223], v[222:223], v[54:55]
    v_exp_f32 v238, v238
    s_waitcnt vmcnt(10)
    ds_read_b64_tr_b16 a[32:33], v219 offset:52224
    ds_read_b64_tr_b16 a[34:35], v219 offset:53248
    ds_read_b64_tr_b16 a[36:37], v218 offset:52224
    ds_read_b64_tr_b16 a[38:39], v218 offset:53248
    buffer_load_dwordx4 v244, s[60:63], s19 offen offset:1024  lds
    v_exp_f32 v239, v239
    v_exp_f32 v222, v222
    v_exp_f32_e64 v223, v223
    v_pk_fma_f32 v[238:239], v[238:239], v[138:139], v[138:139] op_sel_hi:[1,0,0]
    v_pk_fma_f32 v[222:223], v[222:223], v[138:139], v[138:139] op_sel_hi:[1,0,0]
    v_rcp_f32 v238, v238
    v_rcp_f32 v239, v239
    v_rcp_f32 v222, v222
    v_rcp_f32 v223, v223
    buffer_load_dwordx4 v243, s[60:63], s19 offen offset:2048  lds
    v_pk_mul_f32 v[238:239], v[238:239], v[52:53]
    v_pk_mul_f32 v[222:223], v[222:223], v[54:55]
    v_cvt_pk_bf16_f32 v32, v238, v239
    v_cvt_pk_bf16_f32 v33, v222, v223
    v_pk_mul_f32 v[238:239], v[56:57], v[56:57]
    v_pk_mul_f32 v[222:223], v[58:59], v[58:59]
    v_pk_fma_f32 v[238:239], v[238:239], v[136:137], v[136:137] op_sel:[0,1,0] op_sel_hi:[1,1,0]
    v_pk_fma_f32 v[222:223], v[222:223], v[136:137], v[136:137] op_sel:[0,1,0] op_sel_hi:[1,1,0]
    v_pk_mul_f32 v[238:239], v[238:239], v[56:57]
    v_pk_mul_f32 v[222:223], v[222:223], v[58:59]
    v_exp_f32 v238, v238
    s_waitcnt vmcnt(10)
    ds_read_b64_tr_b16 a[40:41], v219 offset:54272
    ds_read_b64_tr_b16 a[42:43], v221 offset:1024
    ds_read_b64_tr_b16 a[44:45], v218 offset:54272
    ds_read_b64_tr_b16 a[46:47], v220 offset:1024
    buffer_load_dwordx4 v242, s[60:63], s19 offen offset:3072  lds
    v_exp_f32 v239, v239
    v_exp_f32 v222, v222
    v_exp_f32_e64 v223, v223
    v_pk_fma_f32 v[238:239], v[238:239], v[138:139], v[138:139] op_sel_hi:[1,0,0]
    v_pk_fma_f32 v[222:223], v[222:223], v[138:139], v[138:139] op_sel_hi:[1,0,0]
    v_rcp_f32 v238, v238
    v_rcp_f32 v239, v239
    v_rcp_f32 v222, v222
    v_rcp_f32 v223, v223
    s_add_u32 m0, s18, 32768
    s_add_u32 s19, s84, 28672
    buffer_load_dwordx4 v246, s[60:63], s19 offen offset:0  lds
    v_pk_mul_f32 v[238:239], v[238:239], v[56:57]
    v_pk_mul_f32 v[222:223], v[222:223], v[58:59]
    v_cvt_pk_bf16_f32 v34, v238, v239
    v_cvt_pk_bf16_f32 v35, v222, v223
    buffer_store_dwordx4 v[32:35], v252, s[72:75], s8 offen offset:1024 sc1
    s_mov_b32 s77, 20480
    buffer_load_dword v239, v255, s[72:75], s77 offen sc1
    v_pk_mul_f32 v[222:223], v[100:101], v[100:101]
    s_waitcnt vmcnt(12)
    s_nop 0
    ds_read_b64_tr_b16 a[48:49], v221 offset:2048
    ds_read_b64_tr_b16 a[50:51], v221 offset:3072
    ds_read_b64_tr_b16 a[52:53], v220 offset:2048
    ds_read_b64_tr_b16 a[54:55], v220 offset:3072
    buffer_load_dwordx4 v244, s[60:63], s19 offen offset:1024  lds
    v_pk_mul_f32 v[216:217], v[102:103], v[102:103]
    v_pk_fma_f32 v[222:223], v[222:223], v[136:137], v[136:137] op_sel:[0,1,0] op_sel_hi:[1,1,0]
    v_pk_fma_f32 v[216:217], v[216:217], v[136:137], v[136:137] op_sel:[0,1,0] op_sel_hi:[1,1,0]
    v_pk_mul_f32 v[222:223], v[222:223], v[100:101]
    v_pk_mul_f32 v[216:217], v[216:217], v[102:103]
    v_exp_f32 v222, v222
    v_exp_f32 v223, v223
    v_exp_f32_e64 v216, v216
    buffer_load_dwordx4 v243, s[60:63], s19 offen offset:2048  lds
    v_exp_f32_e64 v217, v217
    v_pk_fma_f32 v[222:223], v[222:223], v[138:139], v[138:139] op_sel_hi:[1,0,0]
    v_pk_fma_f32 v[216:217], v[216:217], v[138:139], v[138:139] op_sel_hi:[1,0,0]
    v_rcp_f32 v222, v222
    v_rcp_f32 v223, v223
    v_rcp_f32 v216, v216
    v_rcp_f32 v217, v217
    s_waitcnt vmcnt(12)
    ds_read_b64_tr_b16 a[56:57], v221 offset:0
    ds_read_b64_tr_b16 a[58:59], v221 offset:4096
    ds_read_b64_tr_b16 a[60:61], v220 offset:0
    ds_read_b64_tr_b16 a[62:63], v220 offset:4096
    s_waitcnt lgkmcnt(15)
    s_add_u32 m0, s18, 111616
    s_nop 0
    s_nop 0
    buffer_load_dwordx4 v242, s[60:63], s19 offen offset:3072  lds
    v_pk_mul_f32 v[222:223], v[222:223], v[100:101]
    v_pk_mul_f32 v[216:217], v[216:217], v[102:103]
    v_cvt_pk_bf16_f32 v36, v222, v223
    v_cvt_pk_bf16_f32 v37, v216, v217
    v_pk_mul_f32 v[222:223], v[104:105], v[104:105]
    v_pk_mul_f32 v[216:217], v[106:107], v[106:107]
    v_pk_fma_f32 v[222:223], v[222:223], v[136:137], v[136:137] op_sel:[0,1,0] op_sel_hi:[1,1,0]
    v_pk_fma_f32 v[216:217], v[216:217], v[136:137], v[136:137] op_sel:[0,1,0] op_sel_hi:[1,1,0]
    v_pk_mul_f32 v[222:223], v[222:223], v[104:105]
    v_pk_mul_f32 v[216:217], v[216:217], v[106:107]
    v_exp_f32 v222, v222
    v_exp_f32 v223, v223
    s_add_u32 s84, s84, 114688
    s_cmp_ge_u32 s84, s86
    s_cselect_b32 s89, 401408, 0
    s_sub_u32 s84, s84, s89
    s_add_u32 m0, s18, 115712
    s_add_u32 s19, s84, 0
    buffer_load_dwordx4 v246, s[60:63], s19 offen offset:0  lds
    v_exp_f32 v216, v216
    v_exp_f32_e64 v217, v217
    v_pk_fma_f32 v[222:223], v[222:223], v[138:139], v[138:139] op_sel_hi:[1,0,0]
    s_waitcnt vmcnt(12)
    s_nop 0
    ds_read_b64_tr_b16 a[64:65], v221 offset:5120
    ds_read_b64_tr_b16 a[66:67], v221 offset:6144
    ds_read_b64_tr_b16 a[68:69], v220 offset:5120
    ds_read_b64_tr_b16 a[70:71], v220 offset:6144
    buffer_load_dwordx4 v244, s[60:63], s19 offen offset:1024  lds
    v_pk_fma_f32 v[216:217], v[216:217], v[138:139], v[138:139] op_sel_hi:[1,0,0]
    v_rcp_f32 v222, v222
    v_rcp_f32 v223, v223
    v_rcp_f32 v216, v216
    v_rcp_f32 v217, v217
    v_pk_mul_f32 v[222:223], v[222:223], v[104:105]
    v_pk_mul_f32 v[216:217], v[216:217], v[106:107]
    v_cvt_pk_bf16_f32 v38, v222, v223
    v_cvt_pk_bf16_f32 v39, v216, v217
    buffer_store_dwordx4 v[36:39], v252, s[72:75], s10 offen offset:0 sc1
    v_pk_mul_f32 v[222:223], v[108:109], v[108:109]
    s_add_u32 m0, s18, 118784
    s_nop 0
    s_nop 0
    buffer_load_dwordx4 v243, s[60:63], s19 offen offset:2048  lds
    v_pk_mul_f32 v[216:217], v[110:111], v[110:111]
    v_pk_fma_f32 v[222:223], v[222:223], v[136:137], v[136:137] op_sel:[0,1,0] op_sel_hi:[1,1,0]
    v_pk_fma_f32 v[216:217], v[216:217], v[136:137], v[136:137] op_sel:[0,1,0] op_sel_hi:[1,1,0]
    v_pk_mul_f32 v[222:223], v[222:223], v[108:109]
    v_pk_mul_f32 v[216:217], v[216:217], v[110:111]
    v_exp_f32 v222, v222
    v_exp_f32 v223, v223
    v_exp_f32 v216, v216
    v_exp_f32 v217, v217
    s_waitcnt lgkmcnt(15)
    s_add_u32 m0, s18, 114688
    s_nop 0
    buffer_load_dwordx4 v242, s[60:63], s19 offen offset:3072  lds
    v_pk_fma_f32 v[222:223], v[222:223], v[138:139], v[138:139] op_sel_hi:[1,0,0]
    v_pk_fma_f32 v[216:217], v[216:217], v[138:139], v[138:139] op_sel_hi:[1,0,0]
    v_rcp_f32 v222, v222
    v_rcp_f32 v223, v223
    v_rcp_f32 v216, v216
    v_rcp_f32 v217, v217
    v_pk_mul_f32 v[222:223], v[222:223], v[108:109]
    v_pk_mul_f32 v[216:217], v[216:217], v[110:111]
    s_add_u32 m0, s18, 118784
    s_add_u32 s19, s84, 28672
    buffer_load_dwordx4 v246, s[60:63], s19 offen offset:0  lds
    v_cvt_pk_bf16_f32 v40, v222, v223
    v_cvt_pk_bf16_f32 v41, v216, v217
    v_pk_mul_f32 v[222:223], v[112:113], v[112:113]
    v_pk_mul_f32 v[216:217], v[114:115], v[114:115]
    v_pk_fma_f32 v[222:223], v[222:223], v[136:137], v[136:137] op_sel:[0,1,0] op_sel_hi:[1,1,0]
    v_pk_fma_f32 v[216:217], v[216:217], v[136:137], v[136:137] op_sel:[0,1,0] op_sel_hi:[1,1,0]
    v_pk_mul_f32 v[222:223], v[222:223], v[112:113]
    v_pk_mul_f32 v[216:217], v[216:217], v[114:115]
    s_waitcnt vmcnt(14)
    ds_read_b64_tr_b16 a[72:73], v221 offset:28672
    ds_read_b64_tr_b16 a[74:75], v221 offset:29696
    ds_read_b64_tr_b16 a[76:77], v220 offset:28672
    ds_read_b64_tr_b16 a[78:79], v220 offset:29696
    v_exp_f32 v222, v222
    s_waitcnt vmcnt(12)
    ds_read_b64_tr_b16 a[80:81], v221 offset:30720
    ds_read_b64_tr_b16 a[82:83], v221 offset:31744
    ds_read_b64_tr_b16 a[84:85], v220 offset:30720
    ds_read_b64_tr_b16 a[86:87], v220 offset:31744
    v_exp_f32 v223, v223
    v_exp_f32 v216, v216
    v_exp_f32 v217, v217
    v_pk_fma_f32 v[222:223], v[222:223], v[138:139], v[138:139] op_sel_hi:[1,0,0]
    v_pk_fma_f32 v[216:217], v[216:217], v[138:139], v[138:139] op_sel_hi:[1,0,0]
    v_rcp_f32 v222, v222
    v_rcp_f32 v223, v223
    v_rcp_f32 v216, v216
    v_rcp_f32 v217, v217
    v_pk_mul_f32 v[222:223], v[222:223], v[112:113]
    v_pk_mul_f32 v[216:217], v[216:217], v[114:115]
    v_cvt_pk_bf16_f32 v42, v222, v223
    v_cvt_pk_bf16_f32 v43, v216, v217
    buffer_store_dwordx4 v[40:43], v252, s[72:75], s10 offen offset:1024 sc1
    ds_read_b64_tr_b16 v[12:13], v224 offset:4096
    ds_read_b64_tr_b16 v[14:15], v224 offset:5120
    ds_read_b64_tr_b16 v[16:17], v240 offset:4096
    ds_read_b64_tr_b16 v[18:19], v240 offset:5120
    ds_read_b64_tr_b16 v[20:21], v224 offset:6144
    ds_read_b64_tr_b16 v[22:23], v224 offset:7168
    ds_read_b64_tr_b16 v[24:25], v240 offset:6144
    ds_read_b64_tr_b16 v[26:27], v240 offset:7168
    ds_read_b64_tr_b16 v[28:29], v224 offset:8192
    ds_read_b64_tr_b16 v[30:31], v224 offset:9216
    ds_read_b64_tr_b16 v[32:33], v240 offset:8192
    ds_read_b64_tr_b16 v[34:35], v240 offset:9216
    s_waitcnt lgkmcnt(8)
    s_nop 0
    v_mfma_f32_32x32x16_bf16 v[180:195], v[12:15], a[168:171], v[180:195]
    ds_read_b64_tr_b16 v[36:37], v224 offset:10240
    ds_read_b64_tr_b16 v[38:39], v224 offset:11264
    s_add_u32 s8, s8, 4096
    s_add_u32 s10, s10, 4096
    v_mul_u32_u24 v4, 896, v225
    v_lshrrev_b32_e64 v3, 5, v1
    v_mfma_f32_32x32x16_bf16 v[196:211], v[16:19], a[168:171], v[196:211]
    ds_read_b64_tr_b16 v[40:41], v240 offset:10240
    ds_read_b64_tr_b16 v[42:43], v240 offset:11264
    v_lshl_add_u32 v4, v3, 4, v4
    s_mul_i32 s14, s12, 28672
    s_lshl_b32 s15, s13, 6
    s_waitcnt lgkmcnt(8)
    v_mfma_f32_32x32x16_bf16 v[180:195], v[20:23], a[172:175], v[180:195]
    ds_read_b64_tr_b16 v[12:13], v224 offset:12288
    ds_read_b64_tr_b16 v[14:15], v224 offset:13312
    s_add_u32 s14, s14, s15
    v_add_u32 v241, s14, v4
    buffer_load_dwordx4 v244, s[60:63], s19 offen offset:1024  lds
    v_mfma_f32_32x32x16_bf16 v[196:211], v[24:27], a[172:175], v[196:211]
    ds_read_b64_tr_b16 v[16:17], v240 offset:12288
    ds_read_b64_tr_b16 v[18:19], v240 offset:13312
    s_add_u32 m0, s18, 0
    s_nop 0
    buffer_load_dwordx4 v243, s[60:63], s19 offen offset:2048  lds
    s_waitcnt lgkmcnt(8)
    s_nop 0
    v_mfma_f32_32x32x16_bf16 v[180:195], v[28:31], a[176:179], v[180:195]
    ds_read_b64_tr_b16 v[20:21], v224 offset:14336
    ds_read_b64_tr_b16 v[22:23], v224 offset:15360
    v_mfma_f32_32x32x16_bf16 v[196:211], v[32:35], a[176:179], v[196:211]
    ds_read_b64_tr_b16 v[24:25], v240 offset:14336
    ds_read_b64_tr_b16 v[26:27], v240 offset:15360
    s_waitcnt vmcnt(12)
    v_cmp_eq_u32 vcc, v239, v251
    s_nop 0
    s_cmp_eq_u64 vcc, -1
    s_cbranch_scc0 L_spin3
L_pok3:
    buffer_load_dwordx4 v[164:167], v252, s[72:75], s9 offen offset:0 sc1
    buffer_load_dwordx4 v[168:171], v252, s[72:75], s9 offen offset:1024 sc1
    buffer_load_dwordx4 v[172:175], v252, s[72:75], s9 offen offset:2048 sc1
    buffer_load_dwordx4 v[176:179], v252, s[72:75], s9 offen offset:3072 sc1
    s_waitcnt lgkmcnt(8)
    v_mfma_f32_32x32x16_bf16 v[180:195], v[36:39], a[180:183], v[180:195]
    ds_read_b64_tr_b16 v[28:29], v224 offset:16384
    ds_read_b64_tr_b16 v[30:31], v224 offset:17408
    s_waitcnt vmcnt(15)
    s_nop 0
    ds_read_b64_tr_b16 a[88:89], v221 offset:32768
    ds_read_b64_tr_b16 a[90:91], v221 offset:33792
    v_mfma_f32_32x32x16_bf16 v[196:211], v[40:43], a[180:183], v[196:211]
    ds_read_b64_tr_b16 v[32:33], v240 offset:16384
    ds_read_b64_tr_b16 v[34:35], v240 offset:17408
    ds_read_b64_tr_b16 a[92:93], v220 offset:32768
    ds_read_b64_tr_b16 a[94:95], v220 offset:33792
    s_waitcnt lgkmcnt(12)
    v_mfma_f32_32x32x16_bf16 v[180:195], v[12:15], a[184:187], v[180:195]
    ds_read_b64_tr_b16 v[36:37], v224 offset:18432
    ds_read_b64_tr_b16 v[38:39], v224 offset:19456
    s_waitcnt vmcnt(13)
    ds_read_b64_tr_b16 a[96:97], v221 offset:34816
    ds_read_b64_tr_b16 a[98:99], v219 offset:49152
    buffer_load_dwordx4 v242, s[60:63], s19 offen offset:3072  lds
    v_mfma_f32_32x32x16_bf16 v[196:211], v[16:19], a[184:187], v[196:211]
    ds_read_b64_tr_b16 v[40:41], v240 offset:18432
    ds_read_b64_tr_b16 v[42:43], v240 offset:19456
    ds_read_b64_tr_b16 a[100:101], v220 offset:34816
    ds_read_b64_tr_b16 a[102:103], v218 offset:49152
    s_waitcnt lgkmcnt(15)
    s_nop 0
    v_mfma_f32_32x32x16_bf16 v[180:195], v[20:23], a[188:191], v[180:195]
    ds_read_b64_tr_b16 v[12:13], v224 offset:20480
    ds_read_b64_tr_b16 v[14:15], v224 offset:21504
    v_mfma_f32_32x32x16_bf16 v[196:211], v[24:27], a[188:191], v[196:211]
    ds_read_b64_tr_b16 v[16:17], v240 offset:20480
    ds_read_b64_tr_b16 v[18:19], v240 offset:21504
    s_waitcnt vmcnt(12)
    ds_read_b64_tr_b16 a[104:105], v219 offset:50176
    ds_read_b64_tr_b16 a[106:107], v219 offset:51200
    s_waitcnt lgkmcnt(15)
    v_mfma_f32_32x32x16_bf16 v[180:195], v[28:31], a[192:195], v[180:195]
    ds_read_b64_tr_b16 v[20:21], v224 offset:22528
    ds_read_b64_tr_b16 v[22:23], v224 offset:23552
    ds_read_b64_tr_b16 a[108:109], v218 offset:50176
    ds_read_b64_tr_b16 a[110:111], v218 offset:51200
    s_add_u32 s84, s84, 114688
    s_cmp_ge_u32 s84, s86
    s_cselect_b32 s89, 401408, 0
    s_sub_u32 s84, s84, s89
    s_add_u32 s19, s84, 0
    s_nop 0
    buffer_load_dwordx4 v246, s[60:63], s19 offen offset:0  lds
    v_mfma_f32_32x32x16_bf16 v[196:211], v[32:35], a[192:195], v[196:211]
    ds_read_b64_tr_b16 v[24:25], v240 offset:22528
    ds_read_b64_tr_b16 v[26:27], v240 offset:23552
    buffer_load_dwordx4 v244, s[60:63], s19 offen offset:1024  lds
    s_waitcnt lgkmcnt(14)
    s_nop 0
    v_mfma_f32_32x32x16_bf16 v[180:195], v[36:39], a[196:199], v[180:195]
    ds_read_b64_tr_b16 v[28:29], v224 offset:24576
    ds_read_b64_tr_b16 v[30:31], v224 offset:25600
    v_mfma_f32_32x32x16_bf16 v[196:211], v[40:43], a[196:199], v[196:211]
    ds_read_b64_tr_b16 v[32:33], v240 offset:24576
    ds_read_b64_tr_b16 v[34:35], v240 offset:25600
    s_add_u32 m0, s18, 2048
    s_nop 0
    buffer_load_dwordx4 v243, s[60:63], s19 offen offset:2048  lds
    s_waitcnt lgkmcnt(12)
    v_mfma_f32_32x32x16_bf16 v[180:195], v[12:15], a[200:203], v[180:195]
    ds_read_b64_tr_b16 v[36:37], v224 offset:26624
    ds_read_b64_tr_b16 v[38:39], v224 offset:27648
    v_mfma_f32_32x32x16_bf16 v[196:211], v[16:19], a[200:203], v[196:211]
    ds_read_b64_tr_b16 v[40:41], v240 offset:26624
    ds_read_b64_tr_b16 v[42:43], v240 offset:27648
    s_barrier
    s_waitcnt lgkmcnt(8)
    v_mfma_f32_32x32x16_bf16 v[180:195], v[20:23], a[204:207], v[180:195]
    ds_read_b64_tr_b16 v[12:13], v224 offset:28672
    ds_read_b64_tr_b16 v[14:15], v224 offset:29696
    s_add_u32 m0, s18, 57344
    s_add_u32 s78, s79, 0
    buffer_load_dwordx4 v246, s[44:47], s78 offen offset:0  lds
    v_mfma_f32_32x32x16_bf16 v[196:211], v[24:27], a[204:207], v[196:211]
    ds_read_b64_tr_b16 v[16:17], v240 offset:28672
    ds_read_b64_tr_b16 v[18:19], v240 offset:29696
    s_waitcnt vmcnt(11)
    s_barrier
    s_add_u32 s77, s90, 20480
    buffer_store_dword v251, v250, s[72:75], s77 offen sc1
    s_waitcnt lgkmcnt(8)
    v_mfma_f32_32x32x16_bf16 v[180:195], v[28:31], a[208:211], v[180:195]
    ds_read_b64_tr_b16 v[20:21], v224 offset:30720
    ds_read_b64_tr_b16 v[22:23], v224 offset:31744
    v_mfma_f32_32x32x16_bf16 v[196:211], v[32:35], a[208:211], v[196:211]
    ds_read_b64_tr_b16 v[24:25], v240 offset:30720
    ds_read_b64_tr_b16 v[26:27], v240 offset:31744
    s_waitcnt lgkmcnt(8)
    s_nop 0
    v_mfma_f32_32x32x16_bf16 v[180:195], v[36:39], a[212:215], v[180:195]
    ds_read_b64_tr_b16 v[28:29], v224 offset:32768
    ds_read_b64_tr_b16 v[30:31], v224 offset:33792
    v_mfma_f32_32x32x16_bf16 v[196:211], v[40:43], a[212:215], v[196:211]
    ds_read_b64_tr_b16 v[32:33], v240 offset:32768
    ds_read_b64_tr_b16 v[34:35], v240 offset:33792
    buffer_load_dwordx4 v244, s[44:47], s78 offen offset:1024  lds
    s_waitcnt lgkmcnt(8)
    s_nop 0
    v_mfma_f32_32x32x16_bf16 v[180:195], v[12:15], a[216:219], v[180:195]
    ds_read_b64_tr_b16 v[36:37], v224 offset:34816
    ds_read_b64_tr_b16 v[38:39], v224 offset:35840
    v_mfma_f32_32x32x16_bf16 v[196:211], v[16:19], a[216:219], v[196:211]
    ds_read_b64_tr_b16 v[40:41], v240 offset:34816
    ds_read_b64_tr_b16 v[42:43], v240 offset:35840
    buffer_load_dwordx4 v243, s[44:47], s78 offen offset:2048  lds
    s_waitcnt lgkmcnt(8)
    s_nop 0
    v_mfma_f32_32x32x16_bf16 v[180:195], v[20:23], a[220:223], v[180:195]
    ds_read_b64_tr_b16 v[12:13], v224 offset:36864
    ds_read_b64_tr_b16 v[14:15], v224 offset:37888
    v_mfma_f32_32x32x16_bf16 v[196:211], v[24:27], a[220:223], v[196:211]
    ds_read_b64_tr_b16 v[16:17], v240 offset:36864
    ds_read_b64_tr_b16 v[18:19], v240 offset:37888
    buffer_load_dwordx4 v242, s[44:47], s78 offen offset:3072  lds
    s_waitcnt lgkmcnt(8)
    s_nop 0
    v_mfma_f32_32x32x16_bf16 v[180:195], v[28:31], a[224:227], v[180:195]
    ds_read_b64_tr_b16 v[20:21], v224 offset:38912
    ds_read_b64_tr_b16 v[22:23], v224 offset:39936
    v_mfma_f32_32x32x16_bf16 v[196:211], v[32:35], a[224:227], v[196:211]
    ds_read_b64_tr_b16 v[24:25], v240 offset:38912
    ds_read_b64_tr_b16 v[26:27], v240 offset:39936
    s_waitcnt lgkmcnt(8)
    s_nop 0
    v_mfma_f32_32x32x16_bf16 v[180:195], v[36:39], a[228:231], v[180:195]
    ds_read_b64_tr_b16 v[28:29], v224 offset:40960
    ds_read_b64_tr_b16 v[30:31], v224 offset:41984
    v_mfma_f32_32x32x16_bf16 v[196:211], v[40:43], a[228:231], v[196:211]
    ds_read_b64_tr_b16 v[32:33], v240 offset:40960
    ds_read_b64_tr_b16 v[34:35], v240 offset:41984
    s_waitcnt lgkmcnt(8)
    s_nop 0
    v_mfma_f32_32x32x16_bf16 v[180:195], v[12:15], a[232:235], v[180:195]
    ds_read_b64_tr_b16 v[36:37], v224 offset:43008
    ds_read_b64_tr_b16 v[38:39], v224 offset:44032
    s_add_u32 m0, s18, 61440
    s_add_u32 s78, s79, 28672
    buffer_load_dwordx4 v246, s[44:47], s78 offen offset:0  lds
    v_mfma_f32_32x32x16_bf16 v[196:211], v[16:19], a[232:235], v[196:211]
    ds_read_b64_tr_b16 v[40:41], v240 offset:43008
    ds_read_b64_tr_b16 v[42:43], v240 offset:44032
    s_waitcnt lgkmcnt(8)
    s_nop 0
    v_mfma_f32_32x32x16_bf16 v[180:195], v[20:23], a[236:239], v[180:195]
    ds_read_b64_tr_b16 v[12:13], v224 offset:45056
    ds_read_b64_tr_b16 v[14:15], v224 offset:46080
    v_mfma_f32_32x32x16_bf16 v[196:211], v[24:27], a[236:239], v[196:211]
    ds_read_b64_tr_b16 v[16:17], v240 offset:45056
    ds_read_b64_tr_b16 v[18:19], v240 offset:46080
    buffer_load_dwordx4 v244, s[44:47], s78 offen offset:1024  lds
    s_waitcnt lgkmcnt(8)
    s_nop 0
    v_mfma_f32_32x32x16_bf16 v[180:195], v[28:31], a[240:243], v[180:195]
    ds_read_b64_tr_b16 v[20:21], v224 offset:47104
    ds_read_b64_tr_b16 v[22:23], v224 offset:48128
    v_mfma_f32_32x32x16_bf16 v[196:211], v[32:35], a[240:243], v[196:211]
    ds_read_b64_tr_b16 v[24:25], v240 offset:47104
    ds_read_b64_tr_b16 v[26:27], v240 offset:48128
    buffer_load_dwordx4 v243, s[44:47], s78 offen offset:2048  lds
    s_waitcnt lgkmcnt(8)
    v_mfma_f32_32x32x16_bf16 v[180:195], v[36:39], a[244:247], v[180:195]
    v_mfma_f32_32x32x16_bf16 v[196:211], v[40:43], a[244:247], v[196:211]
    s_waitcnt lgkmcnt(4)
    v_mfma_f32_32x32x16_bf16 v[180:195], v[12:15], a[248:251], v[180:195]
    s_add_u32 m0, s18, 111616
    s_nop 0
    buffer_load_dwordx4 v242, s[60:63], s19 offen offset:3072  lds
    v_mfma_f32_32x32x16_bf16 v[196:211], v[16:19], a[248:251], v[196:211]
    s_waitcnt lgkmcnt(0)
    v_mfma_f32_32x32x16_bf16 v[180:195], v[20:23], a[252:255], v[180:195]
    v_mfma_f32_32x32x16_bf16 v[196:211], v[24:27], a[252:255], v[196:211]
    s_add_u32 m0, s18, 115712
    s_add_u32 s19, s84, 28672
    buffer_load_dwordx4 v246, s[60:63], s19 offen offset:0  lds
    v_mfma_f32_32x32x16_bf16 v[180:195], v[124:127], v[8:11], v[180:195]
    s_barrier
    v_mfma_f32_32x32x16_bf16 v[196:211], v[128:131], v[8:11], v[196:211]
    s_waitcnt vmcnt(17)
    v_mfma_f32_32x32x16_bf16 v[44:59], v[164:167], v[84:87], 0
    s_waitcnt vmcnt(16)
    v_mfma_f32_32x32x16_bf16 v[44:59], v[168:171], v[88:91], v[44:59]
    s_waitcnt vmcnt(15)
    v_mfma_f32_32x32x16_bf16 v[44:59], v[172:175], v[92:95], v[44:59]
    s_waitcnt vmcnt(14)
    v_mfma_f32_32x32x16_bf16 v[44:59], v[176:179], v[96:99], v[44:59]
    v_and_b32 v3, 7, v1
    s_lshl_b32 s14, s3, 7
    v_lshl_add_u32 v255, v3, 2, s14
    s_bfe_u32 s14, s3, 0x20001
    s_and_b32 s15, s3, 24
    s_add_u32 s14, s14, s15
    s_lshl_b32 s14, s14, 7
    v_min_u32 v3, 6, v3
    v_and_b32 v2, 8, v1
    v_lshlrev_b32_e64 v2, 6, v2
    v_lshl_add_u32 v2, v3, 2, v2
    v_add_u32_e64 v253, s14, v2
    v_add_f32 v239, 0x358637bd, v56
    v_rcp_f32 v239, v239
    s_nop 0
    v_mov_b32 v238, v239
    s_nop 1
    v_permlane32_swap_b32 v239, v238
    s_nop 0
    v_pk_mul_f32 v[44:45], v[44:45], v[238:239] op_sel_hi:[1,0]
    v_pk_mul_f32 v[46:47], v[46:47], v[238:239] op_sel_hi:[1,0]
    v_pk_mul_f32 v[48:49], v[48:49], v[238:239] op_sel_hi:[1,0]
    v_pk_mul_f32 v[50:51], v[50:51], v[238:239] op_sel_hi:[1,0]
    v_pk_mul_f32 v[52:53], v[52:53], v[238:239] op_sel_hi:[1,0]
    v_pk_mul_f32 v[54:55], v[54:55], v[238:239] op_sel_hi:[1,0]
    v_pk_mul_f32 v[56:57], v[56:57], v[238:239] op_sel_hi:[1,0]
    v_pk_mul_f32 v[58:59], v[58:59], v[238:239] op_sel_hi:[1,0]
    v_cvt_pk_bf16_f32 v84, v44, v45
    v_cvt_pk_bf16_f32 v85, v46, v47
    v_cvt_pk_bf16_f32 v86, v48, v49
    v_cvt_pk_bf16_f32 v87, v50, v51
    v_cvt_pk_bf16_f32 v88, v52, v53
    v_cvt_pk_bf16_f32 v89, v54, v55
    v_cvt_pk_bf16_f32 v90, v56, v57
    v_cvt_pk_bf16_f32 v91, v58, v59
    v_and_b32 v90, v90, v231
    v_and_b32 v91, v91, v231
    buffer_store_dwordx4 v[84:87], v252, s[72:75], s11 offen offset:0 sc1
    buffer_store_dwordx4 v[88:91], v252, s[72:75], s11 offen offset:1024 sc1
    s_lshl_b32 s81, s12, 2
    s_add_u32 s81, s81, s5
    s_xor_b32 s82, s81, 4
    s_mul_i32 s81, s81, 28672
    s_mul_i32 s82, s82, 28672
    s_add_u32 s81, s81, 10747904
    s_add_u32 s82, s82, 10747904
    s_lshl_b32 s83, s12, 1
    s_add_u32 s83, s83, s7
    s_lshl_b32 s83, s83, 14
    s_add_u32 s83, s83, 8650752
    s_mov_b32 s77, 24576
    buffer_load_dword v239, v253, s[72:75], s77 offen sc1
    v_pk_mul_f32 v[222:223], v[180:181], v[180:181]
    ds_read_b64_tr_b16 a[200:201], v219 offset:55296
    ds_read_b64_tr_b16 a[202:203], v219 offset:52224
    ds_read_b64_tr_b16 a[204:205], v218 offset:55296
    ds_read_b64_tr_b16 a[206:207], v218 offset:52224
    s_add_u32 m0, s18, 86016
    s_add_u32 s78, s80, 0
    s_nop 0
    buffer_load_dwordx4 v246, s[44:47], s78 offen offset:0  lds
    v_pk_mul_f32 v[216:217], v[182:183], v[182:183]
    ds_read_b64_tr_b16 a[208:209], v219 offset:53248
    ds_read_b64_tr_b16 a[210:211], v219 offset:54272
    ds_read_b64_tr_b16 a[212:213], v218 offset:53248
    ds_read_b64_tr_b16 a[214:215], v218 offset:54272
    buffer_load_dwordx4 v244, s[44:47], s78 offen offset:1024  lds
    v_pk_fma_f32 v[222:223], v[222:223], v[136:137], v[136:137] op_sel:[0,1,0] op_sel_hi:[1,1,0]
    s_waitcnt vmcnt(18)
    s_nop 0
    ds_read_b64_tr_b16 a[216:217], v221 offset:2048
    ds_read_b64_tr_b16 a[218:219], v221 offset:3072
    ds_read_b64_tr_b16 a[220:221], v220 offset:2048
    ds_read_b64_tr_b16 a[222:223], v220 offset:3072
    buffer_load_dwordx4 v243, s[44:47], s78 offen offset:2048  lds
    v_pk_fma_f32 v[216:217], v[216:217], v[136:137], v[136:137] op_sel:[0,1,0] op_sel_hi:[1,1,0]
    s_waitcnt vmcnt(17)
    s_nop 0
    ds_read_b64_tr_b16 a[224:225], v221 offset:0
    ds_read_b64_tr_b16 a[226:227], v221 offset:1024
    ds_read_b64_tr_b16 a[228:229], v220 offset:0
    ds_read_b64_tr_b16 a[230:231], v220 offset:1024
    buffer_load_dwordx4 v242, s[44:47], s78 offen offset:3072  lds
    v_pk_mul_f32 v[222:223], v[222:223], v[180:181]
    s_add_u32 m0, s18, 90112
    s_add_u32 s78, s80, 28672
    buffer_load_dwordx4 v246, s[44:47], s78 offen offset:0  lds
    v_pk_mul_f32 v[216:217], v[216:217], v[182:183]
    buffer_load_dwordx4 v244, s[44:47], s78 offen offset:1024  lds
    v_exp_f32_e64 v222, v222
    buffer_load_dwordx4 v243, s[44:47], s78 offen offset:2048  lds
    v_exp_f32 v223, v223
    s_waitcnt vmcnt(11)
    ds_read_b64_tr_b16 a[232:233], v221 offset:4096
    ds_read_b64_tr_b16 a[234:235], v219 offset:49152
    ds_read_b64_tr_b16 a[236:237], v220 offset:4096
    ds_read_b64_tr_b16 a[238:239], v218 offset:49152
    s_add_u32 m0, s18, 115712
    s_nop 0
    buffer_load_dwordx4 v244, s[60:63], s19 offen offset:1024  lds
    v_exp_f32 v216, v216
    v_exp_f32_e64 v217, v217
    v_pk_fma_f32 v[222:223], v[222:223], v[138:139], v[138:139] op_sel_hi:[1,0,0]
    v_pk_fma_f32 v[216:217], v[216:217], v[138:139], v[138:139] op_sel_hi:[1,0,0]
    v_rcp_f32 v222, v222
    v_rcp_f32 v223, v223
    v_rcp_f32 v216, v216
    v_rcp_f32 v217, v217
    v_pk_mul_f32 v[222:223], v[222:223], v[180:181]
    v_pk_mul_f32 v[216:217], v[216:217], v[182:183]
    v_cvt_pk_bf16_f32 v28, v222, v223
    v_cvt_pk_bf16_f32 v29, v216, v217
    v_pk_mul_f32 v[222:223], v[184:185], v[184:185]
    v_pk_mul_f32 v[216:217], v[186:187], v[186:187]
    v_pk_fma_f32 v[222:223], v[222:223], v[136:137], v[136:137] op_sel:[0,1,0] op_sel_hi:[1,1,0]
    v_pk_fma_f32 v[216:217], v[216:217], v[136:137], v[136:137] op_sel:[0,1,0] op_sel_hi:[1,1,0]
    v_pk_mul_f32 v[222:223], v[222:223], v[184:185]
    v_pk_mul_f32 v[216:217], v[216:217], v[186:187]
    v_exp_f32 v222, v222
    v_exp_f32 v223, v223
    v_exp_f32 v216, v216
    v_exp_f32 v217, v217
    v_pk_fma_f32 v[222:223], v[222:223], v[138:139], v[138:139] op_sel_hi:[1,0,0]
    v_pk_fma_f32 v[216:217], v[216:217], v[138:139], v[138:139] op_sel_hi:[1,0,0]
    v_rcp_f32 v222, v222
    v_rcp_f32 v223, v223
    v_rcp_f32 v216, v216
    v_rcp_f32 v217, v217
    v_pk_mul_f32 v[222:223], v[222:223], v[184:185]
    v_pk_mul_f32 v[216:217], v[216:217], v[186:187]
    v_cvt_pk_bf16_f32 v30, v222, v223
    v_cvt_pk_bf16_f32 v31, v216, v217
    buffer_store_dwordx4 v[28:31], v252, s[72:75], s8 offen offset:0 sc1
    v_pk_mul_f32 v[222:223], v[188:189], v[188:189]
    v_pk_mul_f32 v[216:217], v[190:191], v[190:191]
    v_pk_fma_f32 v[222:223], v[222:223], v[136:137], v[136:137] op_sel:[0,1,0] op_sel_hi:[1,1,0]
    v_pk_fma_f32 v[216:217], v[216:217], v[136:137], v[136:137] op_sel:[0,1,0] op_sel_hi:[1,1,0]
    v_pk_mul_f32 v[222:223], v[222:223], v[188:189]
    v_pk_mul_f32 v[216:217], v[216:217], v[190:191]
    v_exp_f32 v222, v222
    v_exp_f32 v223, v223
    v_exp_f32 v216, v216
    v_exp_f32 v217, v217
    v_pk_fma_f32 v[222:223], v[222:223], v[138:139], v[138:139] op_sel_hi:[1,0,0]
    v_pk_fma_f32 v[216:217], v[216:217], v[138:139], v[138:139] op_sel_hi:[1,0,0]
    v_rcp_f32 v222, v222
    v_rcp_f32 v223, v223
    v_rcp_f32 v216, v216
    v_rcp_f32 v217, v217
    v_pk_mul_f32 v[222:223], v[222:223], v[188:189]
    v_pk_mul_f32 v[216:217], v[216:217], v[190:191]
    v_cvt_pk_bf16_f32 v32, v222, v223
    v_cvt_pk_bf16_f32 v33, v216, v217
    v_pk_mul_f32 v[222:223], v[192:193], v[192:193]
    v_pk_mul_f32 v[216:217], v[194:195], v[194:195]
    v_pk_fma_f32 v[222:223], v[222:223], v[136:137], v[136:137] op_sel:[0,1,0] op_sel_hi:[1,1,0]
    v_pk_fma_f32 v[216:217], v[216:217], v[136:137], v[136:137] op_sel:[0,1,0] op_sel_hi:[1,1,0]
    v_pk_mul_f32 v[222:223], v[222:223], v[192:193]
    v_pk_mul_f32 v[216:217], v[216:217], v[194:195]
    v_exp_f32 v222, v222
    v_exp_f32 v223, v223
    v_exp_f32 v216, v216
    v_exp_f32 v217, v217
    v_pk_fma_f32 v[222:223], v[222:223], v[138:139], v[138:139] op_sel_hi:[1,0,0]
    v_pk_fma_f32 v[216:217], v[216:217], v[138:139], v[138:139] op_sel_hi:[1,0,0]
    v_rcp_f32 v222, v222
    v_rcp_f32 v223, v223
    v_rcp_f32 v216, v216
    v_rcp_f32 v217, v217
    v_pk_mul_f32 v[222:223], v[222:223], v[192:193]
    v_pk_mul_f32 v[216:217], v[216:217], v[194:195]
    v_cvt_pk_bf16_f32 v34, v222, v223
    v_cvt_pk_bf16_f32 v35, v216, v217
    buffer_store_dwordx4 v[32:35], v252, s[72:75], s8 offen offset:1024 sc1
    s_waitcnt vmcnt(10)
    v_cmp_eq_u32 vcc, v239, v251
    s_nop 0
    s_cmp_eq_u64 vcc, -1
    s_cbranch_scc0 L_spin4
L_pok4:
    s_barrier
    s_add_u32 s77, s90, 24576
    buffer_store_dword v251, v250, s[72:75], s77 offen sc1
    s_cmp_eq_u32 s6, 0
    s_cselect_b32 s14, 0, 1
    s_lshl_b32 s14, s14, 12
    s_add_u32 s14, s14, s82
    buffer_load_dwordx4 a[144:147], v252, s[72:75], s14 offen offset:0 sc1
    buffer_load_dwordx4 a[148:151], v252, s[72:75], s14 offen offset:1024 sc1
    buffer_load_dwordx4 a[152:155], v252, s[72:75], s14 offen offset:2048 sc1
    buffer_load_dwordx4 a[156:159], v252, s[72:75], s14 offen offset:3072 sc1
    s_cmp_eq_u32 s6, 0
    s_cselect_b32 s14, 2, 3
    s_lshl_b32 s14, s14, 12
    s_add_u32 s14, s14, s82
    buffer_load_dwordx4 a[160:163], v252, s[72:75], s14 offen offset:0 sc1
    buffer_load_dwordx4 a[164:167], v252, s[72:75], s14 offen offset:1024 sc1
    v_pk_mul_f32 v[238:239], v[196:197], v[196:197]
    v_pk_mul_f32 v[222:223], v[198:199], v[198:199]
    v_pk_fma_f32 v[238:239], v[238:239], v[136:137], v[136:137] op_sel:[0,1,0] op_sel_hi:[1,1,0]
    v_pk_fma_f32 v[222:223], v[222:223], v[136:137], v[136:137] op_sel:[0,1,0] op_sel_hi:[1,1,0]
    v_pk_mul_f32 v[238:239], v[238:239], v[196:197]
    v_pk_mul_f32 v[222:223], v[222:223], v[198:199]
    v_exp_f32 v238, v238
    v_exp_f32 v239, v239
    v_exp_f32 v222, v222
    v_exp_f32 v223, v223
    v_pk_fma_f32 v[238:239], v[238:239], v[138:139], v[138:139] op_sel_hi:[1,0,0]
    v_pk_fma_f32 v[222:223], v[222:223], v[138:139], v[138:139] op_sel_hi:[1,0,0]
    v_rcp_f32 v238, v238
    v_rcp_f32 v239, v239
    v_rcp_f32_e64 v222, v222
    s_add_u32 m0, s18, 3072
    s_nop 0
    buffer_load_dwordx4 v243, s[60:63], s19 offen offset:2048  lds
    v_rcp_f32 v223, v223
    v_pk_mul_f32 v[238:239], v[238:239], v[196:197]
    v_pk_mul_f32 v[222:223], v[222:223], v[198:199]
    v_cvt_pk_bf16_f32 v36, v238, v239
    v_cvt_pk_bf16_f32 v37, v222, v223
    v_pk_mul_f32 v[238:239], v[200:201], v[200:201]
    v_pk_mul_f32 v[222:223], v[202:203], v[202:203]
    v_pk_fma_f32 v[238:239], v[238:239], v[136:137], v[136:137] op_sel:[0,1,0] op_sel_hi:[1,1,0]
    v_pk_fma_f32 v[222:223], v[222:223], v[136:137], v[136:137] op_sel:[0,1,0] op_sel_hi:[1,1,0]
    v_pk_mul_f32 v[238:239], v[238:239], v[200:201]
    v_pk_mul_f32 v[222:223], v[222:223], v[202:203]
    v_exp_f32_e64 v238, v238
    buffer_load_dwordx4 v242, s[60:63], s19 offen offset:3072  lds
    v_exp_f32 v239, v239
    v_exp_f32 v222, v222
    v_exp_f32_e64 v223, v223
    v_pk_fma_f32 v[238:239], v[238:239], v[138:139], v[138:139] op_sel_hi:[1,0,0]
    v_pk_fma_f32 v[222:223], v[222:223], v[138:139], v[138:139] op_sel_hi:[1,0,0]
    v_rcp_f32 v238, v238
    v_rcp_f32 v239, v239
    v_rcp_f32 v222, v222
    v_rcp_f32 v223, v223
    s_add_u32 s84, s84, 114688
    s_cmp_ge_u32 s84, s86
    s_cselect_b32 s89, 401408, 0
    s_sub_u32 s84, s84, s89
    s_add_u32 m0, s18, 28672
    s_add_u32 s19, s84, 0
    s_nop 0
    buffer_load_dwordx4 v246, s[60:63], s19 offen offset:0  lds
    v_pk_mul_f32 v[238:239], v[238:239], v[200:201]
    v_pk_mul_f32 v[222:223], v[222:223], v[202:203]
    v_cvt_pk_bf16_f32 v38, v238, v239
    v_cvt_pk_bf16_f32 v39, v222, v223
    buffer_store_dwordx4 v[36:39], v252, s[72:75], s10 offen offset:0 sc1
    v_pk_mul_f32 v[238:239], v[204:205], v[204:205]
    v_pk_mul_f32 v[222:223], v[206:207], v[206:207]
    v_pk_fma_f32 v[238:239], v[238:239], v[136:137], v[136:137] op_sel:[0,1,0] op_sel_hi:[1,1,0]
    v_pk_fma_f32 v[222:223], v[222:223], v[136:137], v[136:137] op_sel:[0,1,0] op_sel_hi:[1,1,0]
    v_pk_mul_f32 v[238:239], v[238:239], v[204:205]
    v_pk_mul_f32 v[222:223], v[222:223], v[206:207]
    v_exp_f32 v238, v238
    v_exp_f32 v239, v239
    v_exp_f32 v222, v222
    v_exp_f32 v223, v223
    v_pk_fma_f32 v[238:239], v[238:239], v[138:139], v[138:139] op_sel_hi:[1,0,0]
    v_pk_fma_f32 v[222:223], v[222:223], v[138:139], v[138:139] op_sel_hi:[1,0,0]
    v_rcp_f32 v238, v238
    v_rcp_f32 v239, v239
    s_waitcnt vmcnt(13)
    ds_read_b64_tr_b16 a[240:241], v219 offset:50176
    ds_read_b64_tr_b16 a[242:243], v219 offset:51200
    ds_read_b64_tr_b16 a[244:245], v218 offset:50176
    ds_read_b64_tr_b16 a[246:247], v218 offset:51200
    v_rcp_f32 v222, v222
    v_rcp_f32_e64 v223, v223
    buffer_load_dwordx4 v244, s[60:63], s19 offen offset:1024  lds
    v_pk_mul_f32 v[238:239], v[238:239], v[204:205]
    v_pk_mul_f32 v[222:223], v[222:223], v[206:207]
    v_cvt_pk_bf16_f32 v40, v238, v239
    v_cvt_pk_bf16_f32 v41, v222, v223
    v_pk_mul_f32 v[238:239], v[208:209], v[208:209]
    v_pk_mul_f32 v[222:223], v[210:211], v[210:211]
    v_pk_fma_f32 v[238:239], v[238:239], v[136:137], v[136:137] op_sel:[0,1,0] op_sel_hi:[1,1,0]
    v_pk_fma_f32 v[222:223], v[222:223], v[136:137], v[136:137] op_sel:[0,1,0] op_sel_hi:[1,1,0]
    v_pk_mul_f32 v[238:239], v[238:239], v[208:209]
    v_pk_mul_f32 v[222:223], v[222:223], v[210:211]
    v_exp_f32_e64 v238, v238
    buffer_load_dwordx4 v243, s[60:63], s19 offen offset:2048  lds
    v_exp_f32 v239, v239
    v_exp_f32 v222, v222
    v_exp_f32_e64 v223, v223
    v_pk_fma_f32 v[238:239], v[238:239], v[138:139], v[138:139] op_sel_hi:[1,0,0]
    v_pk_fma_f32 v[222:223], v[222:223], v[138:139], v[138:139] op_sel_hi:[1,0,0]
    v_rcp_f32 v238, v238
    v_rcp_f32 v239, v239
    v_rcp_f32_e64 v222, v222
    buffer_load_dwordx4 v242, s[60:63], s19 offen offset:3072  lds
    v_rcp_f32_e64 v223, v223
    v_pk_mul_f32 v[238:239], v[238:239], v[208:209]
    v_pk_mul_f32 v[222:223], v[222:223], v[210:211]
    v_cvt_pk_bf16_f32 v42, v238, v239
    v_cvt_pk_bf16_f32 v43, v222, v223
    buffer_store_dwordx4 v[40:43], v252, s[72:75], s10 offen offset:1024 sc1
    s_waitcnt vmcnt(13)
    v_mfma_f32_32x32x16_bf16 v[180:195], a[120:123], a[144:147], 0
    buffer_load_dwordx4 a[168:171], v252, s[72:75], s14 offen offset:2048 sc1
    s_cmp_eq_u32 s7, s91
    s_mov_b32 s17, 86016
    s_cselect_b32 s17, 57344, s17
    v_add_u32 v222, s17, v230
    v_add_u32 v217, s17, v229
    v_mfma_f32_32x32x16_bf16 v[196:211], a[124:127], a[144:147], 0
    v_and_b32 v216, 32, v1
    v_lshlrev_b32 v216, 4, v216
    v_sub_u32 v215, v217, v216
    v_sub_u32 v216, v222, v216
    v_add_u32 v239, s18, v252
    s_waitcnt vmcnt(13)
    v_mfma_f32_32x32x16_bf16 v[180:195], a[128:131], a[148:151], v[180:195]
    s_xor_b32 s15, s5, 2
    s_mul_i32 s15, s15, 7168
    v_add_u32 v238, s15, v252
    s_xor_b32 s15, s5, 1
    s_mul_i32 s15, s15, 7168
    v_add_u32 v228, s15, v252
    v_mfma_f32_32x32x16_bf16 v[196:211], a[132:135], a[148:151], v[196:211]
    buffer_load_dwordx4 a[172:175], v252, s[72:75], s14 offen offset:3072 sc1
    s_xor_b32 s15, s5, 3
    s_mul_i32 s15, s15, 7168
    v_add_u32 v223, s15, v252
    v_lshlrev_b32 v76, 16, v156
    s_waitcnt vmcnt(13)
    v_mfma_f32_32x32x16_bf16 v[180:195], a[136:139], a[152:155], v[180:195]
    v_and_b32 v77, 0xffff0000, v156
    v_lshlrev_b32_e64 v78, 16, v157
    v_and_b32 v79, 0xffff0000, v157
    v_lshlrev_b32_e64 v80, 16, v158
    v_and_b32 v81, 0xffff0000, v158
    v_lshlrev_b32_e64 v82, 16, v159
    v_mfma_f32_32x32x16_bf16 v[196:211], a[140:143], a[152:155], v[196:211]
    s_cmp_eq_u32 s6, 0
    s_cselect_b32 s14, 4, 5
    s_lshl_b32 s14, s14, 12
    s_add_u32 s14, s14, s82
    buffer_load_dwordx4 a[176:179], v252, s[72:75], s14 offen offset:0 sc1
    s_waitcnt vmcnt(13)
    v_mfma_f32_32x32x16_bf16 v[180:195], a[0:3], a[156:159], v[180:195]
    v_and_b32 v83, 0xffff0000, v159
    v_lshlrev_b32 v84, 16, v160
    v_and_b32 v85, 0xffff0000, v160
    v_lshlrev_b32_e64 v86, 16, v161
    v_and_b32 v87, 0xffff0000, v161
    v_lshlrev_b32_e64 v88, 16, v162
    v_mfma_f32_32x32x16_bf16 v[196:211], a[4:7], a[156:159], v[196:211]
    v_and_b32 v89, 0xffff0000, v162
    v_lshlrev_b32_e64 v90, 16, v163
    v_and_b32 v91, 0xffff0000, v163
    s_waitcnt vmcnt(12)
    v_mfma_f32_32x32x16_bf16 v[180:195], a[8:11], a[160:163], v[180:195]
    buffer_load_dwordx4 a[180:183], v252, s[72:75], s14 offen offset:1024 sc1
    v_mfma_f32_32x32x16_bf16 v[196:211], a[12:15], a[160:163], v[196:211]
    s_waitcnt vmcnt(12)
    v_mfma_f32_32x32x16_bf16 v[180:195], a[16:19], a[164:167], v[180:195]
    buffer_load_dwordx4 a[184:187], v252, s[72:75], s14 offen offset:2048 sc1
    v_mfma_f32_32x32x16_bf16 v[196:211], a[20:23], a[164:167], v[196:211]
    s_waitcnt vmcnt(4)
    v_mfma_f32_32x32x16_bf16 v[180:195], a[24:27], a[168:171], v[180:195]
    buffer_load_dwordx4 a[188:191], v252, s[72:75], s14 offen offset:3072 sc1
    s_cmp_eq_u32 s6, 0
    s_cselect_b32 s14, 0, 1
    s_lshl_b32 s14, s14, 12
    s_add_u32 s14, s14, s81
    s_nop 0
    buffer_load_dwordx4 a[192:195], v252, s[72:75], s14 offen offset:0 sc1
    v_mfma_f32_32x32x16_bf16 v[196:211], a[28:31], a[168:171], v[196:211]
    buffer_load_dwordx4 a[196:199], v252, s[72:75], s14 offen offset:1024 sc1
    buffer_load_dwordx4 a[144:147], v252, s[72:75], s14 offen offset:2048 sc1
    ds_read_b64_tr_b16 a[248:249], v221 offset:5120
    ds_read_b64_tr_b16 a[250:251], v221 offset:6144
    s_waitcnt vmcnt(7)
    v_mfma_f32_32x32x16_bf16 v[180:195], a[32:35], a[172:175], v[180:195]
    s_barrier
    s_add_u32 s77, s90, 0
    buffer_store_dword v251, v250, s[72:75], s77 offen sc1
    buffer_load_dwordx4 a[148:151], v252, s[72:75], s14 offen offset:3072 sc1
    s_cmp_eq_u32 s6, 0
    s_cselect_b32 s14, 2, 3
    s_lshl_b32 s14, s14, 12
    s_add_u32 s14, s14, s81
    s_nop 0
    buffer_load_dwordx4 a[152:155], v252, s[72:75], s14 offen offset:0 sc1
    v_mfma_f32_32x32x16_bf16 v[196:211], a[36:39], a[172:175], v[196:211]
    buffer_load_dwordx4 a[156:159], v252, s[72:75], s14 offen offset:1024 sc1
    buffer_load_dwordx4 a[160:163], v252, s[72:75], s14 offen offset:2048 sc1
    ds_read_b64_tr_b16 a[252:253], v220 offset:5120
    ds_read_b64_tr_b16 a[254:255], v220 offset:6144
    s_waitcnt vmcnt(11)
    s_nop 0
    v_mfma_f32_32x32x16_bf16 v[180:195], a[40:43], a[176:179], v[180:195]
    s_mov_b32 s77, 28672
    buffer_load_dword v214, v255, s[72:75], s77 offen sc1
    buffer_load_dwordx4 a[164:167], v252, s[72:75], s14 offen offset:3072 sc1
    v_mfma_f32_32x32x16_bf16 v[196:211], a[44:47], a[176:179], v[196:211]
    s_waitcnt vmcnt(12)
    v_mfma_f32_32x32x16_bf16 v[180:195], a[48:51], a[180:183], v[180:195]
    v_mfma_f32_32x32x16_bf16 v[196:211], a[52:55], a[180:183], v[196:211]
    s_waitcnt vmcnt(11)
    v_mfma_f32_32x32x16_bf16 v[180:195], a[56:59], a[184:187], v[180:195]
    v_mfma_f32_32x32x16_bf16 v[196:211], a[60:63], a[184:187], v[196:211]
    s_waitcnt vmcnt(10)
    v_mfma_f32_32x32x16_bf16 v[180:195], a[64:67], a[188:191], v[180:195]
    s_cmp_eq_u32 s6, 0
    s_cselect_b32 s14, 4, 5
    s_lshl_b32 s14, s14, 12
    s_add_u32 s14, s14, s81
    buffer_load_dwordx4 a[168:171], v252, s[72:75], s14 offen offset:0 sc1
    v_mfma_f32_32x32x16_bf16 v[196:211], a[68:71], a[188:191], v[196:211]
    s_waitcnt vmcnt(10)
    v_mfma_f32_32x32x16_bf16 v[44:59], a[120:123], a[192:195], 0
    buffer_load_dwordx4 a[172:175], v252, s[72:75], s14 offen offset:1024 sc1
    v_mfma_f32_32x32x16_bf16 v[100:115], a[124:127], a[192:195], 0
    s_waitcnt vmcnt(10)
    v_mfma_f32_32x32x16_bf16 v[44:59], a[128:131], a[196:199], v[44:59]
    buffer_load_dwordx4 a[176:179], v252, s[72:75], s14 offen offset:2048 sc1
    v_mfma_f32_32x32x16_bf16 v[100:115], a[132:135], a[196:199], v[100:115]
    s_waitcnt vmcnt(10)
    v_mfma_f32_32x32x16_bf16 v[44:59], a[136:139], a[144:147], v[44:59]
    buffer_load_dwordx4 a[180:183], v252, s[72:75], s14 offen offset:3072 sc1
    v_mfma_f32_32x32x16_bf16 v[100:115], a[140:143], a[144:147], v[100:115]
    s_waitcnt vmcnt(9)
    s_nop 0
    v_mfma_f32_32x32x16_bf16 v[44:59], a[0:3], a[148:151], v[44:59]
    s_add_u32 m0, s18, 32768
    s_add_u32 s19, s84, 28672
    buffer_load_dwordx4 v246, s[60:63], s19 offen offset:0  lds
    v_mfma_f32_32x32x16_bf16 v[100:115], a[4:7], a[148:151], v[100:115]
    s_waitcnt vmcnt(9)
    v_mfma_f32_32x32x16_bf16 v[44:59], a[8:11], a[152:155], v[44:59]
    buffer_load_dwordx4 v244, s[60:63], s19 offen offset:1024  lds
    v_mfma_f32_32x32x16_bf16 v[100:115], a[12:15], a[152:155], v[100:115]
    s_waitcnt vmcnt(9)
    v_mfma_f32_32x32x16_bf16 v[44:59], a[16:19], a[156:159], v[44:59]
    s_waitcnt vmcnt(7)
    v_cmp_eq_u32 vcc, v214, v251
    s_nop 0
    s_cmp_eq_u64 vcc, -1
    s_cbranch_scc0 L_spin5
L_pok5:
    s_nop 0
    buffer_load_dwordx4 a[184:187], v252, s[72:75], s83 offen offset:0 sc1
    buffer_load_dwordx4 a[188:191], v252, s[72:75], s83 offen offset:1024 sc1
    v_mfma_f32_32x32x16_bf16 v[100:115], a[20:23], a[156:159], v[100:115]
    buffer_load_dwordx4 a[192:195], v252, s[72:75], s83 offen offset:2048 sc1
    v_mfma_f32_32x32x16_bf16 v[44:59], a[24:27], a[160:163], v[44:59]
    buffer_load_dwordx4 a[196:199], v252, s[72:75], s83 offen offset:3072 sc1
    v_mfma_f32_32x32x16_bf16 v[100:115], a[28:31], a[160:163], v[100:115]
    s_waitcnt vmcnt(10)
    v_mfma_f32_32x32x16_bf16 v[44:59], a[32:35], a[164:167], v[44:59]
    s_add_u32 s83, s83, 4096
    buffer_load_dwordx4 a[144:147], v252, s[72:75], s83 offen offset:0 sc1
    v_mfma_f32_32x32x16_bf16 v[100:115], a[36:39], a[164:167], v[100:115]
    s_waitcnt vmcnt(10)
    v_mfma_f32_32x32x16_bf16 v[44:59], a[40:43], a[168:171], v[44:59]
    buffer_load_dwordx4 a[148:151], v252, s[72:75], s83 offen offset:1024 sc1
    v_mfma_f32_32x32x16_bf16 v[100:115], a[44:47], a[168:171], v[100:115]
    s_waitcnt vmcnt(10)
    s_nop 0
    v_mfma_f32_32x32x16_bf16 v[44:59], a[48:51], a[172:175], v[44:59]
    ds_read_b64_tr_b16 v[12:13], v222 offset:0
    ds_read_b64_tr_b16 v[14:15], v222 offset:1024
    buffer_load_dwordx4 a[152:155], v252, s[72:75], s83 offen offset:2048 sc1
    v_mfma_f32_32x32x16_bf16 v[100:115], a[52:55], a[172:175], v[100:115]
    ds_read_b64_tr_b16 v[16:17], v217 offset:0
    ds_read_b64_tr_b16 v[18:19], v217 offset:1024
    s_waitcnt vmcnt(10)
    s_nop 0
    v_mfma_f32_32x32x16_bf16 v[44:59], a[56:59], a[176:179], v[44:59]
    ds_read_b64_tr_b16 v[20:21], v222 offset:2048
    ds_read_b64_tr_b16 v[22:23], v216 offset:3072
    v_mfma_f32_32x32x16_bf16 v[100:115], a[60:63], a[176:179], v[100:115]
    ds_read_b64_tr_b16 v[24:25], v217 offset:2048
    ds_read_b64_tr_b16 v[26:27], v215 offset:3072
    buffer_load_dwordx4 a[156:159], v252, s[72:75], s83 offen offset:3072 sc1
    s_waitcnt vmcnt(10)
    s_nop 0
    v_mfma_f32_32x32x16_bf16 v[44:59], a[64:67], a[180:183], v[44:59]
    ds_read_b64_tr_b16 v[28:29], v222 offset:3584
    ds_read_b64_tr_b16 v[30:31], v222 offset:4608
    v_mfma_f32_32x32x16_bf16 v[100:115], a[68:71], a[180:183], v[100:115]
    ds_read_b64_tr_b16 v[32:33], v217 offset:3584
    ds_read_b64_tr_b16 v[34:35], v217 offset:4608
    s_add_u32 s83, s83, 4096
    buffer_load_dwordx4 a[160:163], v252, s[72:75], s83 offen offset:0 sc1
    s_waitcnt vmcnt(8) lgkmcnt(8)
    s_nop 0
    v_mfma_f32_32x32x16_bf16 v[164:179], v[12:15], a[184:187], 0
    ds_read_b64_tr_b16 v[36:37], v222 offset:5632
    ds_read_b64_tr_b16 v[38:39], v216 offset:6656
    s_mov_b32 s77, 4096
    buffer_load_dword v214, v253, s[72:75], s77 offen sc1
    buffer_load_dwordx4 a[164:167], v252, s[72:75], s83 offen offset:1024 sc1
    v_mfma_f32_32x32x16_bf16 v[116:131], v[16:19], a[184:187], 0
    ds_read_b64_tr_b16 v[40:41], v217 offset:5632
    ds_read_b64_tr_b16 v[42:43], v215 offset:6656
    buffer_load_dwordx4 v243, s[60:63], s19 offen offset:2048  lds
    s_waitcnt vmcnt(10) lgkmcnt(8)
    s_nop 0
    v_mfma_f32_32x32x16_bf16 v[164:179], v[20:23], a[188:191], v[164:179]
    ds_read_b64_tr_b16 v[12:13], v222 offset:7168
    ds_read_b64_tr_b16 v[14:15], v222 offset:8192
    v_mfma_f32_32x32x16_bf16 v[116:131], v[24:27], a[188:191], v[116:131]
    ds_read_b64_tr_b16 v[16:17], v217 offset:7168
    ds_read_b64_tr_b16 v[18:19], v217 offset:8192
    s_add_u32 m0, s18, 111616
    s_nop 0
    buffer_load_dwordx4 v242, s[60:63], s19 offen offset:3072  lds
    s_waitcnt vmcnt(10) lgkmcnt(8)
    v_mfma_f32_32x32x16_bf16 v[164:179], v[28:31], a[192:195], v[164:179]
    ds_read_b64_tr_b16 v[20:21], v222 offset:9216
    ds_read_b64_tr_b16 v[22:23], v216 offset:10240
    v_mfma_f32_32x32x16_bf16 v[116:131], v[32:35], a[192:195], v[116:131]
    ds_read_b64_tr_b16 v[24:25], v217 offset:9216
    ds_read_b64_tr_b16 v[26:27], v215 offset:10240
    s_waitcnt vmcnt(9) lgkmcnt(8)
    s_nop 0
    v_mfma_f32_32x32x16_bf16 v[164:179], v[36:39], a[196:199], v[164:179]
    ds_read_b64_tr_b16 v[28:29], v222 offset:10752
    ds_read_b64_tr_b16 v[30:31], v222 offset:11776
    buffer_load_dwordx4 a[168:171], v252, s[72:75], s83 offen offset:2048 sc1
    v_mfma_f32_32x32x16_bf16 v[116:131], v[40:43], a[196:199], v[116:131]
    ds_read_b64_tr_b16 v[32:33], v217 offset:10752
    ds_read_b64_tr_b16 v[34:35], v217 offset:11776
    s_waitcnt vmcnt(9) lgkmcnt(8)
    s_nop 0
    v_mfma_f32_32x32x16_bf16 v[164:179], v[12:15], a[144:147], v[164:179]
    ds_read_b64_tr_b16 v[36:37], v222 offset:12800
    ds_read_b64_tr_b16 v[38:39], v216 offset:13824
    buffer_load_dwordx4 a[172:175], v252, s[72:75], s83 offen offset:3072 sc1
    v_mfma_f32_32x32x16_bf16 v[116:131], v[16:19], a[144:147], v[116:131]
    ds_read_b64_tr_b16 v[40:41], v217 offset:12800
    ds_read_b64_tr_b16 v[42:43], v215 offset:13824
    s_waitcnt vmcnt(9) lgkmcnt(8)
    s_nop 0
    v_mfma_f32_32x32x16_bf16 v[164:179], v[20:23], a[148:151], v[164:179]
    ds_read_b64_tr_b16 v[12:13], v222 offset:14336
    ds_read_b64_tr_b16 v[14:15], v222 offset:15360
    s_add_u32 s83, s83, 4096
    buffer_load_dwordx4 a[176:179], v252, s[72:75], s83 offen offset:0 sc1
    v_mfma_f32_32x32x16_bf16 v[116:131], v[24:27], a[148:151], v[116:131]
    ds_read_b64_tr_b16 v[16:17], v217 offset:14336
    ds_read_b64_tr_b16 v[18:19], v217 offset:15360
    s_waitcnt vmcnt(9) lgkmcnt(8)
    s_nop 0
    v_mfma_f32_32x32x16_bf16 v[164:179], v[28:31], a[152:155], v[164:179]
    ds_read_b64_tr_b16 v[20:21], v222 offset:16384
    ds_read_b64_tr_b16 v[22:23], v216 offset:17408
    buffer_load_dwordx4 a[180:183], v252, s[72:75], s83 offen offset:1024 sc1
    v_mfma_f32_32x32x16_bf16 v[116:131], v[32:35], a[152:155], v[116:131]
    ds_read_b64_tr_b16 v[24:25], v217 offset:16384
    ds_read_b64_tr_b16 v[26:27], v215 offset:17408
    s_waitcnt vmcnt(9) lgkmcnt(8)
    s_nop 0
    v_mfma_f32_32x32x16_bf16 v[164:179], v[36:39], a[156:159], v[164:179]
    ds_read_b64_tr_b16 v[28:29], v222 offset:17920
    ds_read_b64_tr_b16 v[30:31], v222 offset:18944
    buffer_load_dwordx4 a[184:187], v252, s[72:75], s83 offen offset:2048 sc1
    v_mfma_f32_32x32x16_bf16 v[116:131], v[40:43], a[156:159], v[116:131]
    ds_read_b64_tr_b16 v[32:33], v217 offset:17920
    ds_read_b64_tr_b16 v[34:35], v217 offset:18944
    s_waitcnt vmcnt(9) lgkmcnt(8)
    s_nop 0
    v_mfma_f32_32x32x16_bf16 v[164:179], v[12:15], a[160:163], v[164:179]
    ds_read_b64_tr_b16 v[36:37], v222 offset:19968
    ds_read_b64_tr_b16 v[38:39], v216 offset:20992
    buffer_load_dwordx4 a[188:191], v252, s[72:75], s83 offen offset:3072 sc1
    v_mfma_f32_32x32x16_bf16 v[116:131], v[16:19], a[160:163], v[116:131]
    ds_read_b64_tr_b16 v[40:41], v217 offset:19968
    ds_read_b64_tr_b16 v[42:43], v215 offset:20992
    s_waitcnt vmcnt(8) lgkmcnt(8)
    v_mfma_f32_32x32x16_bf16 v[164:179], v[20:23], a[164:167], v[164:179]
    ds_read_b64_tr_b16 v[12:13], v222 offset:21504
    ds_read_b64_tr_b16 v[14:15], v222 offset:22528
    v_cmp_eq_u32 vcc, v214, v251
    s_nop 0
    s_cmp_eq_u64 vcc, -1
    s_cbranch_scc0 L_spin6
L_pok6:
    s_cmp_eq_u32 s6, 0
    s_cselect_b32 s14, 6, 0
    s_lshl_b32 s14, s14, 12
    s_add_u32 s14, s14, s82
    s_nop 0
    buffer_load_dwordx4 a[192:195], v252, s[72:75], s14 offen offset:0 sc1
    buffer_load_dwordx4 a[196:199], v252, s[72:75], s14 offen offset:1024 sc1
    v_mfma_f32_32x32x16_bf16 v[116:131], v[24:27], a[164:167], v[116:131]
    ds_read_b64_tr_b16 v[16:17], v217 offset:21504
    ds_read_b64_tr_b16 v[18:19], v217 offset:22528
    buffer_load_dwordx4 a[144:147], v252, s[72:75], s14 offen offset:2048 sc1
    s_waitcnt vmcnt(8) lgkmcnt(8)
    v_mfma_f32_32x32x16_bf16 v[164:179], v[28:31], a[168:171], v[164:179]
    ds_read_b64_tr_b16 v[20:21], v222 offset:23552
    ds_read_b64_tr_b16 v[22:23], v216 offset:24576
    buffer_load_dwordx4 a[148:151], v252, s[72:75], s14 offen offset:3072 sc1
    s_cmp_eq_u32 s6, 0
    s_cselect_b32 s14, 1, 2
    s_lshl_b32 s14, s14, 12
    s_add_u32 s14, s14, s82
    buffer_load_dwordx4 a[152:155], v252, s[72:75], s14 offen offset:0 sc1
    v_mfma_f32_32x32x16_bf16 v[116:131], v[32:35], a[168:171], v[116:131]
    ds_read_b64_tr_b16 v[24:25], v217 offset:23552
    ds_read_b64_tr_b16 v[26:27], v215 offset:24576
    s_waitcnt vmcnt(9) lgkmcnt(8)
    v_mfma_f32_32x32x16_bf16 v[164:179], v[36:39], a[172:175], v[164:179]
    ds_read_b64_tr_b16 v[28:29], v222 offset:25088
    ds_read_b64_tr_b16 v[30:31], v222 offset:26112
    buffer_load_dwordx4 a[156:159], v252, s[72:75], s14 offen offset:1024 sc1
    v_mfma_f32_32x32x16_bf16 v[116:131], v[40:43], a[172:175], v[116:131]
    ds_read_b64_tr_b16 v[32:33], v217 offset:25088
    ds_read_b64_tr_b16 v[34:35], v217 offset:26112
    s_waitcnt vmcnt(9) lgkmcnt(8)
    s_nop 0
    v_mfma_f32_32x32x16_bf16 v[164:179], v[12:15], a[176:179], v[164:179]
    ds_read_b64_tr_b16 v[36:37], v222 offset:27136
    ds_read_b64_tr_b16 v[38:39], v216 offset:28160
    buffer_load_dwordx4 a[160:163], v252, s[72:75], s14 offen offset:2048 sc1
    v_mfma_f32_32x32x16_bf16 v[116:131], v[16:19], a[176:179], v[116:131]
    ds_read_b64_tr_b16 v[40:41], v217 offset:27136
    ds_read_b64_tr_b16 v[42:43], v215 offset:28160
    s_waitcnt vmcnt(9) lgkmcnt(8)
    v_mfma_f32_32x32x16_bf16 v[164:179], v[20:23], a[180:183], v[164:179]
    buffer_load_dwordx4 a[164:167], v252, s[72:75], s14 offen offset:3072 sc1
    v_mfma_f32_32x32x16_bf16 v[116:131], v[24:27], a[180:183], v[116:131]
    s_waitcnt vmcnt(9) lgkmcnt(4)
    v_mfma_f32_32x32x16_bf16 v[164:179], v[28:31], a[184:187], v[164:179]
    s_cmp_eq_u32 s6, 0
    s_cselect_b32 s14, 3, 4
    s_lshl_b32 s14, s14, 12
    s_add_u32 s14, s14, s82
    buffer_load_dwordx4 a[168:171], v252, s[72:75], s14 offen offset:0 sc1
    v_mfma_f32_32x32x16_bf16 v[116:131], v[32:35], a[184:187], v[116:131]
    s_waitcnt vmcnt(9) lgkmcnt(0)
    v_mfma_f32_32x32x16_bf16 v[164:179], v[36:39], a[188:191], v[164:179]
    buffer_load_dwordx4 a[172:175], v252, s[72:75], s14 offen offset:1024 sc1
    v_mfma_f32_32x32x16_bf16 v[116:131], v[40:43], a[188:191], v[116:131]
    s_waitcnt vmcnt(9)
    v_mfma_f32_32x32x16_bf16 v[180:195], a[72:75], a[192:195], v[180:195]
    buffer_load_dwordx4 a[176:179], v252, s[72:75], s14 offen offset:2048 sc1
    v_mfma_f32_32x32x16_bf16 v[196:211], a[76:79], a[192:195], v[196:211]
    s_waitcnt vmcnt(9)
    v_mfma_f32_32x32x16_bf16 v[180:195], a[80:83], a[196:199], v[180:195]
    buffer_load_dwordx4 a[180:183], v252, s[72:75], s14 offen offset:3072 sc1
    s_nop 4
    ds_write_b128 v249, v[116:119] offset:0
    v_mfma_f32_32x32x16_bf16 v[196:211], a[84:87], a[196:199], v[196:211]
    s_cmp_eq_u32 s6, 0
    s_cselect_b32 s14, 5, 6
    s_lshl_b32 s14, s14, 12
    s_add_u32 s14, s14, s82
    buffer_load_dwordx4 a[184:187], v252, s[72:75], s14 offen offset:0 sc1
    s_waitcnt vmcnt(10)
    v_mfma_f32_32x32x16_bf16 v[180:195], a[88:91], a[144:147], v[180:195]
    ds_write_b128 v249, v[120:123] offset:1024
    v_mfma_f32_32x32x16_bf16 v[196:211], a[92:95], a[144:147], v[196:211]
    buffer_load_dwordx4 a[188:191], v252, s[72:75], s14 offen offset:1024 sc1
    s_waitcnt vmcnt(10)
    v_mfma_f32_32x32x16_bf16 v[180:195], a[96:99], a[148:151], v[180:195]
    ds_write_b128 v249, v[124:127] offset:2048
    v_mfma_f32_32x32x16_bf16 v[196:211], a[100:103], a[148:151], v[196:211]
    buffer_load_dwordx4 a[192:195], v252, s[72:75], s14 offen offset:2048 sc1
    s_waitcnt vmcnt(10)
    v_mfma_f32_32x32x16_bf16 v[180:195], a[104:107], a[152:155], v[180:195]
    ds_write_b128 v249, v[128:131] offset:3072
    v_mfma_f32_32x32x16_bf16 v[196:211], a[108:111], a[152:155], v[196:211]
    buffer_load_dwordx4 a[196:199], v252, s[72:75], s14 offen offset:3072 sc1
    s_waitcnt lgkmcnt(0)
    s_barrier
    ds_read_b128 v[116:119], v247 offset:0
    ds_read_b128 v[120:123], v247 offset:1024
    ds_read_b128 v[124:127], v247 offset:2048
    ds_read_b128 v[128:131], v247 offset:3072
    s_waitcnt vmcnt(10)
    v_mfma_f32_32x32x16_bf16 v[180:195], a[200:203], a[156:159], v[180:195]
    s_cmp_eq_u32 s6, 0
    s_cselect_b32 s14, 6, 0
    s_lshl_b32 s14, s14, 12
    s_add_u32 s14, s14, s81
    buffer_load_dwordx4 a[144:147], v252, s[72:75], s14 offen offset:0 sc1
    buffer_load_dwordx4 a[148:151], v252, s[72:75], s14 offen offset:1024 sc1
    v_mfma_f32_32x32x16_bf16 v[196:211], a[204:207], a[156:159], v[196:211]
    s_waitcnt vmcnt(11)
    v_mfma_f32_32x32x16_bf16 v[180:195], a[208:211], a[160:163], v[180:195]
    v_mfma_f32_32x32x16_bf16 v[196:211], a[212:215], a[160:163], v[196:211]
    buffer_load_dwordx4 a[152:155], v252, s[72:75], s14 offen offset:2048 sc1
    s_waitcnt vmcnt(11)
    v_mfma_f32_32x32x16_bf16 v[180:195], a[216:219], a[164:167], v[180:195]
    v_mfma_f32_32x32x16_bf16 v[196:211], a[220:223], a[164:167], v[196:211]
    buffer_load_dwordx4 a[156:159], v252, s[72:75], s14 offen offset:3072 sc1
    s_waitcnt lgkmcnt(0)
    v_add_f32 v164, v164, v116
    v_add_f32 v165, v165, v117
    v_add_f32 v166, v166, v118
    s_waitcnt vmcnt(11)
    v_mfma_f32_32x32x16_bf16 v[180:195], a[224:227], a[168:171], v[180:195]
    v_add_f32 v167, v167, v119
    v_add_f32 v168, v168, v120
    v_add_f32 v169, v169, v121
    v_add_f32 v170, v170, v122
    v_add_f32 v171, v171, v123
    v_add_f32_e64 v172, v172, v124
    v_mfma_f32_32x32x16_bf16 v[196:211], a[228:231], a[168:171], v[196:211]
    s_cmp_eq_u32 s6, 0
    s_cselect_b32 s14, 1, 2
    s_lshl_b32 s14, s14, 12
    s_add_u32 s14, s14, s81
    buffer_load_dwordx4 a[160:163], v252, s[72:75], s14 offen offset:0 sc1
    s_waitcnt vmcnt(11)
    v_mfma_f32_32x32x16_bf16 v[180:195], a[232:235], a[172:175], v[180:195]
    ds_read_b64_tr_b16 v[12:13], v221 offset:28672
    ds_read_b64_tr_b16 v[14:15], v221 offset:29696
    v_add_f32 v173, v173, v125
    v_add_f32 v174, v174, v126
    v_add_f32 v175, v175, v127
    v_add_f32_e64 v176, v176, v128
    v_mfma_f32_32x32x16_bf16 v[196:211], a[236:239], a[172:175], v[196:211]
    ds_read_b64_tr_b16 v[16:17], v220 offset:28672
    ds_read_b64_tr_b16 v[18:19], v220 offset:29696
    buffer_load_dwordx4 a[164:167], v252, s[72:75], s14 offen offset:1024 sc1
    v_add_f32 v177, v177, v129
    v_add_f32 v178, v178, v130
    s_waitcnt vmcnt(11)
    v_mfma_f32_32x32x16_bf16 v[180:195], a[240:243], a[176:179], v[180:195]
    ds_read_b64_tr_b16 v[20:21], v221 offset:30720
    ds_read_b64_tr_b16 v[22:23], v221 offset:31744
    v_add_f32 v179, v179, v131
    v_lshlrev_b32_e64 v116, 16, v68
    v_and_b32 v117, 0xffff0000, v68
    v_lshlrev_b32_e64 v118, 16, v69
    v_mfma_f32_32x32x16_bf16 v[196:211], a[244:247], a[176:179], v[196:211]
    ds_read_b64_tr_b16 v[24:25], v220 offset:30720
    ds_read_b64_tr_b16 v[26:27], v220 offset:31744
    buffer_load_dwordx4 a[168:171], v252, s[72:75], s14 offen offset:2048 sc1
    v_and_b32 v119, 0xffff0000, v69
    v_lshlrev_b32 v120, 16, v70
    s_waitcnt vmcnt(11)
    v_mfma_f32_32x32x16_bf16 v[180:195], a[248:251], a[180:183], v[180:195]
    ds_read_b64_tr_b16 v[28:29], v221 offset:32768
    ds_read_b64_tr_b16 v[30:31], v221 offset:33792
    v_and_b32 v121, 0xffff0000, v70
    v_lshlrev_b32_e64 v122, 16, v71
    v_and_b32 v123, 0xffff0000, v71
    v_lshlrev_b32_e64 v124, 16, v72
    v_mfma_f32_32x32x16_bf16 v[196:211], a[252:255], a[180:183], v[196:211]
    ds_read_b64_tr_b16 v[32:33], v220 offset:32768
    ds_read_b64_tr_b16 v[34:35], v220 offset:33792
    v_and_b32 v125, 0xffff0000, v72
    v_lshlrev_b32_e64 v126, 16, v73
    v_and_b32 v127, 0xffff0000, v73
    s_waitcnt vmcnt(10) lgkmcnt(8)
    v_mfma_f32_32x32x16_bf16 v[180:195], v[12:15], a[184:187], v[180:195]
    ds_read_b64_tr_b16 v[36:37], v221 offset:34816
    ds_read_b64_tr_b16 v[38:39], v219 offset:49152
    buffer_load_dwordx4 a[172:175], v252, s[72:75], s14 offen offset:3072 sc1
    v_lshlrev_b32 v128, 16, v74
    v_and_b32 v129, 0xffff0000, v74
    v_lshlrev_b32_e64 v130, 16, v75
    v_mfma_f32_32x32x16_bf16 v[196:211], v[16:19], a[184:187], v[196:211]
    ds_read_b64_tr_b16 v[40:41], v220 offset:34816
    ds_read_b64_tr_b16 v[42:43], v218 offset:49152
    v_and_b32 v131, 0xffff0000, v75
    s_waitcnt vmcnt(10) lgkmcnt(8)
    v_mfma_f32_32x32x16_bf16 v[180:195], v[20:23], a[188:191], v[180:195]
    s_cmp_eq_u32 s6, 0
    s_cselect_b32 s14, 3, 4
    s_lshl_b32 s14, s14, 12
    s_add_u32 s14, s14, s81
    buffer_load_dwordx4 a[176:179], v252, s[72:75], s14 offen offset:0 sc1
    v_mfma_f32_32x32x16_bf16 v[196:211], v[24:27], a[188:191], v[196:211]
    s_waitcnt vmcnt(10) lgkmcnt(4)
    v_mfma_f32_32x32x16_bf16 v[180:195], v[28:31], a[192:195], v[180:195]
    buffer_load_dwordx4 a[180:183], v252, s[72:75], s14 offen offset:1024 sc1
    v_mfma_f32_32x32x16_bf16 v[196:211], v[32:35], a[192:195], v[196:211]
    s_waitcnt vmcnt(10) lgkmcnt(0)
    v_mfma_f32_32x32x16_bf16 v[180:195], v[36:39], a[196:199], v[180:195]
    v_mfma_f32_32x32x16_bf16 v[196:211], v[40:43], a[196:199], v[196:211]
    buffer_load_dwordx4 a[184:187], v252, s[72:75], s14 offen offset:2048 sc1
    s_waitcnt vmcnt(10)
    v_mfma_f32_32x32x16_bf16 v[44:59], a[72:75], a[144:147], v[44:59]
    s_nop 7
    ds_write_b128 v239, v[180:183] offset:0
    v_mfma_f32_32x32x16_bf16 v[100:115], a[76:79], a[144:147], v[100:115]
    buffer_load_dwordx4 a[188:191], v252, s[72:75], s14 offen offset:3072 sc1
    s_waitcnt vmcnt(10)
    v_mfma_f32_32x32x16_bf16 v[44:59], a[80:83], a[148:151], v[44:59]
    s_cmp_eq_u32 s6, 0
    s_cselect_b32 s14, 5, 6
    s_lshl_b32 s14, s14, 12
    s_add_u32 s14, s14, s81
    buffer_load_dwordx4 a[192:195], v252, s[72:75], s14 offen offset:0 sc1
    v_mfma_f32_32x32x16_bf16 v[100:115], a[84:87], a[148:151], v[100:115]
    ds_write_b128 v239, v[184:187] offset:1024
    s_waitcnt vmcnt(10)
    s_nop 0
    v_mfma_f32_32x32x16_bf16 v[44:59], a[88:91], a[152:155], v[44:59]
    buffer_load_dwordx4 a[196:199], v252, s[72:75], s14 offen offset:1024 sc1
    ds_write_b128 v239, v[188:191] offset:2048
    v_mfma_f32_32x32x16_bf16 v[100:115], a[92:95], a[152:155], v[100:115]
    ds_write_b128 v239, v[192:195] offset:3072
    s_waitcnt vmcnt(10)
    s_nop 0
    v_mfma_f32_32x32x16_bf16 v[44:59], a[96:99], a[156:159], v[44:59]
    buffer_load_dwordx4 a[144:147], v252, s[72:75], s14 offen offset:2048 sc1
    ds_write_b128 v239, v[196:199] offset:4096
    v_mfma_f32_32x32x16_bf16 v[100:115], a[100:103], a[156:159], v[100:115]
    buffer_load_dwordx4 a[148:151], v252, s[72:75], s14 offen offset:3072 sc1
    s_waitcnt vmcnt(11)
    v_mfma_f32_32x32x16_bf16 v[44:59], a[104:107], a[160:163], v[44:59]
    ds_write_b128 v239, v[200:203] offset:5120
    v_mfma_f32_32x32x16_bf16 v[100:115], a[108:111], a[160:163], v[100:115]
    ds_write_b128 v239, v[204:207] offset:6144
    s_waitcnt vmcnt(10)
    v_mfma_f32_32x32x16_bf16 v[44:59], a[200:203], a[164:167], v[44:59]
    ds_write_b128 v239, v[208:211] offset:57344
    v_mfma_f32_32x32x16_bf16 v[100:115], a[204:207], a[164:167], v[100:115]
    s_waitcnt lgkmcnt(0)
    s_barrier
    s_waitcnt vmcnt(9)
    s_nop 0
    v_mfma_f32_32x32x16_bf16 v[44:59], a[208:211], a[168:171], v[44:59]
    ds_read_b128 v[180:183], v228 offset:0
    ds_read_b128 v[184:187], v228 offset:1024
    ds_read_b128 v[188:191], v228 offset:2048
    ds_read_b128 v[192:195], v228 offset:3072
    ds_read_b128 v[196:199], v223 offset:4096
    v_mfma_f32_32x32x16_bf16 v[100:115], a[212:215], a[168:171], v[100:115]
    ds_read_b128 v[200:203], v223 offset:5120
    ds_read_b128 v[204:207], v223 offset:6144
    ds_read_b128 v[208:211], v223 offset:57344
    s_waitcnt vmcnt(8)
    v_mfma_f32_32x32x16_bf16 v[44:59], a[216:219], a[172:175], v[44:59]
    v_mfma_f32_32x32x16_bf16 v[100:115], a[220:223], a[172:175], v[100:115]
    s_waitcnt vmcnt(7)
    v_mfma_f32_32x32x16_bf16 v[44:59], a[224:227], a[176:179], v[44:59]
    v_mfma_f32_32x32x16_bf16 v[100:115], a[228:231], a[176:179], v[100:115]
    s_waitcnt lgkmcnt(7)
    v_add_f32 v76, v76, v180
    v_add_f32 v77, v77, v181
    v_add_f32 v78, v78, v182
    v_add_f32 v79, v79, v183
    s_waitcnt vmcnt(6)
    v_mfma_f32_32x32x16_bf16 v[44:59], a[232:235], a[180:183], v[44:59]
    ds_read_b64_tr_b16 v[12:13], v221 offset:28672
    ds_read_b64_tr_b16 v[14:15], v221 offset:29696
    s_waitcnt lgkmcnt(8)
    v_add_f32 v80, v80, v184
    v_add_f32 v81, v81, v185
    v_add_f32 v82, v82, v186
    v_mfma_f32_32x32x16_bf16 v[100:115], a[236:239], a[180:183], v[100:115]
    ds_read_b64_tr_b16 v[16:17], v220 offset:28672
    ds_read_b64_tr_b16 v[18:19], v220 offset:29696
    v_add_f32 v83, v83, v187
    s_waitcnt lgkmcnt(9)
    v_add_f32 v84, v84, v188
    s_waitcnt vmcnt(5)
    v_mfma_f32_32x32x16_bf16 v[44:59], a[240:243], a[184:187], v[44:59]
    ds_read_b64_tr_b16 v[20:21], v221 offset:30720
    ds_read_b64_tr_b16 v[22:23], v221 offset:31744
    v_add_f32 v85, v85, v189
    v_add_f32 v86, v86, v190
    v_add_f32 v87, v87, v191
    s_waitcnt lgkmcnt(10)
    v_mfma_f32_32x32x16_bf16 v[100:115], a[244:247], a[184:187], v[100:115]
    ds_read_b64_tr_b16 v[24:25], v220 offset:30720
    ds_read_b64_tr_b16 v[26:27], v220 offset:31744
    v_add_f32 v88, v88, v192
    v_add_f32 v89, v89, v193
    v_add_f32 v90, v90, v194
    s_waitcnt vmcnt(4)
    v_mfma_f32_32x32x16_bf16 v[44:59], a[248:251], a[188:191], v[44:59]
    ds_read_b64_tr_b16 v[28:29], v221 offset:32768
    ds_read_b64_tr_b16 v[30:31], v221 offset:33792
    v_add_f32 v91, v91, v195
    s_waitcnt lgkmcnt(13)
    v_add_f32 v76, v76, v196
    v_add_f32 v77, v77, v197
    v_mfma_f32_32x32x16_bf16 v[100:115], a[252:255], a[188:191], v[100:115]
    ds_read_b64_tr_b16 v[32:33], v220 offset:32768
    ds_read_b64_tr_b16 v[34:35], v220 offset:33792
    v_add_f32 v78, v78, v198
    v_add_f32 v79, v79, v199
    s_waitcnt lgkmcnt(14)
    s_waitcnt vmcnt(3) lgkmcnt(8)
    v_mfma_f32_32x32x16_bf16 v[44:59], v[12:15], a[192:195], v[44:59]
    ds_read_b64_tr_b16 v[36:37], v221 offset:34816
    ds_read_b64_tr_b16 v[38:39], v219 offset:49152
    v_add_f32 v80, v80, v200
    v_add_f32 v81, v81, v201
    v_add_f32 v82, v82, v202
    v_add_f32 v83, v83, v203
    v_mfma_f32_32x32x16_bf16 v[100:115], v[16:19], a[192:195], v[100:115]
    ds_read_b64_tr_b16 v[40:41], v220 offset:34816
    ds_read_b64_tr_b16 v[42:43], v218 offset:49152
    v_add_f32 v84, v84, v204
    v_add_f32 v85, v85, v205
    v_add_f32 v86, v86, v206
    s_waitcnt vmcnt(2) lgkmcnt(8)
    v_mfma_f32_32x32x16_bf16 v[44:59], v[20:23], a[196:199], v[44:59]
    v_add_f32 v87, v87, v207
    v_add_f32 v88, v88, v208
    v_add_f32 v89, v89, v209
    v_add_f32 v90, v90, v210
    v_add_f32_e64 v91, v91, v211
    v_mfma_f32_32x32x16_bf16 v[100:115], v[24:27], a[196:199], v[100:115]
    s_waitcnt vmcnt(1) lgkmcnt(4)
    v_mfma_f32_32x32x16_bf16 v[44:59], v[28:31], a[144:147], v[44:59]
    v_mfma_f32_32x32x16_bf16 v[100:115], v[32:35], a[144:147], v[100:115]
    s_waitcnt vmcnt(0) lgkmcnt(0)
    v_mfma_f32_32x32x16_bf16 v[44:59], v[36:39], a[148:151], v[44:59]
    v_mfma_f32_32x32x16_bf16 v[100:115], v[40:43], a[148:151], v[100:115]
    s_nop 11
    s_nop 0
    ds_write_b128 v239, v[100:103] offset:58368
    ds_write_b128 v239, v[104:107] offset:59392
    ds_write_b128 v239, v[108:111] offset:60416
    ds_write_b128 v239, v[112:115] offset:61440
    v_pk_add_f32 v[44:45], v[44:45], v[76:77]
    v_pk_add_f32 v[46:47], v[46:47], v[78:79]
    v_pk_add_f32 v[48:49], v[48:49], v[80:81]
    v_pk_add_f32 v[50:51], v[50:51], v[82:83]
    v_pk_add_f32 v[52:53], v[52:53], v[84:85]
    v_pk_add_f32 v[54:55], v[54:55], v[86:87]
    v_pk_add_f32 v[56:57], v[56:57], v[88:89]
    v_pk_add_f32 v[58:59], v[58:59], v[90:91]
    s_waitcnt lgkmcnt(0)
    s_barrier
    ds_read_b128 v[100:103], v238 offset:58368
    ds_read_b128 v[104:107], v238 offset:59392
    ds_read_b128 v[108:111], v238 offset:60416
    ds_read_b128 v[112:115], v238 offset:61440
    s_waitcnt lgkmcnt(2)
    s_nop 0
    v_pk_add_f32 v[44:45], v[44:45], v[100:101]
    v_pk_add_f32 v[46:47], v[46:47], v[102:103]
    v_pk_add_f32 v[48:49], v[48:49], v[104:105]
    v_pk_add_f32 v[50:51], v[50:51], v[106:107]
    v_pk_mul_f32 v[180:181], v[44:45], s[98:99] neg_lo:[1,0] neg_hi:[1,0]
    v_pk_mul_f32 v[182:183], v[46:47], s[98:99] neg_lo:[1,0] neg_hi:[1,0]
    v_pk_mul_f32 v[184:185], v[48:49], s[98:99] neg_lo:[1,0] neg_hi:[1,0]
    v_pk_mul_f32 v[186:187], v[50:51], s[98:99] neg_lo:[1,0] neg_hi:[1,0]
    v_exp_f32 v180, v180
    v_exp_f32 v181, v181
    v_exp_f32 v182, v182
    v_exp_f32 v183, v183
    v_exp_f32 v184, v184
    v_exp_f32 v185, v185
    v_exp_f32 v186, v186
    v_exp_f32 v187, v187
    v_pk_mul_f32 v[44:45], v[44:45], v[164:165]
    v_pk_mul_f32 v[46:47], v[46:47], v[166:167]
    v_pk_mul_f32 v[48:49], v[48:49], v[168:169]
    v_pk_mul_f32 v[50:51], v[50:51], v[170:171]
    v_pk_add_f32 v[180:181], v[180:181], 1.0 op_sel_hi:[1,0]
    v_pk_add_f32 v[182:183], v[182:183], 1.0 op_sel_hi:[1,0]
    v_pk_add_f32 v[184:185], v[184:185], 1.0 op_sel_hi:[1,0]
    v_pk_add_f32 v[186:187], v[186:187], 1.0 op_sel_hi:[1,0]
    v_rcp_f32 v180, v180
    v_rcp_f32 v181, v181
    v_rcp_f32 v182, v182
    v_rcp_f32 v183, v183
    v_rcp_f32 v184, v184
    v_rcp_f32 v185, v185
    v_rcp_f32 v186, v186
    v_rcp_f32 v187, v187
    v_pk_fma_f32 v[44:45], v[44:45], v[180:181], v[116:117]
    v_pk_fma_f32 v[46:47], v[46:47], v[182:183], v[118:119]
    v_pk_fma_f32 v[48:49], v[48:49], v[184:185], v[120:121]
    v_pk_fma_f32 v[50:51], v[50:51], v[186:187], v[122:123]
    v_cvt_pk_bf16_f32 v68, v44, v45
    v_cvt_pk_bf16_f32 v69, v46, v47
    v_cvt_pk_bf16_f32 v70, v48, v49
    v_cvt_pk_bf16_f32 v71, v50, v51
    s_nop 0
    v_permlane32_swap_b32 v68, v70
    v_permlane32_swap_b32 v69, v71
    buffer_store_dwordx4 v[68:71], v241, s[64:67], 0 offen offset:0
    s_waitcnt lgkmcnt(0)
    v_pk_add_f32 v[52:53], v[52:53], v[108:109]
    v_pk_add_f32 v[54:55], v[54:55], v[110:111]
    v_pk_add_f32 v[56:57], v[56:57], v[112:113]
    v_pk_add_f32 v[58:59], v[58:59], v[114:115]
    v_pk_mul_f32 v[188:189], v[52:53], s[98:99] neg_lo:[1,0] neg_hi:[1,0]
    v_pk_mul_f32 v[190:191], v[54:55], s[98:99] neg_lo:[1,0] neg_hi:[1,0]
    v_pk_mul_f32 v[192:193], v[56:57], s[98:99] neg_lo:[1,0] neg_hi:[1,0]
    v_pk_mul_f32 v[194:195], v[58:59], s[98:99] neg_lo:[1,0] neg_hi:[1,0]
    v_exp_f32 v188, v188
    v_exp_f32 v189, v189
    v_exp_f32 v190, v190
    v_exp_f32 v191, v191
    v_exp_f32 v192, v192
    v_exp_f32 v193, v193
    v_exp_f32 v194, v194
    v_exp_f32 v195, v195
    v_pk_mul_f32 v[52:53], v[52:53], v[172:173]
    v_pk_mul_f32 v[54:55], v[54:55], v[174:175]
    v_pk_mul_f32 v[56:57], v[56:57], v[176:177]
    v_pk_mul_f32 v[58:59], v[58:59], v[178:179]
    v_pk_add_f32 v[188:189], v[188:189], 1.0 op_sel_hi:[1,0]
    v_pk_add_f32 v[190:191], v[190:191], 1.0 op_sel_hi:[1,0]
    v_pk_add_f32 v[192:193], v[192:193], 1.0 op_sel_hi:[1,0]
    v_pk_add_f32 v[194:195], v[194:195], 1.0 op_sel_hi:[1,0]
    v_rcp_f32 v188, v188
    v_rcp_f32 v189, v189
    v_rcp_f32 v190, v190
    v_rcp_f32 v191, v191
    v_rcp_f32 v192, v192
    v_rcp_f32 v193, v193
    v_rcp_f32 v194, v194
    v_rcp_f32 v195, v195
    v_pk_fma_f32 v[52:53], v[52:53], v[188:189], v[124:125]
    v_pk_fma_f32 v[54:55], v[54:55], v[190:191], v[126:127]
    v_pk_fma_f32 v[56:57], v[56:57], v[192:193], v[128:129]
    v_pk_fma_f32 v[58:59], v[58:59], v[194:195], v[130:131]
    v_cvt_pk_bf16_f32 v72, v52, v53
    v_cvt_pk_bf16_f32 v73, v54, v55
    v_cvt_pk_bf16_f32 v74, v56, v57
    v_cvt_pk_bf16_f32 v75, v58, v59
    s_nop 0
    v_permlane32_swap_b32 v72, v74
    v_permlane32_swap_b32 v73, v75
    buffer_store_dwordx4 v[72:75], v241, s[64:67], 0 offen offset:32
L_fin_m:
    s_endpgm
L_abort_m:
    v_mov_b32 v2, 0xdead
    buffer_store_dword v2, v254, s[68:71], 0 offen offset:16
    s_endpgm
L_tok_retry_m:
    s_mov_b32 s89, 200000
L_tok_loop_m:
    s_sleep 8
    buffer_load_dwordx4 v[8:11], v254, s[68:71], 0 offen sc1
    s_sub_u32 s89, s89, 1
    s_cbranch_scc1 L_abort_m
    s_waitcnt vmcnt(0)
    v_readfirstlane_b32 s8, v9
    s_nop 0
    s_cmp_lt_u32 s8, 1
    s_cbranch_scc1 L_tok_loop_m
    s_branch L_tok_ok_m
L_c2_retry:
    s_mov_b32 s89, 200000
L_c2_loop:
    s_sleep 8
    buffer_load_dword v11, v254, s[68:71], 0 offen offset:12 sc1
    s_sub_u32 s89, s89, 1
    s_cbranch_scc1 L_abort_m
    s_waitcnt vmcnt(0)
    v_readfirstlane_b32 s77, v11
    s_nop 0
    s_cmp_lt_u32 s77, 32
    s_cbranch_scc1 L_c2_loop
    s_branch L_c2_ok
L_spin0:
    s_mov_b32 s89, 200000
    s_mov_b32 s77, 8192
L_spinl0:
    s_sleep 8
    buffer_load_dword v241, v255, s[72:75], s77 offen sc1
    s_sub_u32 s89, s89, 1
    s_cbranch_scc1 L_abort_m
    s_waitcnt vmcnt(0)
    v_cmp_eq_u32 vcc, v241, v251
    s_nop 0
    s_cmp_eq_u64 vcc, -1
    s_cbranch_scc0 L_spinl0
    s_branch L_pok0
L_spin1:
    s_mov_b32 s89, 200000
    s_mov_b32 s77, 16384
L_spinl1:
    s_sleep 8
    buffer_load_dword v228, v253, s[72:75], s77 offen sc1
    s_sub_u32 s89, s89, 1
    s_cbranch_scc1 L_abort_m
    s_waitcnt vmcnt(0)
    v_cmp_eq_u32 vcc, v228, v251
    s_nop 0
    s_cmp_eq_u64 vcc, -1
    s_cbranch_scc0 L_spinl1
    s_branch L_pok1
L_spin2:
    s_mov_b32 s89, 200000
    s_mov_b32 s77, 16384
L_spinl2:
    s_sleep 8
    buffer_load_dword v239, v248, s[72:75], s77 offen sc1
    s_sub_u32 s89, s89, 1
    s_cbranch_scc1 L_abort_m
    s_waitcnt vmcnt(0)
    v_cmp_eq_u32 vcc, v239, v251
    s_nop 0
    s_cmp_eq_u64 vcc, -1
    s_cbranch_scc0 L_spinl2
    s_branch L_pok2
L_spin3:
    s_mov_b32 s89, 200000
    s_mov_b32 s77, 20480
L_spinl3:
    s_sleep 8
    buffer_load_dword v239, v255, s[72:75], s77 offen sc1
    s_sub_u32 s89, s89, 1
    s_cbranch_scc1 L_abort_m
    s_waitcnt vmcnt(0)
    v_cmp_eq_u32 vcc, v239, v251
    s_nop 0
    s_cmp_eq_u64 vcc, -1
    s_cbranch_scc0 L_spinl3
    s_branch L_pok3
L_spin4:
    s_mov_b32 s89, 200000
    s_mov_b32 s77, 24576
L_spinl4:
    s_sleep 8
    buffer_load_dword v239, v253, s[72:75], s77 offen sc1
    s_sub_u32 s89, s89, 1
    s_cbranch_scc1 L_abort_m
    s_waitcnt vmcnt(0)
    v_cmp_eq_u32 vcc, v239, v251
    s_nop 0
    s_cmp_eq_u64 vcc, -1
    s_cbranch_scc0 L_spinl4
    s_branch L_pok4
L_spin5:
    s_mov_b32 s89, 200000
    s_mov_b32 s77, 28672
L_spinl5:
    s_sleep 8
    buffer_load_dword v214, v255, s[72:75], s77 offen sc1
    s_sub_u32 s89, s89, 1
    s_cbranch_scc1 L_abort_m
    s_waitcnt vmcnt(0)
    v_cmp_eq_u32 vcc, v214, v251
    s_nop 0
    s_cmp_eq_u64 vcc, -1
    s_cbranch_scc0 L_spinl5
    s_branch L_pok5
L_spin6:
    s_mov_b32 s89, 200000
    s_mov_b32 s77, 4096
L_spinl6:
    s_sleep 8
    buffer_load_dword v214, v253, s[72:75], s77 offen sc1
    s_sub_u32 s89, s89, 1
    s_cbranch_scc1 L_abort_m
    s_waitcnt vmcnt(0)
    v_cmp_eq_u32 vcc, v214, v251
    s_nop 0
    s_cmp_eq_u64 vcc, -1
    s_cbranch_scc0 L_spinl6
    s_branch L_pok6
L_spare:
    v_lshrrev_b32_e64 v2, 2, v1
    v_mul_u32_u24 v255, 896, v2
    v_and_b32_e64 v3, 3, v1
    v_lshl_add_u32 v255, v3, 4, v255
    s_lshl_b32 s30, s3, 2
    s_add_u32 s30, s30, s5
    s_mul_i32 s30, s30, 14336
    s_lshl_b32 s78, s4, 7
    s_add_u32 s78, s78, s30
    s_mul_i32 s89, s91, 448
    s_add_u32 s77, s30, s89
    s_add_u32 s30, s30, 448
    s_sub_u32 s30, s30, s89
    v_mov_b32 v254, 0
    v_lshlrev_b32 v253, 7, v1
    v_lshlrev_b32_e64 v252, 4, v1
    s_mov_b32 s34, 1835008
    s_mov_b32 s35, 0x20000
    v_lshrrev_b32 v2, 3, v1
    v_and_b32 v3, 7, v1
    v_lshlrev_b32 v4, 4, v3
    v_cmp_eq_u32 vcc, 7, v3
    v_mul_u32_u24 v247, 112, v2
    v_add_u32_e64 v247, v247, v4
    v_mov_b32 v5, 0x7fffff00
    v_cndmask_b32_e64 v247, v247, v5, vcc
    v_mul_u32_u24 v246, 57344, v2
    v_add_u32 v246, v246, v4
    s_mul_i32 s81, s3, 14
    s_add_u32 s81, s81, s5
    s_add_u32 s82, s81, 12
    s_min_u32 s82, s82, 447
    s_mul_i32 s79, s81, 2688
    s_mul_i32 s80, s82, 2688
    s_lshl_b32 s81, s81, 7
    s_lshl_b32 s82, s82, 7
    v_cmp_eq_u32 vcc, 0, v0
    v_mov_b32 v248, 1
    s_nop 0
    v_cndmask_b32 v250, v5, v254, vcc
    s_waitcnt lgkmcnt(0)
    s_mov_b64 s[32:33], s[8:9]
    s_mov_b64 s[36:37], s[10:11]
    s_mov_b32 s38, 1204224
    s_mov_b32 s39, 0x20000
    s_mov_b64 s[72:73], s[28:29]
    s_mov_b32 s74, 18087936
    s_mov_b32 s75, 0x20000
    s_mov_b64 s[48:49], s[16:17]
    s_mov_b32 s50, 401408
    s_mov_b32 s51, 0x20000
    s_lshl_b32 s89, s3, 2
    s_add_u32 s89, s89, s5
    s_nop 0
    s_mul_i32 s89, s89, 3136
    v_min_u32 v245, 3200, v253
    buffer_load_dword v7, v245, s[48:51], s89 offen
    v_bfe_u32 v2, v1, 3, 2
    v_mul_u32_u24 v2, 10752, v2
    v_and_b32 v3, 7, v1
    v_min_u32 v3, 6, v3
    v_lshl_add_u32 v2, v3, 7, v2
    buffer_load_dword v7, v2, s[36:39], s79 offen offset:896
    s_add_u32 s90, s79, 1792
    buffer_load_dwordx4 v[12:15], v247, s[36:39], s90 offen
    s_add_u32 s90, s79, 12544
    buffer_load_dwordx4 v[16:19], v247, s[36:39], s90 offen
    s_add_u32 s90, s79, 23296
    buffer_load_dwordx4 v[20:23], v247, s[36:39], s90 offen
    s_add_u32 s90, s80, 1792
    buffer_load_dwordx4 v[24:27], v247, s[36:39], s90 offen
    s_add_u32 s90, s79, 0
    s_nop 0
    buffer_load_dwordx4 v[28:31], v247, s[36:39], s90 offen
    s_add_u32 s90, s79, 10752
    buffer_load_dwordx4 v[32:35], v247, s[36:39], s90 offen
    s_add_u32 s90, s79, 21504
    buffer_load_dwordx4 v[36:39], v247, s[36:39], s90 offen
    s_add_u32 s90, s80, 0
    buffer_load_dwordx4 v[40:43], v247, s[36:39], s90 offen
    s_mov_b64 s[68:69], s[26:27]
    s_mov_b32 s70, 256
    s_mov_b32 s71, 0x20000
    s_mov_b32 s87, s81
    s_mov_b32 s88, s82
    s_add_u32 s90, s87, 6029312
    s_waitcnt vmcnt(7)
    buffer_store_dwordx4 v[12:15], v246, s[72:75], s90 offen sc1
    s_add_u32 s90, s87, 6029824
    s_waitcnt vmcnt(7)
    buffer_store_dwordx4 v[16:19], v246, s[72:75], s90 offen sc1
    s_add_u32 s90, s87, 6030336
    s_waitcnt vmcnt(7)
    buffer_store_dwordx4 v[20:23], v246, s[72:75], s90 offen sc1
    s_add_u32 s90, s88, 6029312
    s_waitcnt vmcnt(7)
    buffer_store_dwordx4 v[24:27], v246, s[72:75], s90 offen sc1
    s_add_u32 s90, s87, 5111808
    s_waitcnt vmcnt(7)
    buffer_store_dwordx4 v[28:31], v246, s[72:75], s90 offen sc1
    s_add_u32 s90, s87, 5112320
    s_waitcnt vmcnt(7)
    buffer_store_dwordx4 v[32:35], v246, s[72:75], s90 offen sc1
    s_add_u32 s90, s87, 5112832
    s_waitcnt vmcnt(7)
    buffer_store_dwordx4 v[36:39], v246, s[72:75], s90 offen sc1
    s_add_u32 s90, s88, 5111808
    s_waitcnt vmcnt(7)
    buffer_store_dwordx4 v[40:43], v246, s[72:75], s90 offen sc1
    buffer_load_dwordx4 v[60:63], v255, s[32:35], s77 offen offset:0
    buffer_load_dwordx4 v[64:67], v255, s[32:35], s77 offen offset:64
    buffer_load_dwordx4 v[68:71], v255, s[32:35], s77 offen offset:128
    buffer_load_dwordx4 v[72:75], v255, s[32:35], s77 offen offset:192
    buffer_load_dwordx4 v[76:79], v255, s[32:35], s77 offen offset:256
    buffer_load_dwordx4 v[80:83], v255, s[32:35], s77 offen offset:320
    buffer_load_dwordx4 v[84:87], v255, s[32:35], s77 offen offset:384
    s_mov_b64 s[40:41], s[12:13]
    s_mov_b32 s42, 25088
    s_mov_b32 s43, 0x20000
    s_mov_b64 s[56:57], s[20:21]
    s_mov_b32 s58, 1605632
    s_mov_b32 s59, 0x20000
    s_mov_b64 s[68:69], s[26:27]
    s_mov_b32 s70, 256
    s_mov_b32 s71, 0x20000
    s_mov_b64 s[44:45], s[14:15]
    s_mov_b32 s46, 401408
    s_mov_b32 s47, 0x20000
    s_mov_b64 s[52:53], s[18:19]
    s_mov_b32 s54, 401408
    s_mov_b32 s55, 0x20000
    s_mov_b64 s[60:61], s[22:23]
    s_mov_b32 s62, 1605632
    s_mov_b32 s63, 0x20000
    s_mov_b64 s[64:65], s[24:25]
    s_mov_b32 s66, 1835008
    s_mov_b32 s67, 0x20000
    v_lshrrev_b32 v2, 3, v1
    v_lshrrev_b32 v3, 2, v1
    v_and_b32 v3, 4, v3
    v_and_b32 v4, 7, v1
    v_xor_b32 v4, v4, v3
    v_lshlrev_b32_e64 v5, 4, v4
    v_mul_u32_u24 v247, 3584, v2
    v_add_u32_e64 v247, v247, v5
    v_add_u32 v244, 27648, v247
    v_add_u32 v243, 55296, v247
    v_add_u32 v242, 82944, v247
    s_lshl_b32 s8, s3, 7
    s_mul_i32 s18, s5, 7168
    s_mul_i32 s79, s5, 200704
    s_add_u32 s79, s79, s8
    s_mul_i32 s11, s91, 802816
    s_add_u32 s80, s79, 802816
    s_sub_u32 s80, s80, s11
    s_add_u32 s79, s79, s11
    s_mul_i32 s9, s4, 112
    v_cmp_eq_u32_e64 vcc, 7, v4
    v_mul_u32_u24 v246, 2688, v2
    v_add_u32_e64 v246, v246, v5
    v_mov_b32 v3, 0x7fffff00
    v_cndmask_b32_e64 v246, v246, v3, vcc
    v_add_u32 v241, 20480, v246
    v_add_u32 v240, 40960, v246
    v_add_u32 v239, 61440, v246
    s_mul_i32 s81, s5, 150528
    s_add_u32 s81, s81, s9
    s_mul_i32 s11, s91, 602112
    s_add_u32 s82, s81, 602112
    s_sub_u32 s82, s82, s11
    s_add_u32 s81, s81, s11
    s_mul_i32 s92, s4, 3136
    s_add_u32 s92, s92, s76
    s_lshl_b32 s12, s3, 1
    s_add_u32 s12, s12, s6
    s_lshl_b32 s13, s4, 1
    s_add_u32 s13, s13, s7
    s_mov_b32 s94, 0
    s_mov_b32 s95, -1
    s_mov_b32 s96, 0x10000000
    s_mov_b32 s97, 0x10000000
    s_mov_b32 s98, 0x3fb8aa3b
    s_mov_b32 s99, s98
    v_cndmask_b32 v236, 1.0, 0, s[94:95]
    v_cndmask_b32 v238, -1, 0, s[94:95]
    v_mov_b32 v237, 0
    v_mov_b32 v2, 0x7fffff00
    v_cmp_eq_u32 vcc, 0, v0
    s_nop 1
    v_cndmask_b32_e64 v250, v2, v254, vcc
    buffer_load_dwordx4 v[88:91], v255, s[32:35], s30 offen offset:0
    buffer_load_dwordx4 v[92:95], v255, s[32:35], s30 offen offset:64
    buffer_load_dwordx4 v[96:99], v255, s[32:35], s30 offen offset:128
    buffer_load_dwordx4 v[100:103], v255, s[32:35], s30 offen offset:192
    buffer_load_dwordx4 v[104:107], v255, s[32:35], s30 offen offset:256
    buffer_load_dwordx4 v[108:111], v255, s[32:35], s30 offen offset:320
    buffer_load_dwordx4 v[112:115], v255, s[32:35], s30 offen offset:384
    v_and_b32_e64 v230, 31, v1
    v_bfe_u32 v2, v1, 2, 2
    v_lshrrev_b32_e64 v3, 5, v1
    v_lshl_add_u32 v231, v3, 2, v2
    v_and_b32 v4, 3, v1
    v_lshlrev_b32 v4, 3, v4
    v_bfe_u32 v5, v1, 4, 1
    v_lshl_add_u32 v232, v5, 5, v4
    v_lshrrev_b32 v2, 1, v2
    v_lshlrev_b32 v2, 6, v2
    s_lshl_b32 s8, s7, 6
    v_add_u32 v3, s8, v232
    v_xor_b32_e64 v3, v3, v2
    v_lshl_add_u32 v235, v231, 7, v3
    v_xor_b32 v234, 64, v235
    s_mul_i32 s8, s7, 56
    v_add_u32 v3, s8, v232
    v_xor_b32 v3, v3, v2
    v_lshl_add_u32 v233, v231, 7, v3
    v_add_u32 v229, 65536, v233
    v_add_u32 v228, 131072, v233
    v_lshrrev_b32 v2, 2, v1
    s_lshl_b32 s8, s6, 4
    v_add_u32_e64 v2, s8, v2
    v_bfe_u32 v3, v1, 1, 1
    v_lshlrev_b32 v4, 2, v3
    v_xor_b32 v2, v2, v4
    v_lshlrev_b32_e64 v2, 4, v2
    v_lshl_add_u32 v2, v3, 10, v2
    v_and_b32_e64 v3, 1, v1
    v_lshl_add_u32 v2, v3, 3, v2
    s_mul_i32 s8, s7, 28672
    v_add_u32_e64 v227, s8, v2
    s_mul_i32 s8, s6, 28672
    v_add_u32 v226, s8, v252
    v_xor_b32 v225, 64, v226
    v_min_u32_e64 v2, 48, v232
    s_mul_i32 s8, s7, 1568
    s_add_u32 s8, s8, 143360
    v_add_u32 v2, s8, v2
    v_and_b32 v3, 3, v231
    v_mul_u32_u24 v3, 56, v3
    v_add_u32 v223, v3, v2
    v_mul_u32_u24 v4, 56, v231
    v_add_u32 v222, v4, v2
    v_mov_b32 v12, 0
    v_mov_b32 v13, 0
    v_mov_b32 v14, 0
    v_mov_b32 v15, 0
    v_mov_b32 v16, 0x3f803f80
    v_mov_b32 v17, 0x3f803f80
    v_mov_b32 v18, 0x3f803f80
    v_mov_b32 v19, 0x3f803f80
    s_waitcnt vmcnt(14)
    s_waitcnt lgkmcnt(0)
    s_barrier
    buffer_atomic_add v248, v250, s[68:71], 0 offen offset:128 sc0 sc1
    s_waitcnt vmcnt(14)
    v_dot2c_f32_bf16 v12, v60, v16
    v_dot2c_f32_bf16 v13, v60, v60
    v_dot2c_f32_bf16 v14, v61, v16
    v_dot2c_f32_bf16 v15, v61, v61
    v_dot2c_f32_bf16 v12, v62, v16
    v_dot2c_f32_bf16 v13, v62, v62
    v_dot2c_f32_bf16 v14, v63, v16
    v_dot2c_f32_bf16 v15, v63, v63
    s_add_u32 m0, s76, 143360
    s_nop 0
    buffer_load_dwordx4 v252, s[40:43], s92 offen lds
    s_waitcnt vmcnt(14)
    v_dot2c_f32_bf16 v12, v64, v16
    v_dot2c_f32_bf16 v13, v64, v64
    v_dot2c_f32_bf16 v14, v65, v16
    v_dot2c_f32_bf16 v15, v65, v65
    v_dot2c_f32_bf16 v12, v66, v16
    v_dot2c_f32_bf16 v13, v66, v66
    v_dot2c_f32_bf16 v14, v67, v16
    v_dot2c_f32_bf16 v15, v67, v67
    s_waitcnt vmcnt(13)
    v_dot2c_f32_bf16 v12, v68, v16
    v_dot2c_f32_bf16 v13, v68, v68
    v_dot2c_f32_bf16 v14, v69, v16
    v_dot2c_f32_bf16 v15, v69, v69
    v_dot2c_f32_bf16 v12, v70, v16
    v_dot2c_f32_bf16 v13, v70, v70
    v_dot2c_f32_bf16 v14, v71, v16
    v_dot2c_f32_bf16 v15, v71, v71
    s_add_u32 m0, s18, 57344
    s_add_u32 s78, s81, 896
    buffer_load_dwordx4 v246, s[36:39], s78 offen offset:0  lds
    s_waitcnt vmcnt(13)
    v_dot2c_f32_bf16 v12, v72, v16
    v_dot2c_f32_bf16 v13, v72, v72
    v_dot2c_f32_bf16 v14, v73, v16
    v_dot2c_f32_bf16 v15, v73, v73
    v_dot2c_f32_bf16 v12, v74, v16
    v_dot2c_f32_bf16 v13, v74, v74
    v_dot2c_f32_bf16 v14, v75, v16
    v_dot2c_f32_bf16 v15, v75, v75
    buffer_load_dwordx4 v241, s[36:39], s78 offen offset:1024  lds
    s_waitcnt vmcnt(13)
    v_dot2c_f32_bf16 v12, v76, v16
    v_dot2c_f32_bf16 v13, v76, v76
    v_dot2c_f32_bf16 v14, v77, v16
    v_dot2c_f32_bf16 v15, v77, v77
    v_dot2c_f32_bf16 v12, v78, v16
    v_dot2c_f32_bf16 v13, v78, v78
    v_dot2c_f32_bf16 v14, v79, v16
    v_dot2c_f32_bf16 v15, v79, v79
    buffer_load_dwordx4 v240, s[36:39], s78 offen offset:2048  lds
    s_waitcnt vmcnt(13)
    v_dot2c_f32_bf16 v12, v80, v16
    v_dot2c_f32_bf16 v13, v80, v80
    v_dot2c_f32_bf16 v14, v81, v16
    v_dot2c_f32_bf16 v15, v81, v81
    v_dot2c_f32_bf16 v12, v82, v16
    v_dot2c_f32_bf16 v13, v82, v82
    v_dot2c_f32_bf16 v14, v83, v16
    v_dot2c_f32_bf16 v15, v83, v83
    buffer_load_dwordx4 v239, s[36:39], s78 offen offset:3072  lds
    s_waitcnt vmcnt(13)
    v_dot2c_f32_bf16 v12, v84, v16
    v_dot2c_f32_bf16 v13, v84, v84
    v_dot2c_f32_bf16 v14, v85, v16
    v_dot2c_f32_bf16 v15, v85, v85
    v_dot2c_f32_bf16 v12, v86, v16
    v_dot2c_f32_bf16 v13, v86, v86
    v_dot2c_f32_bf16 v14, v87, v16
    v_dot2c_f32_bf16 v15, v87, v87
    s_add_u32 m0, s18, 61440
    s_add_u32 s78, s81, 86912
    buffer_load_dwordx4 v246, s[36:39], s78 offen offset:0  lds
    s_waitcnt vmcnt(13)
    v_dot2c_f32_bf16 v12, v88, v16
    v_dot2c_f32_bf16 v13, v88, v88
    v_dot2c_f32_bf16 v14, v89, v16
    v_dot2c_f32_bf16 v15, v89, v89
    v_dot2c_f32_bf16 v12, v90, v16
    v_dot2c_f32_bf16 v13, v90, v90
    v_dot2c_f32_bf16 v14, v91, v16
    v_dot2c_f32_bf16 v15, v91, v91
    buffer_load_dwordx4 v241, s[36:39], s78 offen offset:1024  lds
    s_waitcnt vmcnt(13)
    v_dot2c_f32_bf16 v12, v92, v16
    v_dot2c_f32_bf16 v13, v92, v92
    v_dot2c_f32_bf16 v14, v93, v16
    v_dot2c_f32_bf16 v15, v93, v93
    v_dot2c_f32_bf16 v12, v94, v16
    v_dot2c_f32_bf16 v13, v94, v94
    v_dot2c_f32_bf16 v14, v95, v16
    v_dot2c_f32_bf16 v15, v95, v95
    buffer_load_dwordx4 v240, s[36:39], s78 offen offset:2048  lds
    s_waitcnt vmcnt(13)
    v_dot2c_f32_bf16 v12, v96, v16
    v_dot2c_f32_bf16 v13, v96, v96
    v_dot2c_f32_bf16 v14, v97, v16
    v_dot2c_f32_bf16 v15, v97, v97
    v_dot2c_f32_bf16 v12, v98, v16
    v_dot2c_f32_bf16 v13, v98, v98
    v_dot2c_f32_bf16 v14, v99, v16
    v_dot2c_f32_bf16 v15, v99, v99
    s_add_u32 m0, s18, 86016
    s_add_u32 s78, s82, 896
    buffer_load_dwordx4 v246, s[36:39], s78 offen offset:0  lds
    s_waitcnt vmcnt(13)
    s_waitcnt vmcnt(9)
    v_and_b32 v2, 31, v248
    v_cmp_eq_u32 vcc, 31, v2
    v_mov_b32 v3, 0x7fffff00
    v_mov_b32 v4, 32
    v_cndmask_b32 v2, v3, v250, vcc
    buffer_store_dword v4, v2, s[68:71], 0 offen offset:12 sc1
    v_dot2c_f32_bf16 v12, v100, v16
    v_dot2c_f32_bf16 v13, v100, v100
    v_dot2c_f32_bf16 v14, v101, v16
    v_dot2c_f32_bf16 v15, v101, v101
    v_dot2c_f32_bf16 v12, v102, v16
    v_dot2c_f32_bf16 v13, v102, v102
    v_dot2c_f32_bf16 v14, v103, v16
    v_dot2c_f32_bf16 v15, v103, v103
    buffer_load_dwordx4 v241, s[36:39], s78 offen offset:1024  lds
    v_dot2c_f32_bf16 v12, v104, v16
    v_dot2c_f32_bf16 v13, v104, v104
    v_dot2c_f32_bf16 v14, v105, v16
    v_dot2c_f32_bf16 v15, v105, v105
    v_dot2c_f32_bf16 v12, v106, v16
    v_dot2c_f32_bf16 v13, v106, v106
    v_dot2c_f32_bf16 v14, v107, v16
    v_dot2c_f32_bf16 v15, v107, v107
    buffer_load_dwordx4 v240, s[36:39], s78 offen offset:2048  lds
    v_dot2c_f32_bf16 v12, v108, v16
    v_dot2c_f32_bf16 v13, v108, v108
    v_dot2c_f32_bf16 v14, v109, v16
    v_dot2c_f32_bf16 v15, v109, v109
    v_dot2c_f32_bf16 v12, v110, v16
    v_dot2c_f32_bf16 v13, v110, v110
    v_dot2c_f32_bf16 v14, v111, v16
    v_dot2c_f32_bf16 v15, v111, v111
    buffer_load_dwordx4 v239, s[36:39], s78 offen offset:3072  lds
    v_dot2c_f32_bf16 v12, v112, v16
    v_dot2c_f32_bf16 v13, v112, v112
    v_dot2c_f32_bf16 v14, v113, v16
    v_dot2c_f32_bf16 v15, v113, v113
    v_dot2c_f32_bf16 v12, v114, v16
    v_dot2c_f32_bf16 v13, v114, v114
    v_dot2c_f32_bf16 v14, v115, v16
    v_dot2c_f32_bf16 v15, v115, v115
    s_add_u32 m0, s18, 90112
    s_add_u32 s78, s82, 86912
    buffer_load_dwordx4 v246, s[36:39], s78 offen offset:0  lds
    v_pk_add_f32 v[12:13], v[12:13], v[14:15]
    s_nop 1
    v_add_f32_dpp v12, v12, v12 quad_perm:[1,0,3,2] row_mask:0xf bank_mask:0xf
    v_add_f32_dpp v13, v13, v13 quad_perm:[1,0,3,2] row_mask:0xf bank_mask:0xf
    s_nop 0
    v_add_f32_dpp v12, v12, v12 quad_perm:[2,3,0,1] row_mask:0xf bank_mask:0xf
    v_add_f32_dpp v13, v13, v13 quad_perm:[2,3,0,1] row_mask:0xf bank_mask:0xf
    v_mul_f32 v12, 0x3b124925, v12
    v_mul_f32 v13, 0x3b124925, v13
    v_fma_f32 v13, -v12, v12, v13
    v_max_f32_e64 v13, 0, v13
    v_add_f32 v14, 0x3727c5ac, v13
    v_rsq_f32 v14, v14
    s_nop 0
    v_mul_f32_e64 v15, -v12, v14
    v_lshlrev_b32 v220, 16, v60
    v_lshlrev_b32 v218, 16, v61
    v_and_b32 v221, 0xffff0000, v60
    v_and_b32 v219, 0xffff0000, v61
    buffer_load_dwordx4 v241, s[36:39], s78 offen offset:1024  lds
    v_pk_fma_f32 v[220:221], v[220:221], v[14:15], v[14:15] op_sel:[0,0,1] op_sel_hi:[1,0,1]
    v_pk_fma_f32 v[218:219], v[218:219], v[14:15], v[14:15] op_sel:[0,0,1] op_sel_hi:[1,0,1]
    v_cvt_pk_bf16_f32 v60, v220, v221
    v_cvt_pk_bf16_f32 v61, v218, v219
    v_lshlrev_b32 v220, 16, v62
    v_lshlrev_b32 v218, 16, v63
    v_and_b32 v221, 0xffff0000, v62
    v_and_b32 v219, 0xffff0000, v63
    v_pk_fma_f32 v[220:221], v[220:221], v[14:15], v[14:15] op_sel:[0,0,1] op_sel_hi:[1,0,1]
    v_pk_fma_f32 v[218:219], v[218:219], v[14:15], v[14:15] op_sel:[0,0,1] op_sel_hi:[1,0,1]
    v_cvt_pk_bf16_f32 v62, v220, v221
    v_cvt_pk_bf16_f32 v63, v218, v219
    ds_write2st64_b64 v227, v[60:61], v[62:63] offset0:0 offset1:1
    buffer_load_dwordx4 v240, s[36:39], s78 offen offset:2048  lds
    s_add_u32 m0, s18, 114688
    s_add_u32 s78, s81, 1792
    buffer_load_dwordx4 v246, s[36:39], s78 offen offset:0  lds
    v_lshlrev_b32 v220, 16, v64
    v_lshlrev_b32 v218, 16, v65
    v_and_b32 v221, 0xffff0000, v64
    v_and_b32 v219, 0xffff0000, v65
    v_pk_fma_f32 v[220:221], v[220:221], v[14:15], v[14:15] op_sel:[0,0,1] op_sel_hi:[1,0,1]
    v_pk_fma_f32 v[218:219], v[218:219], v[14:15], v[14:15] op_sel:[0,0,1] op_sel_hi:[1,0,1]
    v_cvt_pk_bf16_f32 v64, v220, v221
    v_cvt_pk_bf16_f32 v65, v218, v219
    v_lshlrev_b32 v220, 16, v66
    v_lshlrev_b32 v218, 16, v67
    v_and_b32 v221, 0xffff0000, v66
    v_and_b32 v219, 0xffff0000, v67
    v_pk_fma_f32 v[220:221], v[220:221], v[14:15], v[14:15] op_sel:[0,0,1] op_sel_hi:[1,0,1]
    v_pk_fma_f32 v[218:219], v[218:219], v[14:15], v[14:15] op_sel:[0,0,1] op_sel_hi:[1,0,1]
    v_cvt_pk_bf16_f32 v66, v220, v221
    v_cvt_pk_bf16_f32 v67, v218, v219
    ds_write2st64_b64 v227, v[64:65], v[66:67] offset0:4 offset1:5
    v_lshlrev_b32_e64 v220, 16, v68
    buffer_load_dwordx4 v241, s[36:39], s78 offen offset:1024  lds
    v_lshlrev_b32_e64 v218, 16, v69
    v_and_b32 v221, 0xffff0000, v68
    v_and_b32 v219, 0xffff0000, v69
    v_pk_fma_f32 v[220:221], v[220:221], v[14:15], v[14:15] op_sel:[0,0,1] op_sel_hi:[1,0,1]
    v_pk_fma_f32 v[218:219], v[218:219], v[14:15], v[14:15] op_sel:[0,0,1] op_sel_hi:[1,0,1]
    v_cvt_pk_bf16_f32 v68, v220, v221
    v_cvt_pk_bf16_f32 v69, v218, v219
    v_lshlrev_b32 v220, 16, v70
    v_lshlrev_b32 v218, 16, v71
    v_and_b32 v221, 0xffff0000, v70
    v_and_b32 v219, 0xffff0000, v71
    v_pk_fma_f32 v[220:221], v[220:221], v[14:15], v[14:15] op_sel:[0,0,1] op_sel_hi:[1,0,1]
    v_pk_fma_f32 v[218:219], v[218:219], v[14:15], v[14:15] op_sel:[0,0,1] op_sel_hi:[1,0,1]
    buffer_load_dwordx4 v240, s[36:39], s78 offen offset:2048  lds
    v_cvt_pk_bf16_f32 v70, v220, v221
    v_cvt_pk_bf16_f32 v71, v218, v219
    ds_write2st64_b64 v227, v[68:69], v[70:71] offset0:8 offset1:9
    s_sub_u32 s90, s31, 0
    s_mul_i32 s90, s90, 49
    s_lshr_b32 s90, s90, 4
    s_lshl_b32 s90, s90, 7
    v_min_u32 v245, 384, v253
    buffer_load_dword v7, v245, s[52:55], s90 offen
    buffer_load_dword v7, v245, s[44:47], s90 offen
    s_sub_u32 s90, s31, 0
    s_mul_i32 s90, s90, 49
    s_lshr_b32 s90, s90, 2
    s_lshl_b32 s90, s90, 7
    v_min_u32 v245, 1536, v253
    buffer_load_dword v7, v245, s[60:63], s90 offen
    s_lshl_b32 s90, s3, 5
    s_add_u32 s90, s90, s4
    s_lshl_b32 s90, s90, 2
    s_add_u32 s90, s90, 4096
    v_lshlrev_b32 v245, 12, v1
    v_min_u32 v245, 28672, v245
    buffer_load_dword v7, v245, s[72:75], s90 offen sc1
    v_lshlrev_b32 v220, 16, v72
    v_lshlrev_b32 v218, 16, v73
    v_and_b32 v221, 0xffff0000, v72
    v_and_b32 v219, 0xffff0000, v73
    v_pk_fma_f32 v[220:221], v[220:221], v[14:15], v[14:15] op_sel:[0,0,1] op_sel_hi:[1,0,1]
    v_pk_fma_f32 v[218:219], v[218:219], v[14:15], v[14:15] op_sel:[0,0,1] op_sel_hi:[1,0,1]
    v_cvt_pk_bf16_f32 v72, v220, v221
    v_cvt_pk_bf16_f32 v73, v218, v219
    v_lshlrev_b32 v220, 16, v74
    v_lshlrev_b32 v218, 16, v75
    v_and_b32 v221, 0xffff0000, v74
    buffer_load_dwordx4 v239, s[36:39], s78 offen offset:3072  lds
    v_and_b32 v219, 0xffff0000, v75
    v_pk_fma_f32 v[220:221], v[220:221], v[14:15], v[14:15] op_sel:[0,0,1] op_sel_hi:[1,0,1]
    v_pk_fma_f32 v[218:219], v[218:219], v[14:15], v[14:15] op_sel:[0,0,1] op_sel_hi:[1,0,1]
    v_cvt_pk_bf16_f32 v74, v220, v221
    v_cvt_pk_bf16_f32 v75, v218, v219
    ds_write2st64_b64 v227, v[72:73], v[74:75] offset0:12 offset1:13
    v_lshlrev_b32 v220, 16, v76
    v_lshlrev_b32 v218, 16, v77
    v_and_b32 v221, 0xffff0000, v76
    s_add_u32 m0, s18, 118784
    s_add_u32 s78, s81, 87808
    buffer_load_dwordx4 v246, s[36:39], s78 offen offset:0  lds
    v_and_b32 v219, 0xffff0000, v77
    v_pk_fma_f32 v[220:221], v[220:221], v[14:15], v[14:15] op_sel:[0,0,1] op_sel_hi:[1,0,1]
    v_pk_fma_f32 v[218:219], v[218:219], v[14:15], v[14:15] op_sel:[0,0,1] op_sel_hi:[1,0,1]
    v_cvt_pk_bf16_f32 v76, v220, v221
    v_cvt_pk_bf16_f32 v77, v218, v219
    v_lshlrev_b32 v220, 16, v78
    v_lshlrev_b32 v218, 16, v79
    v_and_b32 v221, 0xffff0000, v78
    v_and_b32 v219, 0xffff0000, v79
    v_pk_fma_f32 v[220:221], v[220:221], v[14:15], v[14:15] op_sel:[0,0,1] op_sel_hi:[1,0,1]
    v_pk_fma_f32 v[218:219], v[218:219], v[14:15], v[14:15] op_sel:[0,0,1] op_sel_hi:[1,0,1]
    v_cvt_pk_bf16_f32 v78, v220, v221
    v_cvt_pk_bf16_f32 v79, v218, v219
    ds_write2st64_b64 v227, v[76:77], v[78:79] offset0:16 offset1:17
    v_lshlrev_b32_e64 v220, 16, v80
    buffer_load_dwordx4 v241, s[36:39], s78 offen offset:1024  lds
    v_lshlrev_b32_e64 v218, 16, v81
    v_and_b32 v221, 0xffff0000, v80
    v_and_b32 v219, 0xffff0000, v81
    v_pk_fma_f32 v[220:221], v[220:221], v[14:15], v[14:15] op_sel:[0,0,1] op_sel_hi:[1,0,1]
    v_pk_fma_f32 v[218:219], v[218:219], v[14:15], v[14:15] op_sel:[0,0,1] op_sel_hi:[1,0,1]
    v_cvt_pk_bf16_f32 v80, v220, v221
    v_cvt_pk_bf16_f32 v81, v218, v219
    v_lshlrev_b32 v220, 16, v82
    v_lshlrev_b32 v218, 16, v83
    buffer_load_dwordx4 v240, s[36:39], s78 offen offset:2048  lds
    v_and_b32 v221, 0xffff0000, v82
    v_and_b32 v219, 0xffff0000, v83
    v_pk_fma_f32 v[220:221], v[220:221], v[14:15], v[14:15] op_sel:[0,0,1] op_sel_hi:[1,0,1]
    v_pk_fma_f32 v[218:219], v[218:219], v[14:15], v[14:15] op_sel:[0,0,1] op_sel_hi:[1,0,1]
    v_cvt_pk_bf16_f32 v82, v220, v221
    v_cvt_pk_bf16_f32 v83, v218, v219
    ds_write2st64_b64 v227, v[80:81], v[82:83] offset0:20 offset1:21
    v_lshlrev_b32 v220, 16, v84
    v_lshlrev_b32 v218, 16, v85
    v_and_b32 v221, 0xffff0000, v84
    v_and_b32 v219, 0xffff0000, v85
    v_pk_fma_f32 v[220:221], v[220:221], v[14:15], v[14:15] op_sel:[0,0,1] op_sel_hi:[1,0,1]
    v_pk_fma_f32 v[218:219], v[218:219], v[14:15], v[14:15] op_sel:[0,0,1] op_sel_hi:[1,0,1]
    v_cvt_pk_bf16_f32 v84, v220, v221
    v_cvt_pk_bf16_f32 v85, v218, v219
    v_lshlrev_b32 v220, 16, v86
    v_lshlrev_b32 v218, 16, v87
    v_and_b32 v221, 0xffff0000, v86
    v_and_b32 v219, 0xffff0000, v87
    v_pk_fma_f32 v[220:221], v[220:221], v[14:15], v[14:15] op_sel:[0,0,1] op_sel_hi:[1,0,1]
    v_pk_fma_f32 v[218:219], v[218:219], v[14:15], v[14:15] op_sel:[0,0,1] op_sel_hi:[1,0,1]
    v_cvt_pk_bf16_f32 v86, v220, v221
    v_cvt_pk_bf16_f32 v87, v218, v219
    ds_write2st64_b64 v227, v[84:85], v[86:87] offset0:24 offset1:25
    v_lshlrev_b32 v220, 16, v88
    v_lshlrev_b32 v218, 16, v89
    v_and_b32 v221, 0xffff0000, v88
    v_and_b32 v219, 0xffff0000, v89
    v_pk_fma_f32 v[220:221], v[220:221], v[14:15], v[14:15] op_sel:[0,0,1] op_sel_hi:[1,0,1]
    v_pk_fma_f32 v[218:219], v[218:219], v[14:15], v[14:15] op_sel:[0,0,1] op_sel_hi:[1,0,1]
    v_cvt_pk_bf16_f32 v88, v220, v221
    v_cvt_pk_bf16_f32 v89, v218, v219
    v_lshlrev_b32 v220, 16, v90
    v_lshlrev_b32 v218, 16, v91
    v_and_b32 v221, 0xffff0000, v90
    v_and_b32 v219, 0xffff0000, v91
    v_pk_fma_f32 v[220:221], v[220:221], v[14:15], v[14:15] op_sel:[0,0,1] op_sel_hi:[1,0,1]
    v_pk_fma_f32 v[218:219], v[218:219], v[14:15], v[14:15] op_sel:[0,0,1] op_sel_hi:[1,0,1]
    v_cvt_pk_bf16_f32 v90, v220, v221
    v_cvt_pk_bf16_f32 v91, v218, v219
    ds_write2st64_b64 v227, v[88:89], v[90:91] offset0:28 offset1:29
    v_lshlrev_b32 v220, 16, v92
    v_lshlrev_b32 v218, 16, v93
    v_and_b32 v221, 0xffff0000, v92
    v_and_b32 v219, 0xffff0000, v93
    v_pk_fma_f32 v[220:221], v[220:221], v[14:15], v[14:15] op_sel:[0,0,1] op_sel_hi:[1,0,1]
    v_pk_fma_f32 v[218:219], v[218:219], v[14:15], v[14:15] op_sel:[0,0,1] op_sel_hi:[1,0,1]
    v_cvt_pk_bf16_f32 v92, v220, v221
    v_cvt_pk_bf16_f32 v93, v218, v219
    v_lshlrev_b32 v220, 16, v94
    v_lshlrev_b32 v218, 16, v95
    v_and_b32 v221, 0xffff0000, v94
    v_and_b32 v219, 0xffff0000, v95
    v_pk_fma_f32 v[220:221], v[220:221], v[14:15], v[14:15] op_sel:[0,0,1] op_sel_hi:[1,0,1]
    v_pk_fma_f32 v[218:219], v[218:219], v[14:15], v[14:15] op_sel:[0,0,1] op_sel_hi:[1,0,1]
    v_cvt_pk_bf16_f32 v94, v220, v221
    v_cvt_pk_bf16_f32 v95, v218, v219
    ds_write2st64_b64 v227, v[92:93], v[94:95] offset0:32 offset1:33
    v_lshlrev_b32 v220, 16, v96
    v_lshlrev_b32 v218, 16, v97
    v_and_b32 v221, 0xffff0000, v96
    v_and_b32 v219, 0xffff0000, v97
    v_pk_fma_f32 v[220:221], v[220:221], v[14:15], v[14:15] op_sel:[0,0,1] op_sel_hi:[1,0,1]
    v_pk_fma_f32 v[218:219], v[218:219], v[14:15], v[14:15] op_sel:[0,0,1] op_sel_hi:[1,0,1]
    v_cvt_pk_bf16_f32 v96, v220, v221
    v_cvt_pk_bf16_f32 v97, v218, v219
    v_lshlrev_b32 v220, 16, v98
    v_lshlrev_b32 v218, 16, v99
    v_and_b32 v221, 0xffff0000, v98
    v_and_b32 v219, 0xffff0000, v99
    v_pk_fma_f32 v[220:221], v[220:221], v[14:15], v[14:15] op_sel:[0,0,1] op_sel_hi:[1,0,1]
    v_pk_fma_f32 v[218:219], v[218:219], v[14:15], v[14:15] op_sel:[0,0,1] op_sel_hi:[1,0,1]
    v_cvt_pk_bf16_f32 v98, v220, v221
    v_cvt_pk_bf16_f32 v99, v218, v219
    ds_write2st64_b64 v227, v[96:97], v[98:99] offset0:36 offset1:37
    v_lshlrev_b32 v220, 16, v100
    v_lshlrev_b32 v218, 16, v101
    v_and_b32 v221, 0xffff0000, v100
    v_and_b32 v219, 0xffff0000, v101
    v_pk_fma_f32 v[220:221], v[220:221], v[14:15], v[14:15] op_sel:[0,0,1] op_sel_hi:[1,0,1]
    v_pk_fma_f32 v[218:219], v[218:219], v[14:15], v[14:15] op_sel:[0,0,1] op_sel_hi:[1,0,1]
    v_cvt_pk_bf16_f32 v100, v220, v221
    v_cvt_pk_bf16_f32 v101, v218, v219
    v_lshlrev_b32 v220, 16, v102
    v_lshlrev_b32 v218, 16, v103
    v_and_b32 v221, 0xffff0000, v102
    v_and_b32 v219, 0xffff0000, v103
    v_pk_fma_f32 v[220:221], v[220:221], v[14:15], v[14:15] op_sel:[0,0,1] op_sel_hi:[1,0,1]
    v_pk_fma_f32 v[218:219], v[218:219], v[14:15], v[14:15] op_sel:[0,0,1] op_sel_hi:[1,0,1]
    v_cvt_pk_bf16_f32 v102, v220, v221
    v_cvt_pk_bf16_f32 v103, v218, v219
    ds_write2st64_b64 v227, v[100:101], v[102:103] offset0:40 offset1:41
    v_lshlrev_b32 v220, 16, v104
    v_lshlrev_b32 v218, 16, v105
    v_and_b32 v221, 0xffff0000, v104
    v_and_b32 v219, 0xffff0000, v105
    v_pk_fma_f32 v[220:221], v[220:221], v[14:15], v[14:15] op_sel:[0,0,1] op_sel_hi:[1,0,1]
    v_pk_fma_f32 v[218:219], v[218:219], v[14:15], v[14:15] op_sel:[0,0,1] op_sel_hi:[1,0,1]
    v_cvt_pk_bf16_f32 v104, v220, v221
    v_cvt_pk_bf16_f32 v105, v218, v219
    v_lshlrev_b32 v220, 16, v106
    v_lshlrev_b32 v218, 16, v107
    v_and_b32 v221, 0xffff0000, v106
    v_and_b32 v219, 0xffff0000, v107
    v_pk_fma_f32 v[220:221], v[220:221], v[14:15], v[14:15] op_sel:[0,0,1] op_sel_hi:[1,0,1]
    v_pk_fma_f32 v[218:219], v[218:219], v[14:15], v[14:15] op_sel:[0,0,1] op_sel_hi:[1,0,1]
    v_cvt_pk_bf16_f32 v106, v220, v221
    v_cvt_pk_bf16_f32 v107, v218, v219
    ds_write2st64_b64 v227, v[104:105], v[106:107] offset0:44 offset1:45
    v_lshlrev_b32 v220, 16, v108
    v_lshlrev_b32 v218, 16, v109
    v_and_b32 v221, 0xffff0000, v108
    v_and_b32 v219, 0xffff0000, v109
    v_pk_fma_f32 v[220:221], v[220:221], v[14:15], v[14:15] op_sel:[0,0,1] op_sel_hi:[1,0,1]
    v_pk_fma_f32 v[218:219], v[218:219], v[14:15], v[14:15] op_sel:[0,0,1] op_sel_hi:[1,0,1]
    v_cvt_pk_bf16_f32 v108, v220, v221
    v_cvt_pk_bf16_f32 v109, v218, v219
    v_lshlrev_b32 v220, 16, v110
    v_lshlrev_b32 v218, 16, v111
    v_and_b32 v221, 0xffff0000, v110
    v_and_b32 v219, 0xffff0000, v111
    v_pk_fma_f32 v[220:221], v[220:221], v[14:15], v[14:15] op_sel:[0,0,1] op_sel_hi:[1,0,1]
    v_pk_fma_f32 v[218:219], v[218:219], v[14:15], v[14:15] op_sel:[0,0,1] op_sel_hi:[1,0,1]
    v_cvt_pk_bf16_f32 v110, v220, v221
    v_cvt_pk_bf16_f32 v111, v218, v219
    ds_write2st64_b64 v227, v[108:109], v[110:111] offset0:48 offset1:49
    v_lshlrev_b32 v220, 16, v112
    v_lshlrev_b32 v218, 16, v113
    v_and_b32 v221, 0xffff0000, v112
    v_and_b32 v219, 0xffff0000, v113
    v_pk_fma_f32 v[220:221], v[220:221], v[14:15], v[14:15] op_sel:[0,0,1] op_sel_hi:[1,0,1]
    v_pk_fma_f32 v[218:219], v[218:219], v[14:15], v[14:15] op_sel:[0,0,1] op_sel_hi:[1,0,1]
    v_cvt_pk_bf16_f32 v112, v220, v221
    v_cvt_pk_bf16_f32 v113, v218, v219
    v_lshlrev_b32 v220, 16, v114
    v_lshlrev_b32 v218, 16, v115
    v_and_b32 v221, 0xffff0000, v114
    v_and_b32 v219, 0xffff0000, v115
    v_pk_fma_f32 v[220:221], v[220:221], v[14:15], v[14:15] op_sel:[0,0,1] op_sel_hi:[1,0,1]
    v_pk_fma_f32 v[218:219], v[218:219], v[14:15], v[14:15] op_sel:[0,0,1] op_sel_hi:[1,0,1]
    v_cvt_pk_bf16_f32 v114, v220, v221
    v_cvt_pk_bf16_f32 v115, v218, v219
    ds_write2st64_b64 v227, v[112:113], v[114:115] offset0:52 offset1:53
    buffer_load_dwordx4 v[8:11], v254, s[68:71], 0 offen sc1
    s_waitcnt lgkmcnt(0)
    s_waitcnt vmcnt(12)
    s_barrier
    s_nop 0
    ds_read_b128 a[0:3], v226 offset:0
    ds_read_b64_tr_b16 v[20:21], v233 offset:57344
    ds_read_b64_tr_b16 v[22:23], v233 offset:58368
    ds_read_b128 a[4:7], v225 offset:1024
    ds_read_b64_tr_b16 v[24:25], v233 offset:59392
    ds_read_b64_tr_b16 v[26:27], v233 offset:60416
    ds_read_b128 a[8:11], v226 offset:2048
    ds_read_b64_tr_b16 v[28:29], v233 offset:61440
    ds_read_b64_tr_b16 v[30:31], v233 offset:62464
    s_waitcnt lgkmcnt(6)
    v_mfma_f32_32x32x16_bf16 v[52:67], v[20:23], a[0:3], 0
    ds_read_b128 a[12:15], v225 offset:3072
    ds_read_b64_tr_b16 v[32:33], v233 offset:63488
    ds_read_b64_tr_b16 v[34:35], v233 offset:64512
    s_waitcnt lgkmcnt(6)
    v_mfma_f32_32x32x16_bf16 v[52:67], v[24:27], a[4:7], v[52:67]
    ds_read_b128 a[16:19], v226 offset:4096
    ds_read_b64_tr_b16 v[20:21], v229 offset:0
    ds_read_b64_tr_b16 v[22:23], v229 offset:1024
    s_waitcnt lgkmcnt(6)
    v_mfma_f32_32x32x16_bf16 v[52:67], v[28:31], a[8:11], v[52:67]
    ds_read_b128 a[20:23], v225 offset:5120
    ds_read_b64_tr_b16 v[24:25], v229 offset:2048
    ds_read_b64_tr_b16 v[26:27], v229 offset:3072
    s_waitcnt lgkmcnt(6)
    v_mfma_f32_32x32x16_bf16 v[52:67], v[32:35], a[12:15], v[52:67]
    ds_read_b128 a[24:27], v226 offset:6144
    ds_read_b64_tr_b16 v[28:29], v229 offset:4096
    ds_read_b64_tr_b16 v[30:31], v229 offset:5120
    s_waitcnt lgkmcnt(6)
    v_mfma_f32_32x32x16_bf16 v[52:67], v[20:23], a[16:19], v[52:67]
    ds_read_b128 a[28:31], v225 offset:7168
    ds_read_b64_tr_b16 v[32:33], v229 offset:6144
    ds_read_b64_tr_b16 v[34:35], v229 offset:7168
    s_waitcnt lgkmcnt(6)
    v_mfma_f32_32x32x16_bf16 v[52:67], v[24:27], a[20:23], v[52:67]
    ds_read_b128 a[32:35], v226 offset:8192
    ds_read_b64_tr_b16 v[20:21], v229 offset:8192
    ds_read_b64_tr_b16 v[22:23], v229 offset:9216
    s_waitcnt lgkmcnt(6)
    v_mfma_f32_32x32x16_bf16 v[52:67], v[28:31], a[24:27], v[52:67]
    ds_read_b128 a[36:39], v225 offset:9216
    ds_read_b64_tr_b16 v[24:25], v229 offset:10240
    ds_read_b64_tr_b16 v[26:27], v229 offset:11264
    s_waitcnt lgkmcnt(6)
    v_mfma_f32_32x32x16_bf16 v[52:67], v[32:35], a[28:31], v[52:67]
    ds_read_b128 a[40:43], v226 offset:10240
    ds_read_b64_tr_b16 v[28:29], v229 offset:12288
    ds_read_b64_tr_b16 v[30:31], v229 offset:13312
    s_waitcnt lgkmcnt(6)
    v_mfma_f32_32x32x16_bf16 v[52:67], v[20:23], a[32:35], v[52:67]
    ds_read_b128 a[44:47], v225 offset:11264
    ds_read_b64_tr_b16 v[32:33], v229 offset:14336
    ds_read_b64_tr_b16 v[34:35], v229 offset:15360
    s_waitcnt lgkmcnt(6)
    v_mfma_f32_32x32x16_bf16 v[52:67], v[24:27], a[36:39], v[52:67]
    ds_read_b128 a[48:51], v226 offset:12288
    ds_read_b64_tr_b16 v[20:21], v229 offset:16384
    ds_read_b64_tr_b16 v[22:23], v229 offset:17408
    s_waitcnt lgkmcnt(6)
    v_mfma_f32_32x32x16_bf16 v[52:67], v[28:31], a[40:43], v[52:67]
    ds_read_b128 a[52:55], v225 offset:13312
    ds_read_b64_tr_b16 v[24:25], v229 offset:18432
    ds_read_b64_tr_b16 v[26:27], v229 offset:19456
    s_waitcnt lgkmcnt(6)
    v_mfma_f32_32x32x16_bf16 v[52:67], v[32:35], a[44:47], v[52:67]
    ds_read_b128 a[56:59], v226 offset:14336
    ds_read_b64_tr_b16 v[28:29], v229 offset:20480
    ds_read_b64_tr_b16 v[30:31], v229 offset:21504
    s_waitcnt lgkmcnt(6)
    v_mfma_f32_32x32x16_bf16 v[52:67], v[20:23], a[48:51], v[52:67]
    ds_read_b128 a[60:63], v225 offset:15360
    ds_read_b64_tr_b16 v[32:33], v229 offset:22528
    ds_read_b64_tr_b16 v[34:35], v229 offset:23552
    s_waitcnt lgkmcnt(6)
    v_mfma_f32_32x32x16_bf16 v[52:67], v[24:27], a[52:55], v[52:67]
    ds_read_b128 a[64:67], v226 offset:16384
    ds_read_b64_tr_b16 v[20:21], v229 offset:24576
    ds_read_b64_tr_b16 v[22:23], v229 offset:25600
    s_waitcnt lgkmcnt(6)
    v_mfma_f32_32x32x16_bf16 v[52:67], v[28:31], a[56:59], v[52:67]
    ds_read_b128 a[68:71], v225 offset:17408
    ds_read_b64_tr_b16 v[24:25], v229 offset:26624
    ds_read_b64_tr_b16 v[26:27], v229 offset:27648
    s_barrier
    s_waitcnt lgkmcnt(6)
    s_nop 0
    v_mfma_f32_32x32x16_bf16 v[52:67], v[32:35], a[60:63], v[52:67]
    ds_read_b128 a[72:75], v226 offset:18432
    ds_read_b64_tr_b16 v[28:29], v229 offset:28672
    ds_read_b64_tr_b16 v[30:31], v229 offset:29696
    s_add_u32 m0, s18, 57344
    s_add_u32 s78, s82, 1792
    buffer_load_dwordx4 v246, s[36:39], s78 offen offset:0  lds
    s_waitcnt lgkmcnt(6)
    s_nop 0
    v_mfma_f32_32x32x16_bf16 v[52:67], v[20:23], a[64:67], v[52:67]
    ds_read_b128 a[76:79], v225 offset:19456
    ds_read_b64_tr_b16 v[32:33], v229 offset:30720
    ds_read_b64_tr_b16 v[34:35], v229 offset:31744
    buffer_load_dwordx4 v241, s[36:39], s78 offen offset:1024  lds
    buffer_load_dwordx4 v240, s[36:39], s78 offen offset:2048  lds
    buffer_load_dwordx4 v239, s[36:39], s78 offen offset:3072  lds
    s_waitcnt lgkmcnt(6)
    s_nop 0
    v_mfma_f32_32x32x16_bf16 v[52:67], v[24:27], a[68:71], v[52:67]
    ds_read_b128 a[80:83], v226 offset:20480
    ds_read_b64_tr_b16 v[20:21], v229 offset:32768
    ds_read_b64_tr_b16 v[22:23], v229 offset:33792
    s_add_u32 m0, s18, 61440
    s_add_u32 s78, s82, 87808
    buffer_load_dwordx4 v246, s[36:39], s78 offen offset:0  lds
    s_waitcnt lgkmcnt(6)
    s_nop 0
    v_mfma_f32_32x32x16_bf16 v[52:67], v[28:31], a[72:75], v[52:67]
    ds_read_b128 a[84:87], v225 offset:21504
    ds_read_b64_tr_b16 v[24:25], v229 offset:34816
    ds_read_b64_tr_b16 v[26:27], v229 offset:35840
    buffer_load_dwordx4 v241, s[36:39], s78 offen offset:1024  lds
    buffer_load_dwordx4 v240, s[36:39], s78 offen offset:2048  lds
    s_waitcnt lgkmcnt(6)
    v_mfma_f32_32x32x16_bf16 v[52:67], v[32:35], a[76:79], v[52:67]
    ds_read_b128 a[88:91], v226 offset:22528
    ds_read_b64_tr_b16 v[28:29], v229 offset:36864
    ds_read_b64_tr_b16 v[30:31], v229 offset:37888
    s_waitcnt lgkmcnt(6)
    v_mfma_f32_32x32x16_bf16 v[52:67], v[20:23], a[80:83], v[52:67]
    ds_read_b128 a[92:95], v225 offset:23552
    ds_read_b64_tr_b16 v[32:33], v229 offset:38912
    ds_read_b64_tr_b16 v[34:35], v229 offset:39936
    s_waitcnt lgkmcnt(6)
    v_mfma_f32_32x32x16_bf16 v[52:67], v[24:27], a[84:87], v[52:67]
    ds_read_b128 a[96:99], v226 offset:24576
    ds_read_b64_tr_b16 v[20:21], v229 offset:40960
    ds_read_b64_tr_b16 v[22:23], v229 offset:41984
    s_waitcnt lgkmcnt(6)
    v_mfma_f32_32x32x16_bf16 v[52:67], v[28:31], a[88:91], v[52:67]
    ds_read_b128 a[100:103], v225 offset:25600
    ds_read_b64_tr_b16 v[24:25], v229 offset:43008
    ds_read_b64_tr_b16 v[26:27], v229 offset:44032
    s_waitcnt vmcnt(7)
    v_readfirstlane_b32 s8, v9
    s_nop 0
    s_cmp_lt_u32 s8, 1
    s_cbranch_scc1 L_tok_retry_s
L_tok_ok_s:
    v_mov_b32 v251, v8
    s_waitcnt lgkmcnt(6)
    v_mfma_f32_32x32x16_bf16 v[52:67], v[32:35], a[92:95], v[52:67]
    ds_read_b128 a[104:107], v226 offset:26624
    ds_read_b64_tr_b16 v[28:29], v229 offset:45056
    ds_read_b64_tr_b16 v[30:31], v229 offset:46080
    s_waitcnt lgkmcnt(6)
    v_mfma_f32_32x32x16_bf16 v[52:67], v[20:23], a[96:99], v[52:67]
    ds_read_b128 a[108:111], v225 offset:27648
    ds_read_b64_tr_b16 v[32:33], v229 offset:47104
    ds_read_b64_tr_b16 v[34:35], v229 offset:48128
    s_waitcnt lgkmcnt(6)
    v_mfma_f32_32x32x16_bf16 v[52:67], v[24:27], a[100:103], v[52:67]
    s_waitcnt lgkmcnt(3)
    v_mfma_f32_32x32x16_bf16 v[52:67], v[28:31], a[104:107], v[52:67]
    ds_read_b64_tr_b16 a[112:113], v222 offset:0
    ds_read_b64_tr_b16 a[114:115], v222 offset:448
    ds_read_b64_tr_b16 a[116:117], v222 offset:896
    ds_read_b64_tr_b16 a[118:119], v223 offset:1344
    s_waitcnt lgkmcnt(4)
    v_mfma_f32_32x32x16_bf16 v[52:67], v[32:35], a[108:111], v[52:67]
    s_mul_i32 s8, s5, 4608
    s_add_u32 s8, s8, 143360
    v_mul_u32_u24 v2, 144, v230
    v_and_b32 v3, 32, v1
    v_add3_u32 v224, v2, v3, s8
    v_bfe_u32 v3, v232, 3, 1
    v_lshlrev_b32 v3, 5, v3
    v_lshrrev_b32 v4, 4, v232
    v_lshl_add_u32 v3, v4, 3, v3
    v_mul_u32_u24 v4, 144, v231
    v_add3_u32 v3, v3, v4, s8
    v_add_u32 v248, s8, v252
    s_lshl_b32 s9, s6, 6
    v_add_u32 v221, s9, v3
    s_xor_b32 s9, s9, 64
    v_add_u32 v220, s9, v3
    s_xor_b32 s9, s5, 1
    s_mul_i32 s9, s9, 4608
    s_add_u32 s9, s9, 143360
    v_add_u32 v245, s9, v252
    s_xor_b32 s9, s5, 2
    s_mul_i32 s9, s9, 4608
    s_add_u32 s9, s9, 143360
    v_add_u32 v227, s9, v252
    s_lshl_b32 s14, s13, 1
    s_add_u32 s14, s14, s6
    s_lshl_b32 s14, s14, 5
    s_add_u32 s14, s14, s3
    s_lshl_b32 s14, s14, 11
    s_add_u32 s14, s14, 6553600
    s_waitcnt lgkmcnt(0)
    s_barrier
    v_cvt_pk_bf16_f32 v8, v52, v53
    s_add_u32 m0, s18, 0
    s_add_u32 s78, s79, 0
    buffer_load_dwordx4 v247, s[56:59], s78 offen offset:0  lds
    v_cvt_pk_bf16_f32 v9, v54, v55
    buffer_load_dwordx4 v244, s[56:59], s78 offen offset:1024  lds
    v_cvt_pk_bf16_f32 v10, v56, v57
    buffer_load_dwordx4 v243, s[56:59], s78 offen offset:2048  lds
    v_cvt_pk_bf16_f32 v11, v58, v59
    v_cvt_pk_bf16_f32 v12, v60, v61
    v_cvt_pk_bf16_f32 v13, v62, v63
    v_cvt_pk_bf16_f32 v14, v64, v65
    v_cvt_pk_bf16_f32 v15, v66, v67
    v_and_b32 v14, v14, v238
    v_and_b32 v15, v15, v238
    v_mfma_f32_32x32x16_bf16 v[52:67], a[112:115], v[8:11], 0
    s_nop 0
    v_mfma_f32_32x32x16_bf16 v[52:67], a[116:119], v[12:15], v[52:67]
    buffer_load_dwordx4 v242, s[56:59], s78 offen offset:3072  lds
    s_nop 10
    v_max3_f32 v222, v52, v53, v54
    v_max3_f32 v223, -v52, -v53, -v54
    v_max3_f32 v222, v222, v55, v56
    s_add_u32 m0, s18, 4096
    s_add_u32 s78, s79, 114688
    buffer_load_dwordx4 v247, s[56:59], s78 offen offset:0  lds
    v_max3_f32 v223, v223, -v55, -v56
    v_max3_f32 v222, v222, v57, v58
    v_max3_f32 v223, v223, -v57, -v58
    v_max3_f32 v222, v222, v59, v60
    v_max3_f32 v223, v223, -v59, -v60
    v_max3_f32 v222, v222, v61, v62
    v_max3_f32 v223, v223, -v61, -v62
    v_max3_f32 v222, v222, v63, v64
    v_max3_f32 v223, v223, -v63, -v64
    v_max3_f32 v222, v222, v65, v66
    v_max3_f32 v223, v223, -v65, -v66
    v_max_f32_e64 v222, v222, v67
    v_max_f32_e64 v223, v223, -v67
    s_nop 1
    v_permlane32_swap_b32 v222, v223
    buffer_load_dwordx4 v244, s[56:59], s78 offen offset:1024  lds
    v_max_f32_e64 v222, v222, v223
    v_mul_f32 v222, 0xbfb8aa3b, v222
    v_mov_b32 v223, v222
    s_nop 1
    v_permlane32_swap_b32 v222, v223
    s_nop 0
    v_pk_fma_f32 v[100:101], v[52:53], s[98:99], v[222:223] op_sel:[0,0,1] op_sel_hi:[1,0,1] neg_lo:[1,0,0] neg_hi:[1,0,0]
    v_pk_fma_f32 v[52:53], v[52:53], s[98:99], v[222:223] op_sel_hi:[1,0,0]
    v_pk_fma_f32 v[102:103], v[54:55], s[98:99], v[222:223] op_sel:[0,0,1] op_sel_hi:[1,0,1] neg_lo:[1,0,0] neg_hi:[1,0,0]
    v_pk_fma_f32 v[54:55], v[54:55], s[98:99], v[222:223] op_sel_hi:[1,0,0]
    v_pk_fma_f32 v[104:105], v[56:57], s[98:99], v[222:223] op_sel:[0,0,1] op_sel_hi:[1,0,1] neg_lo:[1,0,0] neg_hi:[1,0,0]
    v_pk_fma_f32 v[56:57], v[56:57], s[98:99], v[222:223] op_sel_hi:[1,0,0]
    v_pk_fma_f32 v[106:107], v[58:59], s[98:99], v[222:223] op_sel:[0,0,1] op_sel_hi:[1,0,1] neg_lo:[1,0,0] neg_hi:[1,0,0]
    buffer_load_dwordx4 v243, s[56:59], s78 offen offset:2048  lds
    v_pk_fma_f32 v[58:59], v[58:59], s[98:99], v[222:223] op_sel_hi:[1,0,0]
    v_pk_fma_f32 v[108:109], v[60:61], s[98:99], v[222:223] op_sel:[0,0,1] op_sel_hi:[1,0,1] neg_lo:[1,0,0] neg_hi:[1,0,0]
    v_pk_fma_f32 v[60:61], v[60:61], s[98:99], v[222:223] op_sel_hi:[1,0,0]
    v_pk_fma_f32 v[110:111], v[62:63], s[98:99], v[222:223] op_sel:[0,0,1] op_sel_hi:[1,0,1] neg_lo:[1,0,0] neg_hi:[1,0,0]
    v_pk_fma_f32 v[62:63], v[62:63], s[98:99], v[222:223] op_sel_hi:[1,0,0]
    v_pk_fma_f32 v[112:113], v[64:65], s[98:99], v[222:223] op_sel:[0,0,1] op_sel_hi:[1,0,1] neg_lo:[1,0,0] neg_hi:[1,0,0]
    v_pk_fma_f32 v[64:65], v[64:65], s[98:99], v[222:223] op_sel_hi:[1,0,0]
    v_pk_fma_f32 v[114:115], v[66:67], s[98:99], v[222:223] op_sel:[0,0,1] op_sel_hi:[1,0,1] neg_lo:[1,0,0] neg_hi:[1,0,0]
    v_pk_fma_f32 v[66:67], v[66:67], s[98:99], v[222:223] op_sel_hi:[1,0,0]
    v_exp_f32 v52, v52
    v_exp_f32 v100, v100
    v_exp_f32 v53, v53
    v_exp_f32 v101, v101
    s_add_u32 m0, s18, 28672
    s_add_u32 s78, s80, 0
    buffer_load_dwordx4 v247, s[56:59], s78 offen offset:0  lds
    v_exp_f32 v54, v54
    v_exp_f32 v102, v102
    v_exp_f32 v55, v55
    v_exp_f32 v103, v103
    v_exp_f32 v56, v56
    v_exp_f32 v104, v104
    v_exp_f32 v57, v57
    v_exp_f32 v105, v105
    v_exp_f32 v58, v58
    v_exp_f32 v106, v106
    v_exp_f32 v59, v59
    buffer_load_dwordx4 v244, s[56:59], s78 offen offset:1024  lds
    v_exp_f32 v107, v107
    v_exp_f32 v60, v60
    v_exp_f32 v108, v108
    v_exp_f32 v61, v61
    v_exp_f32 v109, v109
    v_exp_f32 v62, v62
    v_exp_f32 v110, v110
    v_exp_f32 v63, v63
    buffer_load_dwordx4 v243, s[56:59], s78 offen offset:2048  lds
    v_exp_f32 v111, v111
    v_exp_f32 v64, v64
    v_exp_f32 v112, v112
    v_exp_f32 v65, v65
    v_exp_f32 v113, v113
    v_exp_f32 v66, v66
    v_exp_f32 v114, v114
    v_exp_f32 v67, v67
    buffer_load_dwordx4 v242, s[56:59], s78 offen offset:3072  lds
    v_exp_f32_e64 v115, v115
    v_pk_add_f32 v[218:219], v[52:53], v[54:55]
    v_pk_add_f32 v[216:217], v[100:101], v[102:103]
    v_pk_add_f32 v[214:215], v[64:65], v[66:67]
    v_pk_add_f32 v[212:213], v[112:113], v[114:115]
    v_pk_add_f32 v[218:219], v[218:219], v[56:57]
    v_pk_add_f32 v[216:217], v[216:217], v[104:105]
    v_pk_add_f32 v[218:219], v[218:219], v[58:59]
    v_pk_add_f32 v[216:217], v[216:217], v[106:107]
    v_pk_add_f32 v[218:219], v[218:219], v[60:61]
    v_pk_add_f32 v[216:217], v[216:217], v[108:109]
    v_pk_add_f32 v[218:219], v[218:219], v[62:63]
    v_pk_add_f32 v[216:217], v[216:217], v[110:111]
    v_pk_fma_f32 v[218:219], v[214:215], v[236:237], v[218:219] op_sel_hi:[1,0,1]
    v_pk_fma_f32 v[216:217], v[212:213], v[236:237], v[216:217] op_sel_hi:[1,0,1]
    s_add_u32 m0, s18, 32768
    s_add_u32 s78, s80, 114688
    buffer_load_dwordx4 v247, s[56:59], s78 offen offset:0  lds
    v_add_f32 v218, v218, v219
    v_add_f32 v216, v216, v217
    s_nop 1
    v_permlane32_swap_b32 v218, v216
    v_add_f32 v218, v218, v216
    v_rcp_f32 v218, v218
    s_nop 0
    v_mov_b32 v216, v218
    s_nop 1
    v_permlane32_swap_b32 v218, v216
    buffer_load_dwordx4 v244, s[56:59], s78 offen offset:1024  lds
    v_mul_f32 v219, v218, v236
    v_mul_f32 v217, v216, v236
    v_pk_mul_f32 v[52:53], v[52:53], v[218:219] op_sel_hi:[1,0]
    v_pk_mul_f32 v[54:55], v[54:55], v[218:219] op_sel_hi:[1,0]
    v_pk_mul_f32 v[56:57], v[56:57], v[218:219] op_sel_hi:[1,0]
    v_pk_mul_f32 v[58:59], v[58:59], v[218:219] op_sel_hi:[1,0]
    v_pk_mul_f32 v[60:61], v[60:61], v[218:219] op_sel_hi:[1,0]
    v_pk_mul_f32 v[62:63], v[62:63], v[218:219] op_sel_hi:[1,0]
    v_pk_mul_f32 v[64:65], v[64:65], v[218:219] op_sel:[0,1] op_sel_hi:[1,1]
    v_pk_mul_f32 v[66:67], v[66:67], v[218:219] op_sel:[0,1] op_sel_hi:[1,1]
    v_cvt_pk_bf16_f32 v68, v52, v53
    v_cvt_pk_bf16_f32 v69, v54, v55
    v_cvt_pk_bf16_f32 v70, v56, v57
    v_cvt_pk_bf16_f32 v71, v58, v59
    v_cvt_pk_bf16_f32 v72, v60, v61
    v_cvt_pk_bf16_f32 v73, v62, v63
    buffer_load_dwordx4 v243, s[56:59], s78 offen offset:2048  lds
    v_cvt_pk_bf16_f32 v74, v64, v65
    v_cvt_pk_bf16_f32 v75, v66, v67
    v_pk_mul_f32 v[100:101], v[100:101], v[216:217] op_sel_hi:[1,0]
    v_pk_mul_f32 v[102:103], v[102:103], v[216:217] op_sel_hi:[1,0]
    v_pk_mul_f32 v[104:105], v[104:105], v[216:217] op_sel_hi:[1,0]
    v_pk_mul_f32 v[106:107], v[106:107], v[216:217] op_sel_hi:[1,0]
    v_pk_mul_f32 v[108:109], v[108:109], v[216:217] op_sel_hi:[1,0]
    v_pk_mul_f32 v[110:111], v[110:111], v[216:217] op_sel_hi:[1,0]
    v_pk_mul_f32 v[112:113], v[112:113], v[216:217] op_sel:[0,1] op_sel_hi:[1,1]
    v_pk_mul_f32 v[114:115], v[114:115], v[216:217] op_sel:[0,1] op_sel_hi:[1,1]
    v_cvt_pk_bf16_f32 v76, v100, v101
    v_cvt_pk_bf16_f32 v77, v102, v103
    v_cvt_pk_bf16_f32 v78, v104, v105
    v_cvt_pk_bf16_f32 v79, v106, v107
    v_cvt_pk_bf16_f32 v80, v108, v109
    v_cvt_pk_bf16_f32 v81, v110, v111
    v_cvt_pk_bf16_f32 v82, v112, v113
    s_add_u32 m0, s18, 86016
    s_add_u32 s78, s81, 0
    s_nop 0
    buffer_load_dwordx4 v246, s[36:39], s78 offen offset:0  lds
    v_cvt_pk_bf16_f32 v83, v114, v115
    ds_write_b128 v224, v[68:71] offset:0
    ds_write_b128 v224, v[72:75] offset:16
    ds_write_b128 v224, v[76:79] offset:64
    ds_write_b128 v224, v[80:83] offset:80
    ds_read_b64_tr_b16 v[20:21], v229 offset:49152
    ds_read_b64_tr_b16 v[22:23], v229 offset:50176
    ds_read_b64_tr_b16 v[24:25], v229 offset:51200
    ds_read_b64_tr_b16 v[26:27], v229 offset:52224
    ds_read_b64_tr_b16 v[28:29], v229 offset:53248
    ds_read_b64_tr_b16 v[30:31], v229 offset:54272
    s_waitcnt lgkmcnt(4)
    s_nop 0
    v_mfma_f32_32x32x16_bf16 v[84:99], a[0:3], v[20:23], 0
    ds_read_b64_tr_b16 v[32:33], v229 offset:55296
    ds_read_b64_tr_b16 v[34:35], v229 offset:56320
    buffer_load_dwordx4 v241, s[36:39], s78 offen offset:1024  lds
    buffer_load_dwordx4 v240, s[36:39], s78 offen offset:2048  lds
    buffer_load_dwordx4 v239, s[36:39], s78 offen offset:3072  lds
    s_waitcnt lgkmcnt(4)
    v_mfma_f32_32x32x16_bf16 v[84:99], a[4:7], v[24:27], v[84:99]
    ds_read_b64_tr_b16 v[20:21], v229 offset:57344
    ds_read_b64_tr_b16 v[22:23], v229 offset:58368
    s_waitcnt lgkmcnt(4)
    v_mfma_f32_32x32x16_bf16 v[84:99], a[8:11], v[28:31], v[84:99]
    ds_read_b64_tr_b16 v[24:25], v229 offset:59392
    ds_read_b64_tr_b16 v[26:27], v229 offset:60416
    s_add_u32 m0, s18, 90112
    s_add_u32 s78, s81, 86016
    buffer_load_dwordx4 v246, s[36:39], s78 offen offset:0  lds
    s_waitcnt lgkmcnt(4)
    v_mfma_f32_32x32x16_bf16 v[84:99], a[12:15], v[32:35], v[84:99]
    ds_read_b64_tr_b16 v[28:29], v229 offset:61440
    ds_read_b64_tr_b16 v[30:31], v229 offset:62464
    s_waitcnt lgkmcnt(4)
    v_mfma_f32_32x32x16_bf16 v[84:99], a[16:19], v[20:23], v[84:99]
    ds_read_b64_tr_b16 v[32:33], v229 offset:63488
    ds_read_b64_tr_b16 v[34:35], v229 offset:64512
    s_waitcnt lgkmcnt(4)
    v_mfma_f32_32x32x16_bf16 v[84:99], a[20:23], v[24:27], v[84:99]
    ds_read_b64_tr_b16 v[20:21], v228 offset:0
    ds_read_b64_tr_b16 v[22:23], v228 offset:1024
    buffer_load_dwordx4 v241, s[36:39], s78 offen offset:1024  lds
    s_waitcnt lgkmcnt(4)
    v_mfma_f32_32x32x16_bf16 v[84:99], a[24:27], v[28:31], v[84:99]
    ds_read_b64_tr_b16 v[24:25], v228 offset:2048
    ds_read_b64_tr_b16 v[26:27], v228 offset:3072
    s_waitcnt lgkmcnt(4)
    v_mfma_f32_32x32x16_bf16 v[84:99], a[28:31], v[32:35], v[84:99]
    ds_read_b64_tr_b16 v[28:29], v228 offset:4096
    ds_read_b64_tr_b16 v[30:31], v228 offset:5120
    buffer_load_dwordx4 v240, s[36:39], s78 offen offset:2048  lds
    s_waitcnt lgkmcnt(4)
    v_mfma_f32_32x32x16_bf16 v[84:99], a[32:35], v[20:23], v[84:99]
    ds_read_b64_tr_b16 v[32:33], v228 offset:6144
    ds_read_b64_tr_b16 v[34:35], v228 offset:7168
    s_waitcnt lgkmcnt(4)
    v_mfma_f32_32x32x16_bf16 v[84:99], a[36:39], v[24:27], v[84:99]
    ds_read_b64_tr_b16 v[20:21], v228 offset:8192
    ds_read_b64_tr_b16 v[22:23], v228 offset:9216
    s_waitcnt lgkmcnt(4)
    v_mfma_f32_32x32x16_bf16 v[84:99], a[40:43], v[28:31], v[84:99]
    ds_read_b64_tr_b16 v[24:25], v228 offset:10240
    ds_read_b64_tr_b16 v[26:27], v228 offset:11264
    s_waitcnt lgkmcnt(4)
    v_mfma_f32_32x32x16_bf16 v[84:99], a[44:47], v[32:35], v[84:99]
    s_waitcnt vmcnt(21)
    s_barrier
    ds_read_b64_tr_b16 v[28:29], v233 offset:57344
    ds_read_b64_tr_b16 v[30:31], v233 offset:58368
    s_waitcnt lgkmcnt(4)
    v_mfma_f32_32x32x16_bf16 v[84:99], a[48:51], v[20:23], v[84:99]
    ds_read_b64_tr_b16 v[32:33], v233 offset:59392
    ds_read_b64_tr_b16 v[34:35], v233 offset:60416
    s_waitcnt lgkmcnt(4)
    v_mfma_f32_32x32x16_bf16 v[84:99], a[52:55], v[24:27], v[84:99]
    ds_read_b64_tr_b16 v[20:21], v233 offset:61440
    ds_read_b64_tr_b16 v[22:23], v233 offset:62464
    s_waitcnt lgkmcnt(4)
    v_mfma_f32_32x32x16_bf16 v[84:99], a[56:59], v[28:31], v[84:99]
    ds_read_b64_tr_b16 v[24:25], v233 offset:63488
    ds_read_b64_tr_b16 v[26:27], v233 offset:64512
    s_barrier
    s_waitcnt lgkmcnt(4)
    v_mfma_f32_32x32x16_bf16 v[84:99], a[60:63], v[32:35], v[84:99]
    ds_read_b64_tr_b16 v[28:29], v229 offset:0
    ds_read_b64_tr_b16 v[30:31], v229 offset:1024
    s_add_u32 m0, s18, 114688
    s_add_u32 s78, s82, 0
    buffer_load_dwordx4 v246, s[36:39], s78 offen offset:0  lds
    s_waitcnt lgkmcnt(4)
    v_mfma_f32_32x32x16_bf16 v[84:99], a[64:67], v[20:23], v[84:99]
    ds_read_b64_tr_b16 v[32:33], v229 offset:2048
    ds_read_b64_tr_b16 v[34:35], v229 offset:3072
    buffer_load_dwordx4 v241, s[36:39], s78 offen offset:1024  lds
    buffer_load_dwordx4 v240, s[36:39], s78 offen offset:2048  lds
    buffer_load_dwordx4 v239, s[36:39], s78 offen offset:3072  lds
    s_waitcnt lgkmcnt(4)
    v_mfma_f32_32x32x16_bf16 v[84:99], a[68:71], v[24:27], v[84:99]
    ds_read_b64_tr_b16 v[20:21], v229 offset:4096
    ds_read_b64_tr_b16 v[22:23], v229 offset:5120
    s_waitcnt lgkmcnt(4)
    v_mfma_f32_32x32x16_bf16 v[84:99], a[72:75], v[28:31], v[84:99]
    ds_read_b64_tr_b16 v[24:25], v229 offset:6144
    ds_read_b64_tr_b16 v[26:27], v229 offset:7168
    s_waitcnt lgkmcnt(4)
    s_nop 0
    v_mfma_f32_32x32x16_bf16 v[84:99], a[76:79], v[32:35], v[84:99]
    ds_read_b64_tr_b16 v[28:29], v229 offset:8192
    ds_read_b64_tr_b16 v[30:31], v229 offset:9216
    s_add_u32 m0, s18, 118784
    s_add_u32 s78, s82, 86016
    buffer_load_dwordx4 v246, s[36:39], s78 offen offset:0  lds
    s_waitcnt lgkmcnt(4)
    v_mfma_f32_32x32x16_bf16 v[84:99], a[80:83], v[20:23], v[84:99]
    ds_read_b64_tr_b16 v[32:33], v229 offset:10240
    ds_read_b64_tr_b16 v[34:35], v229 offset:11264
    s_waitcnt lgkmcnt(4)
    v_mfma_f32_32x32x16_bf16 v[84:99], a[84:87], v[24:27], v[84:99]
    ds_read_b64_tr_b16 v[20:21], v229 offset:12288
    ds_read_b64_tr_b16 v[22:23], v229 offset:13312
    buffer_load_dwordx4 v241, s[36:39], s78 offen offset:1024  lds
    s_waitcnt lgkmcnt(4)
    v_mfma_f32_32x32x16_bf16 v[84:99], a[88:91], v[28:31], v[84:99]
    ds_read_b64_tr_b16 v[24:25], v229 offset:14336
    ds_read_b64_tr_b16 v[26:27], v229 offset:15360
    s_waitcnt lgkmcnt(4)
    v_mfma_f32_32x32x16_bf16 v[84:99], a[92:95], v[32:35], v[84:99]
    ds_read_b64_tr_b16 v[28:29], v229 offset:16384
    ds_read_b64_tr_b16 v[30:31], v229 offset:17408
    s_waitcnt lgkmcnt(4)
    v_mfma_f32_32x32x16_bf16 v[84:99], a[96:99], v[20:23], v[84:99]
    ds_read_b64_tr_b16 v[32:33], v229 offset:18432
    ds_read_b64_tr_b16 v[34:35], v229 offset:19456
    buffer_load_dwordx4 v240, s[36:39], s78 offen offset:2048  lds
    s_waitcnt lgkmcnt(4)
    v_mfma_f32_32x32x16_bf16 v[84:99], a[100:103], v[24:27], v[84:99]
    ds_read_b64_tr_b16 v[68:69], v220 offset:0
    ds_read_b64_tr_b16 v[70:71], v220 offset:1152
    ds_read_b64_tr_b16 v[72:73], v220 offset:2304
    ds_read_b64_tr_b16 v[74:75], v220 offset:3456
    s_waitcnt lgkmcnt(6)
    s_nop 0
    v_mfma_f32_32x32x16_bf16 v[84:99], a[104:107], v[28:31], v[84:99]
    ds_read_b64_tr_b16 v[76:77], v221 offset:0
    ds_read_b64_tr_b16 v[78:79], v221 offset:1152
    ds_read_b64_tr_b16 v[80:81], v221 offset:2304
    ds_read_b64_tr_b16 v[82:83], v221 offset:3456
    s_waitcnt lgkmcnt(8)
    v_mfma_f32_32x32x16_bf16 v[84:99], a[108:111], v[32:35], v[84:99]
    s_nop 11
    v_cvt_pk_bf16_f32 v8, v84, v85
    v_cvt_pk_bf16_f32 v9, v86, v87
    v_cvt_pk_bf16_f32 v10, v88, v89
    v_cvt_pk_bf16_f32 v11, v90, v91
    v_cvt_pk_bf16_f32 v12, v92, v93
    v_cvt_pk_bf16_f32 v13, v94, v95
    v_cvt_pk_bf16_f32 v14, v96, v97
    v_cvt_pk_bf16_f32 v15, v98, v99
    v_cndmask_b32 v8, v8, v16, s[96:97]
    v_cndmask_b32 v9, v9, v16, s[96:97]
    v_cndmask_b32 v10, v10, v16, s[96:97]
    v_cndmask_b32 v11, v11, v16, s[96:97]
    v_cndmask_b32 v12, v12, v16, s[96:97]
    v_cndmask_b32 v13, v13, v16, s[96:97]
    v_cndmask_b32 v14, v14, v16, s[96:97]
    v_cndmask_b32 v15, v15, v16, s[96:97]
    s_waitcnt lgkmcnt(6)
    v_mfma_f32_32x32x16_bf16 v[84:99], v[68:71], v[8:11], 0
    s_waitcnt lgkmcnt(4)
    v_mfma_f32_32x32x16_bf16 v[84:99], v[72:75], v[12:15], v[84:99]
    s_waitcnt lgkmcnt(2)
    v_mfma_f32_32x32x16_bf16 v[52:67], v[76:79], v[8:11], 0
    s_waitcnt lgkmcnt(0)
    v_mfma_f32_32x32x16_bf16 v[52:67], v[80:83], v[12:15], v[52:67]
    s_nop 7
    ds_write_b128 v248, v[84:87] offset:0
    ds_write_b128 v248, v[88:91] offset:1024
    ds_write_b128 v248, v[92:95] offset:2048
    ds_write_b128 v248, v[96:99] offset:3072
    s_waitcnt lgkmcnt(0)
    s_barrier
    ds_read_b128 v[84:87], v245 offset:0
    ds_read_b128 v[88:91], v245 offset:1024
    ds_read_b128 v[92:95], v245 offset:2048
    ds_read_b128 v[96:99], v245 offset:3072
    s_waitcnt lgkmcnt(3)
    v_pk_add_f32 v[52:53], v[52:53], v[84:85]
    v_pk_add_f32 v[54:55], v[54:55], v[86:87]
    v_cvt_pk_bf16_f32 v8, v52, v53
    v_cvt_pk_bf16_f32 v9, v54, v55
    s_waitcnt lgkmcnt(2)
    v_pk_add_f32 v[56:57], v[56:57], v[88:89]
    v_pk_add_f32 v[58:59], v[58:59], v[90:91]
    v_cvt_pk_bf16_f32 v10, v56, v57
    v_cvt_pk_bf16_f32 v11, v58, v59
    s_waitcnt lgkmcnt(1)
    v_pk_add_f32 v[60:61], v[60:61], v[92:93]
    v_pk_add_f32 v[62:63], v[62:63], v[94:95]
    v_cvt_pk_bf16_f32 v12, v60, v61
    v_cvt_pk_bf16_f32 v13, v62, v63
    s_waitcnt lgkmcnt(0)
    s_nop 0
    v_pk_add_f32 v[64:65], v[64:65], v[96:97]
    v_pk_add_f32 v[66:67], v[66:67], v[98:99]
    v_cvt_pk_bf16_f32 v14, v64, v65
    v_cvt_pk_bf16_f32 v15, v66, v67
    buffer_store_dwordx4 v[8:11], v252, s[72:75], s14 offen offset:0 sc1
    buffer_store_dwordx4 v[12:15], v252, s[72:75], s14 offen offset:1024 sc1
    s_waitcnt vmcnt(23)
    s_barrier
    ds_read_b64_tr_b16 v[20:21], v235 offset:0
    ds_read_b64_tr_b16 v[22:23], v235 offset:1024
    ds_read_b64_tr_b16 v[24:25], v235 offset:2048
    ds_read_b64_tr_b16 v[26:27], v235 offset:3072
    ds_read_b64_tr_b16 v[28:29], v235 offset:4096
    ds_read_b64_tr_b16 v[30:31], v235 offset:5120
    s_waitcnt lgkmcnt(4)
    v_mfma_f32_32x32x16_bf16 v[52:67], v[16:19], v[20:23], 0
    ds_read_b64_tr_b16 v[32:33], v235 offset:6144
    ds_read_b64_tr_b16 v[34:35], v235 offset:7168
    s_waitcnt lgkmcnt(4)
    v_mfma_f32_32x32x16_bf16 v[52:67], v[16:19], v[24:27], v[52:67]
    ds_read_b64_tr_b16 v[20:21], v235 offset:8192
    ds_read_b64_tr_b16 v[22:23], v235 offset:9216
    s_waitcnt lgkmcnt(4)
    v_mfma_f32_32x32x16_bf16 v[52:67], v[16:19], v[28:31], v[52:67]
    ds_read_b64_tr_b16 v[24:25], v235 offset:10240
    ds_read_b64_tr_b16 v[26:27], v235 offset:11264
    s_waitcnt lgkmcnt(4)
    v_mfma_f32_32x32x16_bf16 v[52:67], v[16:19], v[32:35], v[52:67]
    ds_read_b64_tr_b16 v[28:29], v235 offset:12288
    ds_read_b64_tr_b16 v[30:31], v235 offset:13312
    s_waitcnt lgkmcnt(4)
    v_mfma_f32_32x32x16_bf16 v[52:67], v[16:19], v[20:23], v[52:67]
    ds_read_b64_tr_b16 v[32:33], v235 offset:14336
    ds_read_b64_tr_b16 v[34:35], v235 offset:15360
    s_waitcnt lgkmcnt(4)
    v_mfma_f32_32x32x16_bf16 v[52:67], v[16:19], v[24:27], v[52:67]
    ds_read_b64_tr_b16 v[20:21], v235 offset:16384
    ds_read_b64_tr_b16 v[22:23], v235 offset:17408
    s_waitcnt lgkmcnt(4)
    v_mfma_f32_32x32x16_bf16 v[52:67], v[16:19], v[28:31], v[52:67]
    ds_read_b64_tr_b16 v[24:25], v235 offset:18432
    ds_read_b64_tr_b16 v[26:27], v235 offset:19456
    s_waitcnt lgkmcnt(4)
    v_mfma_f32_32x32x16_bf16 v[52:67], v[16:19], v[32:35], v[52:67]
    ds_read_b64_tr_b16 v[28:29], v235 offset:20480
    ds_read_b64_tr_b16 v[30:31], v235 offset:21504
    s_waitcnt lgkmcnt(4)
    v_mfma_f32_32x32x16_bf16 v[52:67], v[16:19], v[20:23], v[52:67]
    ds_read_b64_tr_b16 v[32:33], v235 offset:22528
    ds_read_b64_tr_b16 v[34:35], v235 offset:23552
    s_waitcnt lgkmcnt(4)
    v_mfma_f32_32x32x16_bf16 v[52:67], v[16:19], v[24:27], v[52:67]
    ds_read_b64_tr_b16 v[20:21], v235 offset:24576
    ds_read_b64_tr_b16 v[22:23], v235 offset:25600
    s_waitcnt lgkmcnt(4)
    v_mfma_f32_32x32x16_bf16 v[52:67], v[16:19], v[28:31], v[52:67]
    ds_read_b64_tr_b16 v[24:25], v235 offset:26624
    ds_read_b64_tr_b16 v[26:27], v235 offset:27648
    s_waitcnt lgkmcnt(4)
    v_mfma_f32_32x32x16_bf16 v[52:67], v[16:19], v[32:35], v[52:67]
    s_waitcnt vmcnt(16)
    s_barrier
    ds_read_b64_tr_b16 v[28:29], v235 offset:28672
    ds_read_b64_tr_b16 v[30:31], v235 offset:29696
    s_waitcnt lgkmcnt(4)
    v_mfma_f32_32x32x16_bf16 v[52:67], v[16:19], v[20:23], v[52:67]
    ds_read_b64_tr_b16 v[32:33], v235 offset:30720
    ds_read_b64_tr_b16 v[34:35], v235 offset:31744
    s_waitcnt lgkmcnt(4)
    v_mfma_f32_32x32x16_bf16 v[52:67], v[16:19], v[24:27], v[52:67]
    ds_read_b64_tr_b16 v[20:21], v235 offset:32768
    ds_read_b64_tr_b16 v[22:23], v235 offset:33792
    s_waitcnt lgkmcnt(4)
    v_mfma_f32_32x32x16_bf16 v[52:67], v[16:19], v[28:31], v[52:67]
    ds_read_b64_tr_b16 v[24:25], v235 offset:34816
    ds_read_b64_tr_b16 v[26:27], v235 offset:35840
    s_waitcnt lgkmcnt(4)
    v_mfma_f32_32x32x16_bf16 v[52:67], v[16:19], v[32:35], v[52:67]
    ds_read_b64_tr_b16 v[28:29], v235 offset:36864
    ds_read_b64_tr_b16 v[30:31], v235 offset:37888
    s_waitcnt lgkmcnt(4)
    v_mfma_f32_32x32x16_bf16 v[52:67], v[16:19], v[20:23], v[52:67]
    ds_read_b64_tr_b16 v[32:33], v235 offset:38912
    ds_read_b64_tr_b16 v[34:35], v235 offset:39936
    s_waitcnt lgkmcnt(4)
    v_mfma_f32_32x32x16_bf16 v[52:67], v[16:19], v[24:27], v[52:67]
    ds_read_b64_tr_b16 v[20:21], v235 offset:40960
    ds_read_b64_tr_b16 v[22:23], v235 offset:41984
    s_waitcnt lgkmcnt(4)
    v_mfma_f32_32x32x16_bf16 v[52:67], v[16:19], v[28:31], v[52:67]
    ds_read_b64_tr_b16 v[24:25], v235 offset:43008
    ds_read_b64_tr_b16 v[26:27], v235 offset:44032
    s_waitcnt lgkmcnt(4)
    v_mfma_f32_32x32x16_bf16 v[52:67], v[16:19], v[32:35], v[52:67]
    ds_read_b64_tr_b16 v[28:29], v235 offset:45056
    ds_read_b64_tr_b16 v[30:31], v235 offset:46080
    s_waitcnt lgkmcnt(4)
    v_mfma_f32_32x32x16_bf16 v[52:67], v[16:19], v[20:23], v[52:67]
    ds_read_b64_tr_b16 v[32:33], v235 offset:47104
    ds_read_b64_tr_b16 v[34:35], v235 offset:48128
    s_waitcnt vmcnt(0)
    s_barrier
    s_lshl_b32 s77, s4, 5
    s_add_u32 s77, s77, s3
    s_lshl_b32 s77, s77, 7
    s_add_u32 s77, s77, 65536
    buffer_store_dword v251, v250, s[72:75], s77 offen sc1
    s_waitcnt lgkmcnt(4)
    v_mfma_f32_32x32x16_bf16 v[52:67], v[16:19], v[24:27], v[52:67]
    ds_read_b64_tr_b16 v[20:21], v235 offset:49152
    ds_read_b64_tr_b16 v[22:23], v235 offset:50176
    s_waitcnt lgkmcnt(4)
    v_mfma_f32_32x32x16_bf16 v[52:67], v[16:19], v[28:31], v[52:67]
    ds_read_b64_tr_b16 v[24:25], v235 offset:51200
    ds_read_b64_tr_b16 v[26:27], v235 offset:52224
    s_waitcnt lgkmcnt(4)
    v_mfma_f32_32x32x16_bf16 v[52:67], v[16:19], v[32:35], v[52:67]
    ds_read_b64_tr_b16 v[28:29], v235 offset:53248
    ds_read_b64_tr_b16 v[30:31], v235 offset:54272
    s_waitcnt lgkmcnt(4)
    v_mfma_f32_32x32x16_bf16 v[52:67], v[16:19], v[20:23], v[52:67]
    ds_read_b64_tr_b16 v[32:33], v235 offset:55296
    ds_read_b64_tr_b16 v[34:35], v235 offset:56320
    s_waitcnt lgkmcnt(4)
    v_mfma_f32_32x32x16_bf16 v[52:67], v[16:19], v[24:27], v[52:67]
    s_waitcnt lgkmcnt(2)
    v_mfma_f32_32x32x16_bf16 v[52:67], v[16:19], v[28:31], v[52:67]
    s_waitcnt lgkmcnt(0)
    v_mfma_f32_32x32x16_bf16 v[52:67], v[16:19], v[32:35], v[52:67]
    s_lshl_b32 s8, s3, 1
    s_add_u32 s8, s8, s7
    s_lshl_b32 s8, s8, 10
    s_add_u32 s8, s8, 4980736
    s_nop 7
    v_cvt_pk_bf16_f32 v8, v52, v52
    v_and_b32 v9, 0xffff0000, v8
    v_sub_f32 v9, v52, v9
    v_mov_b32 v10, 0
    v_mov_b32 v11, 0
    v_cvt_pk_bf16_f32 v9, v9, v10
    v_and_b32 v8, v8, v238
    v_and_b32 v9, v9, v238
    buffer_store_dwordx4 v[8:11], v252, s[72:75], s8 offen sc1
    s_waitcnt vmcnt(0)
    s_barrier
    s_add_u32 s77, s90, 28672
    buffer_store_dword v251, v250, s[72:75], s77 offen sc1
    s_lshr_b32 s8, s3, 2
    s_lshl_b32 s8, s8, 12
    v_lshl_add_u32 v255, v230, 7, s8
    s_lshl_b32 s8, s3, 1
    s_add_u32 s8, s8, s6
    s_lshl_b32 s10, s8, 10
    s_lshl_b32 s8, s3, 1
    s_add_u32 s8, s8, s7
    s_lshl_b32 s8, s8, 5
    s_add_u32 s8, s8, s6
    s_lshl_b32 s8, s8, 10
    s_add_u32 s8, s8, 6553600
    s_add_u32 s10, s10, 5046272
    s_cmp_lg_u32 s5, 0
    s_cbranch_scc1 L_p2_skip
    s_mov_b32 s77, 65536
    buffer_load_dword v226, v255, s[72:75], s77 offen sc1
    s_waitcnt vmcnt(0)
    v_cmp_eq_u32 vcc, v226, v251
    s_nop 0
    s_cmp_eq_u64 vcc, -1
    s_cbranch_scc0 L_spin7
L_pok7:
L_p2_skip:
    s_waitcnt vmcnt(0)
    s_barrier
    s_nop 0
    buffer_load_dwordx4 v[100:103], v252, s[72:75], s8 offen sc1
    s_add_u32 s8, s8, 2048
    buffer_load_dwordx4 v[104:107], v252, s[72:75], s8 offen sc1
    s_add_u32 s8, s8, 2048
    buffer_load_dwordx4 v[108:111], v252, s[72:75], s8 offen sc1
    s_add_u32 s8, s8, 2048
    buffer_load_dwordx4 v[112:115], v252, s[72:75], s8 offen sc1
    s_add_u32 s8, s8, 2048
    buffer_load_dwordx4 v[116:119], v252, s[72:75], s8 offen sc1
    s_add_u32 s8, s8, 2048
    buffer_load_dwordx4 v[120:123], v252, s[72:75], s8 offen sc1
    s_add_u32 s8, s8, 2048
    buffer_load_dwordx4 v[124:127], v252, s[72:75], s8 offen sc1
    s_add_u32 s8, s8, 2048
    buffer_load_dwordx4 v[128:131], v252, s[72:75], s8 offen sc1
    s_add_u32 s8, s8, 2048
    buffer_load_dwordx4 v[132:135], v252, s[72:75], s8 offen sc1
    s_add_u32 s8, s8, 2048
    buffer_load_dwordx4 v[136:139], v252, s[72:75], s8 offen sc1
    s_add_u32 s8, s8, 2048
    buffer_load_dwordx4 v[140:143], v252, s[72:75], s8 offen sc1
    s_add_u32 s8, s8, 2048
    buffer_load_dwordx4 v[144:147], v252, s[72:75], s8 offen sc1
    s_add_u32 s8, s8, 2048
    buffer_load_dwordx4 v[148:151], v252, s[72:75], s8 offen sc1
    s_add_u32 s8, s8, 2048
    buffer_load_dwordx4 v[152:155], v252, s[72:75], s8 offen sc1
    s_add_u32 s8, s8, 2048
    buffer_load_dwordx4 v[156:159], v252, s[72:75], s8 offen sc1
    s_add_u32 s8, s8, 2048
    buffer_load_dwordx4 v[160:163], v252, s[72:75], s8 offen sc1
    s_add_u32 s8, s8, 2048
    v_mov_b32 v52, 0
    v_mov_b32 v53, 0
    v_mov_b32 v54, 0
    v_mov_b32 v55, 0
    v_mov_b32 v56, 0
    v_mov_b32 v57, 0
    v_mov_b32 v58, 0
    v_mov_b32 v59, 0
    v_mov_b32 v224, 0x3f80
    v_mov_b32 v225, 0x3f800000
    s_waitcnt vmcnt(15)
    v_dot2c_f32_bf16 v52, v100, v224
    v_dot2c_f32_bf16 v53, v100, v225
    v_dot2c_f32_bf16 v54, v101, v224
    v_dot2c_f32_bf16 v55, v101, v225
    v_dot2c_f32_bf16 v56, v102, v224
    v_dot2c_f32_bf16 v57, v102, v225
    v_dot2c_f32_bf16 v58, v103, v224
    v_dot2c_f32_bf16 v59, v103, v225
    s_waitcnt vmcnt(14)
    v_dot2c_f32_bf16 v52, v104, v224
    v_dot2c_f32_bf16 v53, v104, v225
    v_dot2c_f32_bf16 v54, v105, v224
    v_dot2c_f32_bf16 v55, v105, v225
    v_dot2c_f32_bf16 v56, v106, v224
    v_dot2c_f32_bf16 v57, v106, v225
    v_dot2c_f32_bf16 v58, v107, v224
    v_dot2c_f32_bf16 v59, v107, v225
    s_waitcnt vmcnt(13)
    v_dot2c_f32_bf16 v52, v108, v224
    v_dot2c_f32_bf16 v53, v108, v225
    v_dot2c_f32_bf16 v54, v109, v224
    v_dot2c_f32_bf16 v55, v109, v225
    v_dot2c_f32_bf16 v56, v110, v224
    v_dot2c_f32_bf16 v57, v110, v225
    v_dot2c_f32_bf16 v58, v111, v224
    v_dot2c_f32_bf16 v59, v111, v225
    s_waitcnt vmcnt(12)
    v_dot2c_f32_bf16 v52, v112, v224
    v_dot2c_f32_bf16 v53, v112, v225
    v_dot2c_f32_bf16 v54, v113, v224
    v_dot2c_f32_bf16 v55, v113, v225
    v_dot2c_f32_bf16 v56, v114, v224
    v_dot2c_f32_bf16 v57, v114, v225
    v_dot2c_f32_bf16 v58, v115, v224
    v_dot2c_f32_bf16 v59, v115, v225
    s_waitcnt vmcnt(11)
    v_dot2c_f32_bf16 v52, v116, v224
    v_dot2c_f32_bf16 v53, v116, v225
    v_dot2c_f32_bf16 v54, v117, v224
    v_dot2c_f32_bf16 v55, v117, v225
    v_dot2c_f32_bf16 v56, v118, v224
    v_dot2c_f32_bf16 v57, v118, v225
    v_dot2c_f32_bf16 v58, v119, v224
    v_dot2c_f32_bf16 v59, v119, v225
    s_waitcnt vmcnt(10)
    v_dot2c_f32_bf16 v52, v120, v224
    v_dot2c_f32_bf16 v53, v120, v225
    v_dot2c_f32_bf16 v54, v121, v224
    v_dot2c_f32_bf16 v55, v121, v225
    v_dot2c_f32_bf16 v56, v122, v224
    v_dot2c_f32_bf16 v57, v122, v225
    v_dot2c_f32_bf16 v58, v123, v224
    v_dot2c_f32_bf16 v59, v123, v225
    s_waitcnt vmcnt(9)
    v_dot2c_f32_bf16 v52, v124, v224
    v_dot2c_f32_bf16 v53, v124, v225
    v_dot2c_f32_bf16 v54, v125, v224
    v_dot2c_f32_bf16 v55, v125, v225
    v_dot2c_f32_bf16 v56, v126, v224
    v_dot2c_f32_bf16 v57, v126, v225
    v_dot2c_f32_bf16 v58, v127, v224
    v_dot2c_f32_bf16 v59, v127, v225
    s_waitcnt vmcnt(8)
    v_dot2c_f32_bf16 v52, v128, v224
    v_dot2c_f32_bf16 v53, v128, v225
    v_dot2c_f32_bf16 v54, v129, v224
    v_dot2c_f32_bf16 v55, v129, v225
    v_dot2c_f32_bf16 v56, v130, v224
    v_dot2c_f32_bf16 v57, v130, v225
    v_dot2c_f32_bf16 v58, v131, v224
    v_dot2c_f32_bf16 v59, v131, v225
    s_waitcnt vmcnt(7)
    v_dot2c_f32_bf16 v52, v132, v224
    v_dot2c_f32_bf16 v53, v132, v225
    v_dot2c_f32_bf16 v54, v133, v224
    v_dot2c_f32_bf16 v55, v133, v225
    v_dot2c_f32_bf16 v56, v134, v224
    v_dot2c_f32_bf16 v57, v134, v225
    v_dot2c_f32_bf16 v58, v135, v224
    v_dot2c_f32_bf16 v59, v135, v225
    s_waitcnt vmcnt(6)
    v_dot2c_f32_bf16 v52, v136, v224
    v_dot2c_f32_bf16 v53, v136, v225
    v_dot2c_f32_bf16 v54, v137, v224
    v_dot2c_f32_bf16 v55, v137, v225
    v_dot2c_f32_bf16 v56, v138, v224
    v_dot2c_f32_bf16 v57, v138, v225
    v_dot2c_f32_bf16 v58, v139, v224
    v_dot2c_f32_bf16 v59, v139, v225
    s_waitcnt vmcnt(5)
    v_dot2c_f32_bf16 v52, v140, v224
    v_dot2c_f32_bf16 v53, v140, v225
    v_dot2c_f32_bf16 v54, v141, v224
    v_dot2c_f32_bf16 v55, v141, v225
    v_dot2c_f32_bf16 v56, v142, v224
    v_dot2c_f32_bf16 v57, v142, v225
    v_dot2c_f32_bf16 v58, v143, v224
    v_dot2c_f32_bf16 v59, v143, v225
    s_waitcnt vmcnt(4)
    v_dot2c_f32_bf16 v52, v144, v224
    v_dot2c_f32_bf16 v53, v144, v225
    v_dot2c_f32_bf16 v54, v145, v224
    v_dot2c_f32_bf16 v55, v145, v225
    v_dot2c_f32_bf16 v56, v146, v224
    v_dot2c_f32_bf16 v57, v146, v225
    v_dot2c_f32_bf16 v58, v147, v224
    v_dot2c_f32_bf16 v59, v147, v225
    s_waitcnt vmcnt(3)
    v_dot2c_f32_bf16 v52, v148, v224
    v_dot2c_f32_bf16 v53, v148, v225
    v_dot2c_f32_bf16 v54, v149, v224
    v_dot2c_f32_bf16 v55, v149, v225
    v_dot2c_f32_bf16 v56, v150, v224
    v_dot2c_f32_bf16 v57, v150, v225
    v_dot2c_f32_bf16 v58, v151, v224
    v_dot2c_f32_bf16 v59, v151, v225
    s_waitcnt vmcnt(2)
    v_dot2c_f32_bf16 v52, v152, v224
    v_dot2c_f32_bf16 v53, v152, v225
    v_dot2c_f32_bf16 v54, v153, v224
    v_dot2c_f32_bf16 v55, v153, v225
    v_dot2c_f32_bf16 v56, v154, v224
    v_dot2c_f32_bf16 v57, v154, v225
    v_dot2c_f32_bf16 v58, v155, v224
    v_dot2c_f32_bf16 v59, v155, v225
    s_waitcnt vmcnt(1)
    v_dot2c_f32_bf16 v52, v156, v224
    v_dot2c_f32_bf16 v53, v156, v225
    v_dot2c_f32_bf16 v54, v157, v224
    v_dot2c_f32_bf16 v55, v157, v225
    v_dot2c_f32_bf16 v56, v158, v224
    v_dot2c_f32_bf16 v57, v158, v225
    v_dot2c_f32_bf16 v58, v159, v224
    v_dot2c_f32_bf16 v59, v159, v225
    s_waitcnt vmcnt(0)
    v_dot2c_f32_bf16 v52, v160, v224
    v_dot2c_f32_bf16 v53, v160, v225
    v_dot2c_f32_bf16 v54, v161, v224
    v_dot2c_f32_bf16 v55, v161, v225
    v_dot2c_f32_bf16 v56, v162, v224
    v_dot2c_f32_bf16 v57, v162, v225
    v_dot2c_f32_bf16 v58, v163, v224
    v_dot2c_f32_bf16 v59, v163, v225
    ds_write_b128 v248, v[52:55] offset:0
    s_nop 1
    ds_write_b128 v248, v[56:59] offset:1024
    s_waitcnt lgkmcnt(0)
    s_barrier
    ds_read_b128 v[60:63], v227 offset:0
    ds_read_b128 v[64:67], v227 offset:1024
    s_waitcnt lgkmcnt(0)
    s_nop 0
    v_pk_add_f32 v[52:53], v[52:53], v[60:61]
    v_pk_add_f32 v[54:55], v[54:55], v[62:63]
    v_pk_add_f32 v[56:57], v[56:57], v[64:65]
    v_pk_add_f32 v[58:59], v[58:59], v[66:67]
    v_cvt_pk_bf16_f32 v8, v52, v53
    v_cvt_pk_bf16_f32 v9, v54, v55
    v_cvt_pk_bf16_f32 v10, v56, v57
    v_cvt_pk_bf16_f32 v11, v58, v59
    buffer_store_dwordx4 v[8:11], v252, s[72:75], s10 offen sc1
    v_and_b32 v2, 1, v1
    s_lshl_b32 s9, s13, 1
    v_add_u32 v2, s9, v2
    v_lshlrev_b32 v2, 7, v2
    v_add_u32 v255, 28, v2
    s_waitcnt vmcnt(0)
    s_barrier
    s_nop 0
    s_add_u32 s77, s90, 16384
    buffer_store_dword v251, v250, s[72:75], s77 offen sc1
    ds_read_b64_tr_b16 v[20:21], v229 offset:20480
    ds_read_b64_tr_b16 v[22:23], v229 offset:21504
    ds_read_b64_tr_b16 v[24:25], v229 offset:22528
    ds_read_b64_tr_b16 v[26:27], v229 offset:23552
    ds_read_b64_tr_b16 v[28:29], v229 offset:24576
    ds_read_b64_tr_b16 v[30:31], v229 offset:25600
    s_waitcnt lgkmcnt(4)
    v_mfma_f32_32x32x16_bf16 v[52:67], v[20:23], a[0:3], 0
    ds_read_b64_tr_b16 v[32:33], v229 offset:26624
    ds_read_b64_tr_b16 v[34:35], v229 offset:27648
    s_waitcnt lgkmcnt(4)
    v_mfma_f32_32x32x16_bf16 v[52:67], v[24:27], a[4:7], v[52:67]
    ds_read_b64_tr_b16 v[20:21], v229 offset:28672
    ds_read_b64_tr_b16 v[22:23], v229 offset:29696
    s_waitcnt lgkmcnt(4)
    v_mfma_f32_32x32x16_bf16 v[52:67], v[28:31], a[8:11], v[52:67]
    ds_read_b64_tr_b16 v[24:25], v229 offset:30720
    ds_read_b64_tr_b16 v[26:27], v229 offset:31744
    s_waitcnt lgkmcnt(4)
    v_mfma_f32_32x32x16_bf16 v[52:67], v[32:35], a[12:15], v[52:67]
    ds_read_b64_tr_b16 v[28:29], v229 offset:32768
    ds_read_b64_tr_b16 v[30:31], v229 offset:33792
    s_waitcnt lgkmcnt(4)
    v_mfma_f32_32x32x16_bf16 v[52:67], v[20:23], a[16:19], v[52:67]
    ds_read_b64_tr_b16 v[32:33], v229 offset:34816
    ds_read_b64_tr_b16 v[34:35], v229 offset:35840
    s_waitcnt lgkmcnt(4)
    v_mfma_f32_32x32x16_bf16 v[52:67], v[24:27], a[20:23], v[52:67]
    ds_read_b64_tr_b16 v[20:21], v229 offset:36864
    ds_read_b64_tr_b16 v[22:23], v229 offset:37888
    s_waitcnt lgkmcnt(4)
    v_mfma_f32_32x32x16_bf16 v[52:67], v[28:31], a[24:27], v[52:67]
    ds_read_b64_tr_b16 v[24:25], v229 offset:38912
    ds_read_b64_tr_b16 v[26:27], v229 offset:39936
    s_waitcnt lgkmcnt(4)
    v_mfma_f32_32x32x16_bf16 v[52:67], v[32:35], a[28:31], v[52:67]
    ds_read_b64_tr_b16 v[28:29], v229 offset:40960
    ds_read_b64_tr_b16 v[30:31], v229 offset:41984
    s_waitcnt lgkmcnt(4)
    v_mfma_f32_32x32x16_bf16 v[52:67], v[20:23], a[32:35], v[52:67]
    ds_read_b64_tr_b16 v[32:33], v229 offset:43008
    ds_read_b64_tr_b16 v[34:35], v229 offset:44032
    s_waitcnt lgkmcnt(4)
    v_mfma_f32_32x32x16_bf16 v[52:67], v[24:27], a[36:39], v[52:67]
    ds_read_b64_tr_b16 v[20:21], v229 offset:45056
    ds_read_b64_tr_b16 v[22:23], v229 offset:46080
    s_waitcnt lgkmcnt(4)
    v_mfma_f32_32x32x16_bf16 v[52:67], v[28:31], a[40:43], v[52:67]
    ds_read_b64_tr_b16 v[24:25], v229 offset:47104
    ds_read_b64_tr_b16 v[26:27], v229 offset:48128
    s_waitcnt lgkmcnt(4)
    v_mfma_f32_32x32x16_bf16 v[52:67], v[32:35], a[44:47], v[52:67]
    ds_read_b64_tr_b16 v[28:29], v229 offset:49152
    ds_read_b64_tr_b16 v[30:31], v229 offset:50176
    s_waitcnt lgkmcnt(4)
    v_mfma_f32_32x32x16_bf16 v[52:67], v[20:23], a[48:51], v[52:67]
    ds_read_b64_tr_b16 v[32:33], v229 offset:51200
    ds_read_b64_tr_b16 v[34:35], v229 offset:52224
    s_waitcnt lgkmcnt(4)
    v_mfma_f32_32x32x16_bf16 v[52:67], v[24:27], a[52:55], v[52:67]
    ds_read_b64_tr_b16 v[20:21], v229 offset:53248
    ds_read_b64_tr_b16 v[22:23], v229 offset:54272
    s_waitcnt lgkmcnt(4)
    v_mfma_f32_32x32x16_bf16 v[52:67], v[28:31], a[56:59], v[52:67]
    ds_read_b64_tr_b16 v[24:25], v229 offset:55296
    ds_read_b64_tr_b16 v[26:27], v229 offset:56320
    s_waitcnt lgkmcnt(4)
    v_mfma_f32_32x32x16_bf16 v[52:67], v[32:35], a[60:63], v[52:67]
    ds_read_b64_tr_b16 v[28:29], v229 offset:57344
    ds_read_b64_tr_b16 v[30:31], v229 offset:58368
    s_waitcnt lgkmcnt(4)
    v_mfma_f32_32x32x16_bf16 v[52:67], v[20:23], a[64:67], v[52:67]
    ds_read_b64_tr_b16 v[32:33], v229 offset:59392
    ds_read_b64_tr_b16 v[34:35], v229 offset:60416
    s_waitcnt lgkmcnt(4)
    v_mfma_f32_32x32x16_bf16 v[52:67], v[24:27], a[68:71], v[52:67]
    ds_read_b64_tr_b16 v[20:21], v229 offset:61440
    ds_read_b64_tr_b16 v[22:23], v229 offset:62464
    s_waitcnt lgkmcnt(4)
    v_mfma_f32_32x32x16_bf16 v[52:67], v[28:31], a[72:75], v[52:67]
    ds_read_b64_tr_b16 v[24:25], v229 offset:63488
    ds_read_b64_tr_b16 v[26:27], v229 offset:64512
    s_waitcnt lgkmcnt(4)
    v_mfma_f32_32x32x16_bf16 v[52:67], v[32:35], a[76:79], v[52:67]
    ds_read_b64_tr_b16 v[28:29], v228 offset:0
    ds_read_b64_tr_b16 v[30:31], v228 offset:1024
    s_waitcnt lgkmcnt(4)
    v_mfma_f32_32x32x16_bf16 v[52:67], v[20:23], a[80:83], v[52:67]
    ds_read_b64_tr_b16 v[32:33], v228 offset:2048
    ds_read_b64_tr_b16 v[34:35], v228 offset:3072
    s_waitcnt lgkmcnt(4)
    v_mfma_f32_32x32x16_bf16 v[52:67], v[24:27], a[84:87], v[52:67]
    ds_read_b64_tr_b16 v[20:21], v228 offset:4096
    ds_read_b64_tr_b16 v[22:23], v228 offset:5120
    s_waitcnt lgkmcnt(4)
    v_mfma_f32_32x32x16_bf16 v[52:67], v[28:31], a[88:91], v[52:67]
    ds_read_b64_tr_b16 v[24:25], v228 offset:6144
    ds_read_b64_tr_b16 v[26:27], v228 offset:7168
    s_waitcnt lgkmcnt(4)
    v_mfma_f32_32x32x16_bf16 v[52:67], v[32:35], a[92:95], v[52:67]
    ds_read_b64_tr_b16 v[28:29], v228 offset:8192
    ds_read_b64_tr_b16 v[30:31], v228 offset:9216
    s_waitcnt lgkmcnt(4)
    v_mfma_f32_32x32x16_bf16 v[52:67], v[20:23], a[96:99], v[52:67]
    ds_read_b64_tr_b16 v[32:33], v228 offset:10240
    ds_read_b64_tr_b16 v[34:35], v228 offset:11264
    s_waitcnt lgkmcnt(4)
    v_mfma_f32_32x32x16_bf16 v[52:67], v[24:27], a[100:103], v[52:67]
    s_waitcnt lgkmcnt(2)
    v_mfma_f32_32x32x16_bf16 v[52:67], v[28:31], a[104:107], v[52:67]
    s_waitcnt lgkmcnt(0)
    v_mfma_f32_32x32x16_bf16 v[52:67], v[32:35], a[108:111], v[52:67]
    s_nop 11
    s_nop 0
    v_cvt_pk_bf16_f32 v164, v52, v53
    v_cvt_pk_bf16_f32 v165, v54, v55
    v_cvt_pk_bf16_f32 v166, v56, v57
    v_cvt_pk_bf16_f32 v167, v58, v59
    v_cvt_pk_bf16_f32 v168, v60, v61
    v_cvt_pk_bf16_f32 v169, v62, v63
    v_cvt_pk_bf16_f32 v170, v64, v65
    v_cvt_pk_bf16_f32 v171, v66, v67
    v_and_b32 v170, v170, v238
    v_and_b32 v171, v171, v238
    v_mfma_f32_32x32x16_bf16 v[52:67], a[112:115], v[164:167], 0
    s_nop 0
    v_mfma_f32_32x32x16_bf16 v[52:67], a[116:119], v[168:171], v[52:67]
    s_nop 11
    v_max3_f32 v222, v52, v53, v54
    v_max3_f32 v223, -v52, -v53, -v54
    v_max3_f32 v222, v222, v55, v56
    v_max3_f32 v223, v223, -v55, -v56
    v_max3_f32 v222, v222, v57, v58
    v_max3_f32 v223, v223, -v57, -v58
    v_max3_f32 v222, v222, v59, v60
    v_max3_f32 v223, v223, -v59, -v60
    v_max3_f32 v222, v222, v61, v62
    v_max3_f32 v223, v223, -v61, -v62
    v_max3_f32 v222, v222, v63, v64
    v_max3_f32 v223, v223, -v63, -v64
    v_max3_f32 v222, v222, v65, v66
    v_max3_f32 v223, v223, -v65, -v66
    v_max_f32_e64 v222, v222, v67
    v_max_f32_e64 v223, v223, -v67
    s_nop 1
    v_permlane32_swap_b32 v222, v223
    v_max_f32_e64 v222, v222, v223
    v_mul_f32 v222, 0xbfb8aa3b, v222
    v_mov_b32 v223, v222
    s_nop 1
    v_permlane32_swap_b32 v222, v223
    s_nop 0
    v_pk_fma_f32 v[164:165], v[52:53], s[98:99], v[222:223] op_sel:[0,0,1] op_sel_hi:[1,0,1] neg_lo:[1,0,0] neg_hi:[1,0,0]
    v_pk_fma_f32 v[52:53], v[52:53], s[98:99], v[222:223] op_sel_hi:[1,0,0]
    v_pk_fma_f32 v[166:167], v[54:55], s[98:99], v[222:223] op_sel:[0,0,1] op_sel_hi:[1,0,1] neg_lo:[1,0,0] neg_hi:[1,0,0]
    v_pk_fma_f32 v[54:55], v[54:55], s[98:99], v[222:223] op_sel_hi:[1,0,0]
    v_pk_fma_f32 v[168:169], v[56:57], s[98:99], v[222:223] op_sel:[0,0,1] op_sel_hi:[1,0,1] neg_lo:[1,0,0] neg_hi:[1,0,0]
    v_pk_fma_f32 v[56:57], v[56:57], s[98:99], v[222:223] op_sel_hi:[1,0,0]
    v_pk_fma_f32 v[170:171], v[58:59], s[98:99], v[222:223] op_sel:[0,0,1] op_sel_hi:[1,0,1] neg_lo:[1,0,0] neg_hi:[1,0,0]
    v_pk_fma_f32 v[58:59], v[58:59], s[98:99], v[222:223] op_sel_hi:[1,0,0]
    v_pk_fma_f32 v[172:173], v[60:61], s[98:99], v[222:223] op_sel:[0,0,1] op_sel_hi:[1,0,1] neg_lo:[1,0,0] neg_hi:[1,0,0]
    v_pk_fma_f32 v[60:61], v[60:61], s[98:99], v[222:223] op_sel_hi:[1,0,0]
    v_pk_fma_f32 v[174:175], v[62:63], s[98:99], v[222:223] op_sel:[0,0,1] op_sel_hi:[1,0,1] neg_lo:[1,0,0] neg_hi:[1,0,0]
    v_pk_fma_f32 v[62:63], v[62:63], s[98:99], v[222:223] op_sel_hi:[1,0,0]
    v_pk_fma_f32 v[176:177], v[64:65], s[98:99], v[222:223] op_sel:[0,0,1] op_sel_hi:[1,0,1] neg_lo:[1,0,0] neg_hi:[1,0,0]
    v_pk_fma_f32 v[64:65], v[64:65], s[98:99], v[222:223] op_sel_hi:[1,0,0]
    v_pk_fma_f32 v[178:179], v[66:67], s[98:99], v[222:223] op_sel:[0,0,1] op_sel_hi:[1,0,1] neg_lo:[1,0,0] neg_hi:[1,0,0]
    v_pk_fma_f32 v[66:67], v[66:67], s[98:99], v[222:223] op_sel_hi:[1,0,0]
    v_exp_f32 v52, v52
    v_exp_f32 v164, v164
    v_exp_f32 v53, v53
    v_exp_f32 v165, v165
    v_exp_f32 v54, v54
    v_exp_f32 v166, v166
    v_exp_f32 v55, v55
    v_exp_f32 v167, v167
    v_exp_f32 v56, v56
    v_exp_f32 v168, v168
    v_exp_f32 v57, v57
    v_exp_f32 v169, v169
    v_exp_f32 v58, v58
    v_exp_f32 v170, v170
    v_exp_f32 v59, v59
    v_exp_f32 v171, v171
    v_exp_f32 v60, v60
    v_exp_f32 v172, v172
    v_exp_f32 v61, v61
    v_exp_f32 v173, v173
    v_exp_f32 v62, v62
    v_exp_f32 v174, v174
    v_exp_f32 v63, v63
    v_exp_f32 v175, v175
    v_exp_f32 v64, v64
    v_exp_f32 v176, v176
    v_exp_f32 v65, v65
    v_exp_f32 v177, v177
    v_exp_f32 v66, v66
    v_exp_f32 v178, v178
    v_exp_f32 v67, v67
    v_exp_f32 v179, v179
    v_pk_add_f32 v[220:221], v[52:53], v[54:55]
    v_pk_add_f32 v[218:219], v[164:165], v[166:167]
    v_pk_add_f32 v[216:217], v[64:65], v[66:67]
    v_pk_add_f32 v[214:215], v[176:177], v[178:179]
    v_pk_add_f32 v[220:221], v[220:221], v[56:57]
    v_pk_add_f32 v[218:219], v[218:219], v[168:169]
    v_pk_add_f32 v[220:221], v[220:221], v[58:59]
    v_pk_add_f32 v[218:219], v[218:219], v[170:171]
    v_pk_add_f32 v[220:221], v[220:221], v[60:61]
    v_pk_add_f32 v[218:219], v[218:219], v[172:173]
    v_pk_add_f32 v[220:221], v[220:221], v[62:63]
    v_pk_add_f32 v[218:219], v[218:219], v[174:175]
    v_pk_fma_f32 v[220:221], v[216:217], v[236:237], v[220:221] op_sel_hi:[1,0,1]
    v_pk_fma_f32 v[218:219], v[214:215], v[236:237], v[218:219] op_sel_hi:[1,0,1]
    v_add_f32 v220, v220, v221
    v_add_f32 v218, v218, v219
    s_nop 1
    v_permlane32_swap_b32 v220, v218
    v_add_f32 v220, v220, v218
    v_rcp_f32 v220, v220
    s_nop 0
    v_mov_b32 v218, v220
    s_nop 1
    v_permlane32_swap_b32 v220, v218
    v_mul_f32 v221, v220, v236
    v_mul_f32 v219, v218, v236
    v_pk_mul_f32 v[52:53], v[52:53], v[220:221] op_sel_hi:[1,0]
    v_pk_mul_f32 v[54:55], v[54:55], v[220:221] op_sel_hi:[1,0]
    v_pk_mul_f32 v[56:57], v[56:57], v[220:221] op_sel_hi:[1,0]
    v_pk_mul_f32 v[58:59], v[58:59], v[220:221] op_sel_hi:[1,0]
    v_pk_mul_f32 v[60:61], v[60:61], v[220:221] op_sel_hi:[1,0]
    v_pk_mul_f32 v[62:63], v[62:63], v[220:221] op_sel_hi:[1,0]
    v_pk_mul_f32 v[64:65], v[64:65], v[220:221] op_sel:[0,1] op_sel_hi:[1,1]
    v_pk_mul_f32 v[66:67], v[66:67], v[220:221] op_sel:[0,1] op_sel_hi:[1,1]
    v_cvt_pk_bf16_f32 v68, v52, v53
    v_cvt_pk_bf16_f32 v69, v54, v55
    v_cvt_pk_bf16_f32 v70, v56, v57
    v_cvt_pk_bf16_f32 v71, v58, v59
    v_cvt_pk_bf16_f32 v72, v60, v61
    v_cvt_pk_bf16_f32 v73, v62, v63
    v_cvt_pk_bf16_f32 v74, v64, v65
    v_cvt_pk_bf16_f32 v75, v66, v67
    v_pk_mul_f32 v[164:165], v[164:165], v[218:219] op_sel_hi:[1,0]
    v_pk_mul_f32 v[166:167], v[166:167], v[218:219] op_sel_hi:[1,0]
    v_pk_mul_f32 v[168:169], v[168:169], v[218:219] op_sel_hi:[1,0]
    v_pk_mul_f32 v[170:171], v[170:171], v[218:219] op_sel_hi:[1,0]
    v_pk_mul_f32 v[172:173], v[172:173], v[218:219] op_sel_hi:[1,0]
    v_pk_mul_f32 v[174:175], v[174:175], v[218:219] op_sel_hi:[1,0]
    v_pk_mul_f32 v[176:177], v[176:177], v[218:219] op_sel:[0,1] op_sel_hi:[1,1]
    v_pk_mul_f32 v[178:179], v[178:179], v[218:219] op_sel:[0,1] op_sel_hi:[1,1]
    v_cvt_pk_bf16_f32 v76, v164, v165
    v_cvt_pk_bf16_f32 v77, v166, v167
    v_cvt_pk_bf16_f32 v78, v168, v169
    v_cvt_pk_bf16_f32 v79, v170, v171
    v_cvt_pk_bf16_f32 v80, v172, v173
    v_cvt_pk_bf16_f32 v81, v174, v175
    v_cvt_pk_bf16_f32 v82, v176, v177
    v_cvt_pk_bf16_f32 v83, v178, v179
    s_lshl_b32 s9, s13, 12
    s_add_u32 s9, s9, 5046272
    s_lshl_b32 s11, s12, 4
    s_add_u32 s11, s11, s13
    s_lshl_b32 s11, s11, 11
    s_add_u32 s11, s11, 8650752
    s_mov_b32 s77, 20480
    buffer_load_dword v226, v255, s[72:75], s77 offen sc1
    s_waitcnt vmcnt(0)
    v_cmp_eq_u32 vcc, v226, v251
    s_nop 0
    s_cmp_eq_u64 vcc, -1
    s_cbranch_scc0 L_spin8
L_pok8:
    buffer_load_dwordx4 v[100:103], v252, s[72:75], s9 offen offset:0 sc1
    buffer_load_dwordx4 v[104:107], v252, s[72:75], s9 offen offset:1024 sc1
    buffer_load_dwordx4 v[108:111], v252, s[72:75], s9 offen offset:2048 sc1
    buffer_load_dwordx4 v[112:115], v252, s[72:75], s9 offen offset:3072 sc1
    s_waitcnt vmcnt(3)
    v_mfma_f32_32x32x16_bf16 v[52:67], v[100:103], v[68:71], 0
    s_waitcnt vmcnt(2)
    v_mfma_f32_32x32x16_bf16 v[52:67], v[104:107], v[72:75], v[52:67]
    s_waitcnt vmcnt(1)
    v_mfma_f32_32x32x16_bf16 v[52:67], v[108:111], v[76:79], v[52:67]
    s_waitcnt vmcnt(0)
    v_mfma_f32_32x32x16_bf16 v[52:67], v[112:115], v[80:83], v[52:67]
    s_nop 11
    v_add_f32 v223, 0x358637bd, v64
    v_rcp_f32 v223, v223
    s_nop 0
    v_mov_b32 v222, v223
    s_nop 1
    v_permlane32_swap_b32 v223, v222
    s_nop 0
    v_pk_mul_f32 v[52:53], v[52:53], v[222:223] op_sel_hi:[1,0]
    v_pk_mul_f32 v[54:55], v[54:55], v[222:223] op_sel_hi:[1,0]
    v_pk_mul_f32 v[56:57], v[56:57], v[222:223] op_sel_hi:[1,0]
    v_pk_mul_f32 v[58:59], v[58:59], v[222:223] op_sel_hi:[1,0]
    v_pk_mul_f32 v[60:61], v[60:61], v[222:223] op_sel_hi:[1,0]
    v_pk_mul_f32 v[62:63], v[62:63], v[222:223] op_sel_hi:[1,0]
    v_pk_mul_f32 v[64:65], v[64:65], v[222:223] op_sel_hi:[1,0]
    v_pk_mul_f32 v[66:67], v[66:67], v[222:223] op_sel_hi:[1,0]
    v_cvt_pk_bf16_f32 v68, v52, v53
    v_cvt_pk_bf16_f32 v69, v54, v55
    v_cvt_pk_bf16_f32 v70, v56, v57
    v_cvt_pk_bf16_f32 v71, v58, v59
    v_cvt_pk_bf16_f32 v72, v60, v61
    v_cvt_pk_bf16_f32 v73, v62, v63
    v_cvt_pk_bf16_f32 v74, v64, v65
    v_cvt_pk_bf16_f32 v75, v66, v67
    v_and_b32 v74, v74, v238
    v_and_b32 v75, v75, v238
    buffer_store_dwordx4 v[68:71], v252, s[72:75], s11 offen offset:0 sc1
    buffer_store_dwordx4 v[72:75], v252, s[72:75], s11 offen offset:1024 sc1
    s_waitcnt vmcnt(0)
    s_barrier
    s_add_u32 s77, s90, 24576
    buffer_store_dword v251, v250, s[72:75], s77 offen sc1
L_fin_s:
    s_endpgm
L_abort_s:
    v_mov_b32 v2, 0xdead
    buffer_store_dword v2, v254, s[68:71], 0 offen offset:16
    s_endpgm
L_tok_retry_s:
    s_mov_b32 s89, 200000
L_tok_loop_s:
    s_sleep 8
    buffer_load_dwordx4 v[8:11], v254, s[68:71], 0 offen sc1
    s_sub_u32 s89, s89, 1
    s_cbranch_scc1 L_abort_s
    s_waitcnt vmcnt(0)
    v_readfirstlane_b32 s8, v9
    s_nop 0
    s_cmp_lt_u32 s8, 1
    s_cbranch_scc1 L_tok_loop_s
    s_branch L_tok_ok_s
L_spin7:
    s_mov_b32 s89, 200000
    s_mov_b32 s77, 65536
L_spinl7:
    s_sleep 4
    buffer_load_dword v226, v255, s[72:75], s77 offen sc1
    s_sub_u32 s89, s89, 1
    s_cbranch_scc1 L_abort_s
    s_waitcnt vmcnt(0)
    v_cmp_eq_u32 vcc, v226, v251
    s_nop 0
    s_cmp_eq_u64 vcc, -1
    s_cbranch_scc0 L_spinl7
    s_branch L_pok7
L_spin8:
    s_mov_b32 s89, 200000
    s_mov_b32 s77, 20480
L_spinl8:
    s_sleep 4
    buffer_load_dword v226, v255, s[72:75], s77 offen sc1
    s_sub_u32 s89, s89, 1
    s_cbranch_scc1 L_abort_s
    s_waitcnt vmcnt(0)
    v_cmp_eq_u32 vcc, v226, v251
    s_nop 0
    s_cmp_eq_u64 vcc, -1
    s_cbranch_scc0 L_spinl8
    s_branch L_pok8
L_end:
    s_endpgm
L_code_end:
.section .rodata,"a"
.p2align 6
.amdhsa_kernel recurrent_scan__linear_kernel_hedgehog__mixer_s_mlp__prompt_kernel
  .amdhsa_next_free_vgpr 512
  .amdhsa_next_free_sgpr 102
  .amdhsa_accum_offset 256
  .amdhsa_group_segment_fixed_size 0
  .amdhsa_kernarg_size 96
  .amdhsa_user_sgpr_count 2
  .amdhsa_user_sgpr_kernarg_segment_ptr 1
  .amdhsa_system_sgpr_workgroup_id_x 1
.end_amdhsa_kernel
```
